```python
import torch

def _softmax(x, axis=-1):
    return torch.softmax(x, dim=axis)

def _gelu(x):
    return torch.nn.functional.gelu(x, approximate='tanh')

def _silu(x):
    return torch.nn.functional.silu(x)

def _sigmoid(x):
    return torch.sigmoid(x)

def _layernorm(x, axis=-1, eps=1e-05):
    m = x.mean(dim=axis, keepdim=True)
    v = x.var(dim=axis, keepdim=True, unbiased=False)
    return (x - m) / torch.sqrt(v + eps)

def _scatter_add(tgt, idx, src, axis=0):
    return tgt.clone().index_add_(axis, idx, src)

def _segment_sum(src, seg, n):
    out = torch.zeros((n,) + src.shape[1:], dtype=src.dtype)
    return out.index_add_(0, seg, src)

def _pad(x, pw):
    flat = tuple((v for pair in reversed(pw) for v in pair))
    return torch.nn.functional.pad(x, flat)
kernel_name = 'concat_heads__ssm_conv_s5__memory_aug_recurrent_mem_tr__prompt'

def setup_inputs():

    _w = lambda a: (lambda t: t.to(torch.bfloat16) if t.is_floating_point() else t)(torch.as_tensor(a))

    def _A_setup():
        B, S, D = (1, 2048, 512)
        P = D
        Lambda_re = -0.5 * (lambda _x: torch.exp(torch.as_tensor(_x)))((lambda *s: torch.randn(*s, dtype=torch.bfloat16) * 0.8)(P))
        Lambda_im = (lambda *s: torch.randn(*s, dtype=torch.bfloat16) * 0.8)(P) * 1.0
        B_re = (lambda *s: torch.randn(*s, dtype=torch.bfloat16) * 0.8)(P, D) * D ** (-0.5)
        B_im = (lambda *s: torch.randn(*s, dtype=torch.bfloat16) * 0.8)(P, D) * D ** (-0.5)
        C_re = (lambda *s: torch.randn(*s, dtype=torch.bfloat16) * 0.8)(D, P) * P ** (-0.5)
        C_im = (lambda *s: torch.randn(*s, dtype=torch.bfloat16) * 0.8)(D, P) * P ** (-0.5)
        log_dt = (lambda *s: torch.randn(*s, dtype=torch.bfloat16) * 0.8)(P) * 0.3 - 2.0
        Dskip = (lambda *s: torch.randn(*s, dtype=torch.bfloat16) * 0.8)(D)
        return {'x': _w((lambda *s: torch.randn(*s, dtype=torch.bfloat16) * 0.05)(B, S, D)), 'Lambda_re': _w(Lambda_re), 'Lambda_im': _w(Lambda_im), 'B_re': _w(B_re), 'B_im': _w(B_im), 'C_re': _w(C_re), 'C_im': _w(C_im), 'log_dt': _w(log_dt), 'Dskip': _w(Dskip)}
    _A_in = _A_setup()

    def _B_setup():
        B, S, Dm = (1, 2048, 512)
        H, Dh = (32, 128)
        M, seg = (8, 32)
        seg = min(seg, S)
        S = S // seg * seg
        return {'x': _w((lambda *s: torch.randn(*s, dtype=torch.bfloat16) * 0.05)(B, S, Dm)), 'mem0': _w((lambda *s: torch.randn(*s, dtype=torch.bfloat16) * 0.8)(B, M, Dm)), 'Wq': _w((lambda *s: torch.randn(*s, dtype=torch.bfloat16) * 1.6)(Dm, H, Dh) * Dm ** (-0.5)), 'Wk': _w((lambda *s: torch.randn(*s, dtype=torch.bfloat16) * 1.6)(Dm, H, Dh) * Dm ** (-0.5)), 'Wv': _w((lambda *s: torch.randn(*s, dtype=torch.bfloat16) * 0.8)(Dm, H, Dh) * Dm ** (-0.5)), 'Wo': _w((lambda *s: torch.randn(*s, dtype=torch.bfloat16) * 0.8)(H, Dh, Dm) * (H * Dh) ** (-0.5)), 'seg_len': seg}
    _B_in = _B_setup()
    return {'A_x': _A_in['x'], 'A_Lambda_re': _A_in['Lambda_re'], 'A_Lambda_im': _A_in['Lambda_im'], 'A_B_re': _A_in['B_re'], 'A_B_im': _A_in['B_im'], 'A_C_re': _A_in['C_re'], 'A_C_im': _A_in['C_im'], 'A_log_dt': _A_in['log_dt'], 'A_Dskip': _A_in['Dskip'], 'B_x': _B_in['x'], 'B_mem0': _B_in['mem0'], 'B_Wq': _B_in['Wq'], 'B_Wk': _B_in['Wk'], 'B_Wv': _B_in['Wv'], 'B_Wo': _B_in['Wo'], 'B_seg_len': _B_in['seg_len']}

def reference(A_x, A_Lambda_re, A_Lambda_im, A_B_re, A_B_im, A_C_re, A_C_im, A_log_dt, A_Dskip, B_x, B_mem0, B_Wq, B_Wk, B_Wv, B_Wo, B_seg_len):

    def _A_ref(x, Lambda_re, Lambda_im, B_re, B_im, C_re, C_im, log_dt, Dskip):
        Bsz, L, H = x.shape
        Lam = Lambda_re + 1j * Lambda_im
        Bmat = B_re + 1j * B_im
        Cmat = C_re + 1j * C_im
        dt = torch.exp(log_dt)
        Lam_bar = torch.exp(dt * Lam)
        B_bar = ((Lam_bar - 1.0) / Lam)[:, None] * Bmat
        Bu = torch.einsum('bld,pd->blp', x + 0j, B_bar)
        h = torch.zeros_like(Bu[:, 0, :])
        hs = []
        for t in range(L):
            h = Lam_bar[None, :] * h + Bu[:, t, :]
            hs.append(h)
        hseq = torch.stack(hs, 1)
        y = 2.0 * torch.einsum('blp,dp->bld', hseq, Cmat).real + x * Dskip[None, None, :]
        return y

    def _B_ref(x, mem0, Wq, Wk, Wv, Wo, seg_len):
        B, S, Dm = x.shape
        H, Dh = (Wq.shape[1], Wq.shape[2])
        M = mem0.shape[1]
        scale = Dh ** (-0.5)
        n_seg = S // seg_len
        L = M + seg_len
        idx = torch.arange(L)
        mask = (idx[:, None] < M) | (idx[:, None] >= idx[None, :])
        mem = mem0
        outs = []
        for s in range(n_seg):
            xs = x[:, s * seg_len:(s + 1) * seg_len, :].clone()
            h = torch.concatenate([mem, xs], axis=1)
            q = torch.einsum('btd,dhe->bhte', h, Wq)
            k = torch.einsum('btd,dhe->bhte', h, Wk)
            v = torch.einsum('btd,dhe->bhte', h, Wv)
            scores = torch.einsum('bhqe,bhke->bhqk', q, k) * scale
            scores = torch.where(mask[None, None], scores, -1000000000.0)
            p = _softmax(scores, axis=-1)
            o = torch.einsum('bhqk,bhke->bhqe', p, v)
            o = torch.einsum('bhte,hed->btd', o, Wo)
            mem = o[:, :M, :].clone()
            outs.append(o[:, M:, :])
        return torch.concatenate(outs, axis=1)
    a = _A_ref(A_x, A_Lambda_re, A_Lambda_im, A_B_re, A_B_im, A_C_re, A_C_im, A_log_dt, A_Dskip)
    b = _B_ref(B_x, B_mem0, B_Wq, B_Wk, B_Wv, B_Wo, B_seg_len)
    return torch.concatenate([a, b], axis=-1)
```

```asm
; @launch grid=(256,1,1) block=(256,1,1) lds=163840
.amdgcn_target "amdgcn-amd-amdhsa--gfx950"
.text
.globl concat_heads__ssm_conv_s5__memory_aug_recurrent_mem_tr__prompt_kernel
.p2align 8
.type concat_heads__ssm_conv_s5__memory_aug_recurrent_mem_tr__prompt_kernel,@function
concat_heads__ssm_conv_s5__memory_aug_recurrent_mem_tr__prompt_kernel:
    s_cmp_ge_u32 s2, 256
    s_cbranch_scc1 L_exit
    s_load_dwordx16 s[64:79], s[0:1], 0
    s_load_dwordx16 s[80:95], s[0:1], 64
    s_load_dwordx4 s[96:99], s[0:1], 128
    s_load_dwordx2 s[100:101], s[0:1], 144
    v_lshrrev_b32 v1, 6, v0
    s_and_b32 s30, s2, 7
    s_lshr_b32 s29, s2, 3
    v_readfirstlane_b32 s28, v1
    s_getreg_b32 s31, hwreg(HW_REG_XCC_ID, 0, 4)
    s_and_b32 s31, s31, 7
    s_mov_b32 s43, 0
    s_cmp_lg_u32 s30, 0
    s_cbranch_scc1 L_other
L_chain:
    s_mov_b32 s49, 0x05040100
    s_mov_b32 s50, 0x07060302
    s_mov_b32 s52, 0x3e0293ee
    s_mov_b32 s53, 0x3e0293ee
    s_mov_b32 s54, 0x000f000f
    s_mov_b32 s55, 0x000f000f
    v_and_b32 v100, 63, v0
    v_and_b32 v101, 15, v100
    v_lshrrev_b32 v102, 4, v100
    s_lshl_b32 s32, s29, 8
    v_lshrrev_b32 v104, 3, v100
    v_and_b32 v105, 7, v100
    v_lshlrev_b32 v105, 4, v105
    v_lshl_add_u32 v104, v104, 13, v105
    s_and_b32 s33, s28, 1
    s_lshl_b32 s33, s33, 7
    s_add_u32 s33, s33, s32
    v_add_u32 v92, s33, v104
    s_lshr_b32 s33, s28, 1
    s_lshl_b32 s33, s33, 7
    s_add_u32 s33, s33, s32
    v_add_u32 v93, s33, v104
    v_lshlrev_b32 v104, 10, v102
    v_lshl_add_u32 v104, v101, 4, v104
    s_lshl_b32 s32, s29, 17
    s_lshl_b32 s33, s28, 8
    s_add_u32 s33, s33, s32
    v_add_u32 v94, s33, v104
    s_lshl_b32 s46, s28, 15
    s_lshl_b32 s47, s28, 13
    s_add_u32 s47, s47, 0x20000
    v_lshlrev_b32 v103, 4, v100
    v_add_u32 v122, 0x20000, v103
    v_mov_b32 v72, -1
    v_mov_b32 v73, -1
    v_mov_b32 v74, -1
    v_mov_b32 v75, -1
    v_mov_b32 v76, 0
    v_lshlrev_b32 v77, 2, v100
    s_lshl_b32 s32, s29, 14
    s_lshl_b32 s33, s28, 12
    s_add_u32 s32, s32, s33
    s_add_u32 s33, s32, 0xe0000
    s_add_u32 s34, s32, 0x1e0000
    s_lshl_b32 s42, s43, 16
    s_mov_b32 s40, s33
    s_add_u32 s41, s34, s42
    s_lshr_b32 s32, s32, 1
    s_add_u32 s44, s32, 0x1e0000
    s_add_u32 s44, s44, s42
    s_lshl_b32 s51, s29, 8
    s_add_u32 s63, s51, 0x0
    s_add_u32 s51, s51, 0x4000
    s_waitcnt lgkmcnt(0)
    s_mov_b32 s4, s100
    s_and_b32 s5, s101, 0xffff
    s_mov_b32 s6, 0x10000000
    s_mov_b32 s7, 0x20000
    s_mov_b32 s16, s98
    s_and_b32 s17, s99, 0xffff
    s_mov_b32 s18, 0x100
    s_mov_b32 s19, 0x20000
    s_mov_b32 s20, s90
    s_and_b32 s21, s91, 0xffff
    s_mov_b32 s22, 0x400000
    s_mov_b32 s23, 0x20000
    s_mov_b32 s24, s92
    s_and_b32 s25, s93, 0xffff
    s_mov_b32 s26, 0x400000
    s_mov_b32 s27, 0x20000
    s_mov_b32 s12, s84
    s_and_b32 s13, s85, 0xffff
    s_mov_b32 s14, 0x2000
    s_mov_b32 s15, 0x20000
    s_cmp_lt_u32 s28, 2
    s_cselect_b32 s8, s86, s88
    s_cselect_b32 s9, s87, s89
    s_and_b32 s9, s9, 0xffff
    s_mov_b32 s10, 0x400000
    s_mov_b32 s11, 0x20000
    s_lshl_b32 s59, s28, 20
    s_lshl_b32 s60, s28, 15
    s_cmp_lg_u32 s43, 0
    s_cbranch_scc1 L_nofill_1
    buffer_store_dwordx4 v[72:75], v122, s[4:7], s40 offen offset:0 sc1
    buffer_store_dwordx4 v[72:75], v122, s[4:7], s40 offen offset:1024 sc1
    buffer_store_dwordx4 v[72:75], v122, s[4:7], s40 offen offset:2048 sc1
    buffer_store_dwordx4 v[72:75], v122, s[4:7], s40 offen offset:3072 sc1
L_nofill_1:
    buffer_store_dwordx4 v[72:75], v122, s[4:7], s44 offen offset:0 sc1
    buffer_store_dwordx4 v[72:75], v122, s[4:7], s44 offen offset:1024 sc1
    s_xor_b32 s32, s59, 0x0
    s_add_u32 m0, s46, 0
    s_add_u32 s33, s32, 0
    buffer_load_dwordx4 v93, s[20:23], s33 offen  lds
    s_add_u32 m0, s46, 1024
    s_add_u32 s33, s32, 65536
    buffer_load_dwordx4 v93, s[20:23], s33 offen  lds
    s_add_u32 m0, s46, 2048
    s_add_u32 s33, s32, 131072
    buffer_load_dwordx4 v93, s[20:23], s33 offen  lds
    s_add_u32 m0, s46, 3072
    s_add_u32 s33, s32, 196608
    buffer_load_dwordx4 v93, s[20:23], s33 offen  lds
    s_xor_b32 s32, s59, 0x0
    s_add_u32 m0, s46, 4096
    s_add_u32 s33, s32, 0
    buffer_load_dwordx4 v92, s[8:11], s33 offen  lds
    s_add_u32 m0, s46, 5120
    s_add_u32 s33, s32, 65536
    buffer_load_dwordx4 v92, s[8:11], s33 offen  lds
    s_add_u32 m0, s46, 6144
    s_add_u32 s33, s32, 131072
    buffer_load_dwordx4 v92, s[8:11], s33 offen  lds
    s_add_u32 m0, s46, 7168
    s_add_u32 s33, s32, 196608
    buffer_load_dwordx4 v92, s[8:11], s33 offen  lds
    s_xor_b32 s32, s59, 0x0
    s_add_u32 m0, s46, 8192
    s_add_u32 s33, s32, 262144
    buffer_load_dwordx4 v93, s[20:23], s33 offen  lds
    s_add_u32 m0, s46, 9216
    s_add_u32 s33, s32, 327680
    buffer_load_dwordx4 v93, s[20:23], s33 offen  lds
    s_add_u32 m0, s46, 10240
    s_add_u32 s33, s32, 393216
    buffer_load_dwordx4 v93, s[20:23], s33 offen  lds
    s_add_u32 m0, s46, 11264
    s_add_u32 s33, s32, 458752
    buffer_load_dwordx4 v93, s[20:23], s33 offen  lds
    s_xor_b32 s32, s59, 0x0
    s_add_u32 m0, s46, 12288
    s_add_u32 s33, s32, 262144
    buffer_load_dwordx4 v92, s[8:11], s33 offen  lds
    s_add_u32 m0, s46, 13312
    s_add_u32 s33, s32, 327680
    buffer_load_dwordx4 v92, s[8:11], s33 offen  lds
    s_add_u32 m0, s46, 14336
    s_add_u32 s33, s32, 393216
    buffer_load_dwordx4 v92, s[8:11], s33 offen  lds
    s_add_u32 m0, s46, 15360
    s_add_u32 s33, s32, 458752
    buffer_load_dwordx4 v92, s[8:11], s33 offen  lds
    s_xor_b32 s32, s59, 0x80000
    s_add_u32 m0, s46, 16384
    s_add_u32 s33, s32, 0
    buffer_load_dwordx4 v93, s[20:23], s33 offen  lds
    s_add_u32 m0, s46, 17408
    s_add_u32 s33, s32, 65536
    buffer_load_dwordx4 v93, s[20:23], s33 offen  lds
    s_add_u32 m0, s46, 18432
    s_add_u32 s33, s32, 131072
    buffer_load_dwordx4 v93, s[20:23], s33 offen  lds
    s_add_u32 m0, s46, 19456
    s_add_u32 s33, s32, 196608
    buffer_load_dwordx4 v93, s[20:23], s33 offen  lds
    s_xor_b32 s32, s59, 0x80000
    s_add_u32 m0, s46, 20480
    s_add_u32 s33, s32, 0
    buffer_load_dwordx4 v92, s[8:11], s33 offen  lds
    s_add_u32 m0, s46, 21504
    s_add_u32 s33, s32, 65536
    buffer_load_dwordx4 v92, s[8:11], s33 offen  lds
    s_add_u32 m0, s46, 22528
    s_add_u32 s33, s32, 131072
    buffer_load_dwordx4 v92, s[8:11], s33 offen  lds
    s_add_u32 m0, s46, 23552
    s_add_u32 s33, s32, 196608
    buffer_load_dwordx4 v92, s[8:11], s33 offen  lds
    s_xor_b32 s32, s59, 0x80000
    s_add_u32 m0, s46, 24576
    s_add_u32 s33, s32, 262144
    buffer_load_dwordx4 v93, s[20:23], s33 offen  lds
    s_add_u32 m0, s46, 25600
    s_add_u32 s33, s32, 327680
    buffer_load_dwordx4 v93, s[20:23], s33 offen  lds
    s_add_u32 m0, s46, 26624
    s_add_u32 s33, s32, 393216
    buffer_load_dwordx4 v93, s[20:23], s33 offen  lds
    s_add_u32 m0, s46, 27648
    s_add_u32 s33, s32, 458752
    buffer_load_dwordx4 v93, s[20:23], s33 offen  lds
    s_xor_b32 s32, s59, 0x80000
    s_add_u32 m0, s46, 28672
    s_add_u32 s33, s32, 262144
    buffer_load_dwordx4 v92, s[8:11], s33 offen  lds
    s_add_u32 m0, s46, 29696
    s_add_u32 s33, s32, 327680
    buffer_load_dwordx4 v92, s[8:11], s33 offen  lds
    s_add_u32 m0, s46, 30720
    s_add_u32 s33, s32, 393216
    buffer_load_dwordx4 v92, s[8:11], s33 offen  lds
    s_add_u32 m0, s46, 31744
    s_add_u32 s33, s32, 458752
    buffer_load_dwordx4 v92, s[8:11], s33 offen  lds
    s_xor_b32 s32, s59, 0x200000
    s_add_u32 m0, s47, 0
    s_add_u32 s33, s32, 0
    buffer_load_dwordx4 v93, s[20:23], s33 offen  lds
    s_add_u32 m0, s47, 1024
    s_add_u32 s33, s32, 65536
    buffer_load_dwordx4 v93, s[20:23], s33 offen  lds
    s_add_u32 m0, s47, 2048
    s_add_u32 s33, s32, 131072
    buffer_load_dwordx4 v93, s[20:23], s33 offen  lds
    s_add_u32 m0, s47, 3072
    s_add_u32 s33, s32, 196608
    buffer_load_dwordx4 v93, s[20:23], s33 offen  lds
    s_xor_b32 s32, s59, 0x180000
    s_add_u32 m0, s47, 4096
    s_add_u32 s33, s32, 0
    buffer_load_dwordx4 v92, s[8:11], s33 offen  lds
    s_add_u32 m0, s47, 5120
    s_add_u32 s33, s32, 65536
    buffer_load_dwordx4 v92, s[8:11], s33 offen  lds
    s_add_u32 m0, s47, 6144
    s_add_u32 s33, s32, 131072
    buffer_load_dwordx4 v92, s[8:11], s33 offen  lds
    s_add_u32 m0, s47, 7168
    s_add_u32 s33, s32, 196608
    buffer_load_dwordx4 v92, s[8:11], s33 offen  lds
    v_lshlrev_b32 v103, 4, v100
    s_lshl_b32 s32, s28, 15
    v_add_u32 v120, s32, v103
    s_lshl_b32 s32, s28, 11
    s_add_u32 s32, s32, 0x24000
    v_add_u32 v121, s32, v103
    v_add_u32 v122, 0x20000, v103
    v_mov_b32 v123, v122
    s_lshr_b32 s32, s28, 1
    s_lshl_b32 s32, s32, 11
    s_and_b32 s33, s28, 1
    s_lshl_b32 s33, s33, 10
    s_add_u32 s32, s32, s33
    s_add_u32 s32, s32, 0x26000
    v_lshrrev_b32 v104, 1, v101
    v_lshlrev_b32 v105, 7, v104
    v_add_u32 v124, s32, v105
    v_lshlrev_b32 v105, 1, v102
    v_xor_b32 v105, v105, v104
    v_lshlrev_b32 v105, 4, v105
    v_add_u32 v124, v124, v105
    v_and_b32 v105, 1, v101
    v_lshlrev_b32 v105, 3, v105
    v_add_u32 v124, v124, v105
    v_lshrrev_b32 v104, 2, v101
    v_lshlrev_b32 v104, 1, v104
    v_and_b32 v105, 1, v101
    v_add_u32 v104, v104, v105
    v_xor_b32 v105, v104, v102
    v_lshlrev_b32 v105, 4, v105
    v_lshl_add_u32 v105, v102, 7, v105
    v_add_u32 v125, 0x26000, v105
    v_xor_b32 v126, 576, v125
    s_lshl_b32 s32, s28, 9
    s_add_u32 s32, s32, 0x27000
    v_lshlrev_b32 v105, 4, v104
    v_lshl_add_u32 v105, v102, 7, v105
    v_add_u32 v127, s32, v105
    v_lshrrev_b32 v104, 2, v101
    v_lshlrev_b32 v105, 14, v104
    v_lshl_add_u32 v105, v102, 11, v105
    v_lshl_add_u32 v104, v104, 2, v102
    v_mul_u32_u24 v104, 2, v104
    v_add_u32 v104, s29, v104
    v_and_b32 v104, 31, v104
    v_lshl_add_u32 v105, v104, 6, v105
    v_and_b32 v104, 3, v101
    v_lshl_add_u32 v105, v104, 4, v105
    s_lshl_b32 s32, s28, 16
    v_add_u32 v0, s32, v105
    v_and_b32 v104, 3, v100
    v_lshlrev_b32 v104, 2, v104
    v_lshl_add_u32 v1, v102, 4, v104
    v_and_b32 v104, 3, v101
    v_lshrrev_b32 v105, 2, v101
    v_lshl_add_u32 v104, v104, 2, v105
    v_and_b32 v105, 1, v104
    v_lshlrev_b32 v105, 4, v105
    v_mov_b32 v106, 0x3f80
    v_lshlrev_b32 v105, v105, v106
    v_lshrrev_b32 v104, 1, v104
    v_cmp_eq_u32 vcc, 0, v104
    s_nop 1
    v_cndmask_b32 v80, 0, v105, vcc
    v_cmp_eq_u32 vcc, 1, v104
    s_nop 1
    v_cndmask_b32 v81, 0, v105, vcc
    v_cmp_eq_u32 vcc, 2, v104
    s_nop 1
    v_cndmask_b32 v82, 0, v105, vcc
    v_cmp_eq_u32 vcc, 3, v104
    s_nop 1
    v_cndmask_b32 v83, 0, v105, vcc
    v_and_b32 v104, 2, v100
    v_cmp_ne_u32 vcc, 0, v104
    v_mov_b32 v104, 0x44444444
    v_mov_b32 v105, 0xeeeeeeee
    v_cndmask_b32 v3, v104, v105, vcc
    v_and_b32 v104, 1, v102
    v_lshrrev_b32 v105, 1, v102
    v_lshlrev_b32 v106, 4, v104
    v_lshl_add_u32 v106, v105, 1, v106
    v_lshlrev_b32 v107, 3, v101
    v_lshl_add_u32 v107, v106, 7, v107
    v_add_u32 v86, s46, v107
    v_add_u32 v87, s47, v107
    v_lshlrev_b32 v107, 2, v101
    v_lshl_add_u32 v107, v106, 7, v107
    s_and_b32 s33, s28, 1
    s_lshl_b32 s33, s33, 6
    v_add_u32 v107, s33, v107
    v_add_u32 v88, s46, v107
    v_add_u32 v89, s47, v107
    v_xor_b32 v84, 0x8000, v88
    v_xor_b32 v85, 0x2000, v89
    v_lshlrev_b32 v106, 2, v104
    v_lshl_add_u32 v106, v105, 3, v106
    v_lshlrev_b32 v107, 4, v101
    v_lshl_add_u32 v107, v106, 8, v107
    v_add_u32 v90, s46, v107
    v_add_u32 v91, s47, v107
    v_and_b32 v104, 1, v102
    v_lshlrev_b32 v104, 10, v104
    v_lshl_add_u32 v104, v105, 1, v104
    v_and_b32 v105, 3, v100
    v_lshl_add_u32 v104, v105, 4, v104
    s_lshl_b32 s32, s28, 11
    s_lshr_b32 s33, s29, 1
    s_lshl_b32 s33, s33, 6
    s_add_u32 s32, s32, s33
    s_and_b32 s33, s29, 1
    s_lshl_b32 s33, s33, 2
    s_add_u32 s32, s32, s33
    v_add_u32 v95, s32, v104
    s_getpc_b64 s[34:35]
L_pc_here:
    s_add_u32 s34, s34, L_chain_loops - L_pc_here
    s_addc_u32 s35, s35, 0
    s_lshl_b32 s32, s28, 12
    v_lshl_add_u32 v78, v77, 4, s32
    global_load_dword v79, v78, s[34:35]
    s_waitcnt vmcnt(41)
    s_barrier
    s_cmp_lg_u32 s28, 0
    s_cbranch_scc1 L_arr_2
    s_mul_i32 s32, s31, 6
    s_lshl_b64 s[34:35], 1, s32
    s_or_b32 s35, s35, 0x01000000
    s_lshl_b32 s32, s43, 3
    v_mov_b32 v100, s34
    v_mov_b32 v101, s35
    v_mov_b32 v102, s32
    s_mov_b64 s[36:37], exec
    s_mov_b64 exec, 1
    buffer_atomic_add_x2 v[100:101], v102, s[16:19], 0 offen offset:128
    s_mov_b64 exec, s[36:37]
L_arr_2:
    s_waitcnt vmcnt(37)
    s_barrier
    ds_read_b32 v104, v88 offset:512
    ds_read_b32 v105, v88 offset:0
    ds_read_b32 v106, v88 offset:640
    ds_read_b32 v107, v88 offset:128
    ds_read_b32 v108, v88 offset:1536
    ds_read_b32 v109, v88 offset:1024
    ds_read_b32 v110, v88 offset:1664
    ds_read_b32 v111, v88 offset:1152
    ds_read_b32 v112, v84 offset:512
    ds_read_b32 v113, v84 offset:0
    ds_read_b32 v114, v84 offset:640
    ds_read_b32 v115, v84 offset:128
    ds_read_b32 v116, v84 offset:1536
    ds_read_b32 v117, v84 offset:1024
    ds_read_b32 v118, v84 offset:1664
    ds_read_b32 v119, v84 offset:1152
    s_waitcnt lgkmcnt(8)
    v_perm_b32 v128, v105, v104, s49
    v_perm_b32 v136, v105, v104, s50
    v_perm_b32 v129, v107, v106, s49
    v_perm_b32 v137, v107, v106, s50
    v_perm_b32 v130, v109, v108, s49
    v_perm_b32 v138, v109, v108, s50
    v_perm_b32 v131, v111, v110, s49
    v_perm_b32 v139, v111, v110, s50
    s_waitcnt lgkmcnt(0)
    v_perm_b32 v160, v113, v112, s49
    v_perm_b32 v168, v113, v112, s50
    v_perm_b32 v161, v115, v114, s49
    v_perm_b32 v169, v115, v114, s50
    v_perm_b32 v162, v117, v116, s49
    v_perm_b32 v170, v117, v116, s50
    v_perm_b32 v163, v119, v118, s49
    v_perm_b32 v171, v119, v118, s50
    s_waitcnt vmcnt(33)
    ds_read_b64 v[104:105], v86 offset:4608
    ds_read_b64 v[106:107], v86 offset:4096
    ds_read_b64 v[108:109], v86 offset:4736
    ds_read_b64 v[110:111], v86 offset:4224
    ds_read_b64 v[112:113], v86 offset:5632
    ds_read_b64 v[114:115], v86 offset:5120
    ds_read_b64 v[116:117], v86 offset:5760
    ds_read_b64 v[118:119], v86 offset:5248
    s_waitcnt lgkmcnt(6)
    v_perm_b32 v96, v106, v104, s49
    v_perm_b32 v97, v106, v104, s50
    v_perm_b32 v98, v107, v105, s49
    v_perm_b32 v99, v107, v105, s50
    v_accvgpr_write_b32 a0, v96
    v_accvgpr_write_b32 a8, v97
    v_accvgpr_write_b32 a16, v98
    v_accvgpr_write_b32 a24, v99
    s_waitcnt lgkmcnt(4)
    v_perm_b32 v96, v110, v108, s49
    v_perm_b32 v97, v110, v108, s50
    v_perm_b32 v98, v111, v109, s49
    v_perm_b32 v99, v111, v109, s50
    v_accvgpr_write_b32 a1, v96
    v_accvgpr_write_b32 a9, v97
    v_accvgpr_write_b32 a17, v98
    v_accvgpr_write_b32 a25, v99
    s_waitcnt lgkmcnt(2)
    v_perm_b32 v96, v114, v112, s49
    v_perm_b32 v97, v114, v112, s50
    v_perm_b32 v98, v115, v113, s49
    v_perm_b32 v99, v115, v113, s50
    v_accvgpr_write_b32 a2, v96
    v_accvgpr_write_b32 a10, v97
    v_accvgpr_write_b32 a18, v98
    v_accvgpr_write_b32 a26, v99
    s_waitcnt lgkmcnt(0)
    v_perm_b32 v96, v118, v116, s49
    v_perm_b32 v97, v118, v116, s50
    v_perm_b32 v98, v119, v117, s49
    v_perm_b32 v99, v119, v117, s50
    v_accvgpr_write_b32 a3, v96
    v_accvgpr_write_b32 a11, v97
    v_accvgpr_write_b32 a19, v98
    v_accvgpr_write_b32 a27, v99
    s_xor_b32 s32, s59, 0x200000
    s_add_u32 m0, s46, 4096
    s_add_u32 s33, s32, 262144
    buffer_load_dwordx4 v93, s[20:23], s33 offen  lds
    s_add_u32 m0, s46, 5120
    s_add_u32 s33, s32, 327680
    buffer_load_dwordx4 v93, s[20:23], s33 offen  lds
    s_add_u32 m0, s46, 6144
    s_add_u32 s33, s32, 393216
    buffer_load_dwordx4 v93, s[20:23], s33 offen  lds
    s_add_u32 m0, s46, 7168
    s_add_u32 s33, s32, 458752
    buffer_load_dwordx4 v93, s[20:23], s33 offen  lds
    s_waitcnt vmcnt(33)
    s_barrier
    ds_read_b32 v104, v88 offset:8704
    ds_read_b32 v105, v88 offset:8192
    ds_read_b32 v106, v88 offset:8832
    ds_read_b32 v107, v88 offset:8320
    ds_read_b32 v108, v88 offset:9728
    ds_read_b32 v109, v88 offset:9216
    ds_read_b32 v110, v88 offset:9856
    ds_read_b32 v111, v88 offset:9344
    ds_read_b32 v112, v84 offset:8704
    ds_read_b32 v113, v84 offset:8192
    ds_read_b32 v114, v84 offset:8832
    ds_read_b32 v115, v84 offset:8320
    ds_read_b32 v116, v84 offset:9728
    ds_read_b32 v117, v84 offset:9216
    ds_read_b32 v118, v84 offset:9856
    ds_read_b32 v119, v84 offset:9344
    s_waitcnt lgkmcnt(8)
    v_perm_b32 v132, v105, v104, s49
    v_perm_b32 v140, v105, v104, s50
    v_perm_b32 v133, v107, v106, s49
    v_perm_b32 v141, v107, v106, s50
    v_perm_b32 v134, v109, v108, s49
    v_perm_b32 v142, v109, v108, s50
    v_perm_b32 v135, v111, v110, s49
    v_perm_b32 v143, v111, v110, s50
    s_waitcnt lgkmcnt(0)
    v_perm_b32 v164, v113, v112, s49
    v_perm_b32 v172, v113, v112, s50
    v_perm_b32 v165, v115, v114, s49
    v_perm_b32 v173, v115, v114, s50
    v_perm_b32 v166, v117, v116, s49
    v_perm_b32 v174, v117, v116, s50
    v_perm_b32 v167, v119, v118, s49
    v_perm_b32 v175, v119, v118, s50
    s_xor_b32 s32, s59, 0x180000
    s_add_u32 m0, s46, 0
    s_add_u32 s33, s32, 262144
    buffer_load_dwordx4 v92, s[8:11], s33 offen  lds
    s_add_u32 m0, s46, 1024
    s_add_u32 s33, s32, 327680
    buffer_load_dwordx4 v92, s[8:11], s33 offen  lds
    s_add_u32 m0, s46, 2048
    s_add_u32 s33, s32, 393216
    buffer_load_dwordx4 v92, s[8:11], s33 offen  lds
    s_add_u32 m0, s46, 3072
    s_add_u32 s33, s32, 458752
    buffer_load_dwordx4 v92, s[8:11], s33 offen  lds
    s_waitcnt vmcnt(33)
    ds_read_b64 v[104:105], v86 offset:12800
    ds_read_b64 v[106:107], v86 offset:12288
    ds_read_b64 v[108:109], v86 offset:12928
    ds_read_b64 v[110:111], v86 offset:12416
    ds_read_b64 v[112:113], v86 offset:13824
    ds_read_b64 v[114:115], v86 offset:13312
    ds_read_b64 v[116:117], v86 offset:13952
    ds_read_b64 v[118:119], v86 offset:13440
    s_waitcnt lgkmcnt(6)
    v_perm_b32 v96, v106, v104, s49
    v_perm_b32 v97, v106, v104, s50
    v_perm_b32 v98, v107, v105, s49
    v_perm_b32 v99, v107, v105, s50
    v_accvgpr_write_b32 a4, v96
    v_accvgpr_write_b32 a12, v97
    v_accvgpr_write_b32 a20, v98
    v_accvgpr_write_b32 a28, v99
    s_waitcnt lgkmcnt(4)
    v_perm_b32 v96, v110, v108, s49
    v_perm_b32 v97, v110, v108, s50
    v_perm_b32 v98, v111, v109, s49
    v_perm_b32 v99, v111, v109, s50
    v_accvgpr_write_b32 a5, v96
    v_accvgpr_write_b32 a13, v97
    v_accvgpr_write_b32 a21, v98
    v_accvgpr_write_b32 a29, v99
    s_waitcnt lgkmcnt(2)
    v_perm_b32 v96, v114, v112, s49
    v_perm_b32 v97, v114, v112, s50
    v_perm_b32 v98, v115, v113, s49
    v_perm_b32 v99, v115, v113, s50
    v_accvgpr_write_b32 a6, v96
    v_accvgpr_write_b32 a14, v97
    v_accvgpr_write_b32 a22, v98
    v_accvgpr_write_b32 a30, v99
    s_waitcnt lgkmcnt(0)
    v_perm_b32 v96, v118, v116, s49
    v_perm_b32 v97, v118, v116, s50
    v_perm_b32 v98, v119, v117, s49
    v_perm_b32 v99, v119, v117, s50
    v_accvgpr_write_b32 a7, v96
    v_accvgpr_write_b32 a15, v97
    v_accvgpr_write_b32 a23, v98
    v_accvgpr_write_b32 a31, v99
    s_xor_b32 s32, s59, 0x280000
    s_add_u32 m0, s46, 12288
    s_add_u32 s33, s32, 0
    buffer_load_dwordx4 v93, s[20:23], s33 offen  lds
    s_add_u32 m0, s46, 13312
    s_add_u32 s33, s32, 65536
    buffer_load_dwordx4 v93, s[20:23], s33 offen  lds
    s_add_u32 m0, s46, 14336
    s_add_u32 s33, s32, 131072
    buffer_load_dwordx4 v93, s[20:23], s33 offen  lds
    s_add_u32 m0, s46, 15360
    s_add_u32 s33, s32, 196608
    buffer_load_dwordx4 v93, s[20:23], s33 offen  lds
    s_waitcnt vmcnt(33)
    s_barrier
    ds_read_b32 v104, v88 offset:16896
    ds_read_b32 v105, v88 offset:16384
    ds_read_b32 v106, v88 offset:17024
    ds_read_b32 v107, v88 offset:16512
    ds_read_b32 v108, v88 offset:17920
    ds_read_b32 v109, v88 offset:17408
    ds_read_b32 v110, v88 offset:18048
    ds_read_b32 v111, v88 offset:17536
    ds_read_b32 v112, v84 offset:16896
    ds_read_b32 v113, v84 offset:16384
    ds_read_b32 v114, v84 offset:17024
    ds_read_b32 v115, v84 offset:16512
    ds_read_b32 v116, v84 offset:17920
    ds_read_b32 v117, v84 offset:17408
    ds_read_b32 v118, v84 offset:18048
    ds_read_b32 v119, v84 offset:17536
    s_waitcnt lgkmcnt(8)
    v_perm_b32 v144, v105, v104, s49
    v_perm_b32 v152, v105, v104, s50
    v_perm_b32 v145, v107, v106, s49
    v_perm_b32 v153, v107, v106, s50
    v_perm_b32 v146, v109, v108, s49
    v_perm_b32 v154, v109, v108, s50
    v_perm_b32 v147, v111, v110, s49
    v_perm_b32 v155, v111, v110, s50
    s_waitcnt lgkmcnt(0)
    v_perm_b32 v176, v113, v112, s49
    v_perm_b32 v184, v113, v112, s50
    v_perm_b32 v177, v115, v114, s49
    v_perm_b32 v185, v115, v114, s50
    v_perm_b32 v178, v117, v116, s49
    v_perm_b32 v186, v117, v116, s50
    v_perm_b32 v179, v119, v118, s49
    v_perm_b32 v187, v119, v118, s50
    s_xor_b32 s32, s59, 0x200000
    s_add_u32 m0, s46, 8192
    s_add_u32 s33, s32, 0
    buffer_load_dwordx4 v92, s[8:11], s33 offen  lds
    s_add_u32 m0, s46, 9216
    s_add_u32 s33, s32, 65536
    buffer_load_dwordx4 v92, s[8:11], s33 offen  lds
    s_add_u32 m0, s46, 10240
    s_add_u32 s33, s32, 131072
    buffer_load_dwordx4 v92, s[8:11], s33 offen  lds
    s_add_u32 m0, s46, 11264
    s_add_u32 s33, s32, 196608
    buffer_load_dwordx4 v92, s[8:11], s33 offen  lds
    s_waitcnt vmcnt(33)
    ds_read_b64 v[104:105], v86 offset:20992
    ds_read_b64 v[106:107], v86 offset:20480
    ds_read_b64 v[108:109], v86 offset:21120
    ds_read_b64 v[110:111], v86 offset:20608
    ds_read_b64 v[112:113], v86 offset:22016
    ds_read_b64 v[114:115], v86 offset:21504
    ds_read_b64 v[116:117], v86 offset:22144
    ds_read_b64 v[118:119], v86 offset:21632
    s_waitcnt lgkmcnt(6)
    v_perm_b32 v96, v106, v104, s49
    v_perm_b32 v97, v106, v104, s50
    v_perm_b32 v98, v107, v105, s49
    v_perm_b32 v99, v107, v105, s50
    v_accvgpr_write_b32 a32, v96
    v_accvgpr_write_b32 a40, v97
    v_accvgpr_write_b32 a48, v98
    v_accvgpr_write_b32 a56, v99
    s_waitcnt lgkmcnt(4)
    v_perm_b32 v96, v110, v108, s49
    v_perm_b32 v97, v110, v108, s50
    v_perm_b32 v98, v111, v109, s49
    v_perm_b32 v99, v111, v109, s50
    v_accvgpr_write_b32 a33, v96
    v_accvgpr_write_b32 a41, v97
    v_accvgpr_write_b32 a49, v98
    v_accvgpr_write_b32 a57, v99
    s_waitcnt lgkmcnt(2)
    v_perm_b32 v96, v114, v112, s49
    v_perm_b32 v97, v114, v112, s50
    v_perm_b32 v98, v115, v113, s49
    v_perm_b32 v99, v115, v113, s50
    v_accvgpr_write_b32 a34, v96
    v_accvgpr_write_b32 a42, v97
    v_accvgpr_write_b32 a50, v98
    v_accvgpr_write_b32 a58, v99
    s_waitcnt lgkmcnt(0)
    v_perm_b32 v96, v118, v116, s49
    v_perm_b32 v97, v118, v116, s50
    v_perm_b32 v98, v119, v117, s49
    v_perm_b32 v99, v119, v117, s50
    v_accvgpr_write_b32 a35, v96
    v_accvgpr_write_b32 a43, v97
    v_accvgpr_write_b32 a51, v98
    v_accvgpr_write_b32 a59, v99
    s_xor_b32 s32, s59, 0x280000
    s_add_u32 m0, s46, 20480
    s_add_u32 s33, s32, 262144
    buffer_load_dwordx4 v93, s[20:23], s33 offen  lds
    s_add_u32 m0, s46, 21504
    s_add_u32 s33, s32, 327680
    buffer_load_dwordx4 v93, s[20:23], s33 offen  lds
    s_add_u32 m0, s46, 22528
    s_add_u32 s33, s32, 393216
    buffer_load_dwordx4 v93, s[20:23], s33 offen  lds
    s_add_u32 m0, s46, 23552
    s_add_u32 s33, s32, 458752
    buffer_load_dwordx4 v93, s[20:23], s33 offen  lds
    s_waitcnt vmcnt(33)
    s_barrier
    ds_read_b32 v104, v88 offset:25088
    ds_read_b32 v105, v88 offset:24576
    ds_read_b32 v106, v88 offset:25216
    ds_read_b32 v107, v88 offset:24704
    ds_read_b32 v108, v88 offset:26112
    ds_read_b32 v109, v88 offset:25600
    ds_read_b32 v110, v88 offset:26240
    ds_read_b32 v111, v88 offset:25728
    ds_read_b32 v112, v84 offset:25088
    ds_read_b32 v113, v84 offset:24576
    ds_read_b32 v114, v84 offset:25216
    ds_read_b32 v115, v84 offset:24704
    ds_read_b32 v116, v84 offset:26112
    ds_read_b32 v117, v84 offset:25600
    ds_read_b32 v118, v84 offset:26240
    ds_read_b32 v119, v84 offset:25728
    s_waitcnt lgkmcnt(8)
    v_perm_b32 v148, v105, v104, s49
    v_perm_b32 v156, v105, v104, s50
    v_perm_b32 v149, v107, v106, s49
    v_perm_b32 v157, v107, v106, s50
    v_perm_b32 v150, v109, v108, s49
    v_perm_b32 v158, v109, v108, s50
    v_perm_b32 v151, v111, v110, s49
    v_perm_b32 v159, v111, v110, s50
    s_waitcnt lgkmcnt(0)
    v_perm_b32 v180, v113, v112, s49
    v_perm_b32 v188, v113, v112, s50
    v_perm_b32 v181, v115, v114, s49
    v_perm_b32 v189, v115, v114, s50
    v_perm_b32 v182, v117, v116, s49
    v_perm_b32 v190, v117, v116, s50
    v_perm_b32 v183, v119, v118, s49
    v_perm_b32 v191, v119, v118, s50
    s_xor_b32 s32, s59, 0x200000
    s_add_u32 m0, s46, 16384
    s_add_u32 s33, s32, 262144
    buffer_load_dwordx4 v92, s[8:11], s33 offen  lds
    s_add_u32 m0, s46, 17408
    s_add_u32 s33, s32, 327680
    buffer_load_dwordx4 v92, s[8:11], s33 offen  lds
    s_add_u32 m0, s46, 18432
    s_add_u32 s33, s32, 393216
    buffer_load_dwordx4 v92, s[8:11], s33 offen  lds
    s_add_u32 m0, s46, 19456
    s_add_u32 s33, s32, 458752
    buffer_load_dwordx4 v92, s[8:11], s33 offen  lds
    s_waitcnt vmcnt(33)
    ds_read_b64 v[104:105], v86 offset:29184
    ds_read_b64 v[106:107], v86 offset:28672
    ds_read_b64 v[108:109], v86 offset:29312
    ds_read_b64 v[110:111], v86 offset:28800
    ds_read_b64 v[112:113], v86 offset:30208
    ds_read_b64 v[114:115], v86 offset:29696
    ds_read_b64 v[116:117], v86 offset:30336
    ds_read_b64 v[118:119], v86 offset:29824
    s_waitcnt lgkmcnt(6)
    v_perm_b32 v96, v106, v104, s49
    v_perm_b32 v97, v106, v104, s50
    v_perm_b32 v98, v107, v105, s49
    v_perm_b32 v99, v107, v105, s50
    v_accvgpr_write_b32 a36, v96
    v_accvgpr_write_b32 a44, v97
    v_accvgpr_write_b32 a52, v98
    v_accvgpr_write_b32 a60, v99
    s_waitcnt lgkmcnt(4)
    v_perm_b32 v96, v110, v108, s49
    v_perm_b32 v97, v110, v108, s50
    v_perm_b32 v98, v111, v109, s49
    v_perm_b32 v99, v111, v109, s50
    v_accvgpr_write_b32 a37, v96
    v_accvgpr_write_b32 a45, v97
    v_accvgpr_write_b32 a53, v98
    v_accvgpr_write_b32 a61, v99
    s_waitcnt lgkmcnt(2)
    v_perm_b32 v96, v114, v112, s49
    v_perm_b32 v97, v114, v112, s50
    v_perm_b32 v98, v115, v113, s49
    v_perm_b32 v99, v115, v113, s50
    v_accvgpr_write_b32 a38, v96
    v_accvgpr_write_b32 a46, v97
    v_accvgpr_write_b32 a54, v98
    v_accvgpr_write_b32 a62, v99
    s_waitcnt lgkmcnt(0)
    v_perm_b32 v96, v118, v116, s49
    v_perm_b32 v97, v118, v116, s50
    v_perm_b32 v98, v119, v117, s49
    v_perm_b32 v99, v119, v117, s50
    v_accvgpr_write_b32 a39, v96
    v_accvgpr_write_b32 a47, v97
    v_accvgpr_write_b32 a55, v98
    v_accvgpr_write_b32 a63, v99
    s_xor_b32 s32, s59, 0x280000
    s_add_u32 m0, s46, 28672
    s_add_u32 s33, s32, 0
    buffer_load_dwordx4 v92, s[8:11], s33 offen  lds
    s_add_u32 m0, s46, 29696
    s_add_u32 s33, s32, 65536
    buffer_load_dwordx4 v92, s[8:11], s33 offen  lds
    s_add_u32 m0, s46, 30720
    s_add_u32 s33, s32, 131072
    buffer_load_dwordx4 v92, s[8:11], s33 offen  lds
    s_add_u32 m0, s46, 31744
    s_add_u32 s33, s32, 196608
    buffer_load_dwordx4 v92, s[8:11], s33 offen  lds
    s_waitcnt vmcnt(33)
    s_barrier
    ds_read_b32 v104, v89 offset:512
    ds_read_b32 v105, v89 offset:0
    ds_read_b32 v106, v89 offset:640
    ds_read_b32 v107, v89 offset:128
    ds_read_b32 v108, v89 offset:1536
    ds_read_b32 v109, v89 offset:1024
    ds_read_b32 v110, v89 offset:1664
    ds_read_b32 v111, v89 offset:1152
    ds_read_b32 v112, v85 offset:512
    ds_read_b32 v113, v85 offset:0
    ds_read_b32 v114, v85 offset:640
    ds_read_b32 v115, v85 offset:128
    ds_read_b32 v116, v85 offset:1536
    ds_read_b32 v117, v85 offset:1024
    ds_read_b32 v118, v85 offset:1664
    ds_read_b32 v119, v85 offset:1152
    s_waitcnt lgkmcnt(8)
    v_perm_b32 v192, v105, v104, s49
    v_perm_b32 v200, v105, v104, s50
    v_perm_b32 v193, v107, v106, s49
    v_perm_b32 v201, v107, v106, s50
    v_perm_b32 v194, v109, v108, s49
    v_perm_b32 v202, v109, v108, s50
    v_perm_b32 v195, v111, v110, s49
    v_perm_b32 v203, v111, v110, s50
    s_waitcnt lgkmcnt(0)
    v_perm_b32 v224, v113, v112, s49
    v_perm_b32 v232, v113, v112, s50
    v_perm_b32 v225, v115, v114, s49
    v_perm_b32 v233, v115, v114, s50
    v_perm_b32 v226, v117, v116, s49
    v_perm_b32 v234, v117, v116, s50
    v_perm_b32 v227, v119, v118, s49
    v_perm_b32 v235, v119, v118, s50
    s_xor_b32 s32, s59, 0x280000
    s_add_u32 m0, s46, 24576
    s_add_u32 s33, s32, 262144
    buffer_load_dwordx4 v92, s[8:11], s33 offen  lds
    s_add_u32 m0, s46, 25600
    s_add_u32 s33, s32, 327680
    buffer_load_dwordx4 v92, s[8:11], s33 offen  lds
    s_add_u32 m0, s46, 26624
    s_add_u32 s33, s32, 393216
    buffer_load_dwordx4 v92, s[8:11], s33 offen  lds
    s_add_u32 m0, s46, 27648
    s_add_u32 s33, s32, 458752
    buffer_load_dwordx4 v92, s[8:11], s33 offen  lds
    s_waitcnt vmcnt(33)
    ds_read_b64 v[104:105], v87 offset:4608
    ds_read_b64 v[106:107], v87 offset:4096
    ds_read_b64 v[108:109], v87 offset:4736
    ds_read_b64 v[110:111], v87 offset:4224
    ds_read_b64 v[112:113], v87 offset:5632
    ds_read_b64 v[114:115], v87 offset:5120
    ds_read_b64 v[116:117], v87 offset:5760
    ds_read_b64 v[118:119], v87 offset:5248
    s_waitcnt lgkmcnt(6)
    v_perm_b32 v96, v106, v104, s49
    v_perm_b32 v97, v106, v104, s50
    v_perm_b32 v98, v107, v105, s49
    v_perm_b32 v99, v107, v105, s50
    v_accvgpr_write_b32 a64, v96
    v_accvgpr_write_b32 a72, v97
    v_accvgpr_write_b32 a80, v98
    v_accvgpr_write_b32 a88, v99
    s_waitcnt lgkmcnt(4)
    v_perm_b32 v96, v110, v108, s49
    v_perm_b32 v97, v110, v108, s50
    v_perm_b32 v98, v111, v109, s49
    v_perm_b32 v99, v111, v109, s50
    v_accvgpr_write_b32 a65, v96
    v_accvgpr_write_b32 a73, v97
    v_accvgpr_write_b32 a81, v98
    v_accvgpr_write_b32 a89, v99
    s_waitcnt lgkmcnt(2)
    v_perm_b32 v96, v114, v112, s49
    v_perm_b32 v97, v114, v112, s50
    v_perm_b32 v98, v115, v113, s49
    v_perm_b32 v99, v115, v113, s50
    v_accvgpr_write_b32 a66, v96
    v_accvgpr_write_b32 a74, v97
    v_accvgpr_write_b32 a82, v98
    v_accvgpr_write_b32 a90, v99
    s_waitcnt lgkmcnt(0)
    v_perm_b32 v96, v118, v116, s49
    v_perm_b32 v97, v118, v116, s50
    v_perm_b32 v98, v119, v117, s49
    v_perm_b32 v99, v119, v117, s50
    v_accvgpr_write_b32 a67, v96
    v_accvgpr_write_b32 a75, v97
    v_accvgpr_write_b32 a83, v98
    v_accvgpr_write_b32 a91, v99
    s_xor_b32 s32, s59, 0x380000
    s_add_u32 m0, s47, 4096
    s_add_u32 s33, s32, 0
    buffer_load_dwordx4 v92, s[8:11], s33 offen  lds
    s_add_u32 m0, s47, 5120
    s_add_u32 s33, s32, 65536
    buffer_load_dwordx4 v92, s[8:11], s33 offen  lds
    s_add_u32 m0, s47, 6144
    s_add_u32 s33, s32, 131072
    buffer_load_dwordx4 v92, s[8:11], s33 offen  lds
    s_add_u32 m0, s47, 7168
    s_add_u32 s33, s32, 196608
    buffer_load_dwordx4 v92, s[8:11], s33 offen  lds
    s_waitcnt vmcnt(32)
    s_barrier
    ds_read_b32 v104, v88 offset:4608
    ds_read_b32 v105, v88 offset:4096
    ds_read_b32 v106, v88 offset:4736
    ds_read_b32 v107, v88 offset:4224
    ds_read_b32 v108, v88 offset:5632
    ds_read_b32 v109, v88 offset:5120
    ds_read_b32 v110, v88 offset:5760
    ds_read_b32 v111, v88 offset:5248
    ds_read_b32 v112, v84 offset:4608
    ds_read_b32 v113, v84 offset:4096
    ds_read_b32 v114, v84 offset:4736
    ds_read_b32 v115, v84 offset:4224
    ds_read_b32 v116, v84 offset:5632
    ds_read_b32 v117, v84 offset:5120
    ds_read_b32 v118, v84 offset:5760
    ds_read_b32 v119, v84 offset:5248
    s_waitcnt lgkmcnt(8)
    v_perm_b32 v196, v105, v104, s49
    v_perm_b32 v204, v105, v104, s50
    v_perm_b32 v197, v107, v106, s49
    v_perm_b32 v205, v107, v106, s50
    v_perm_b32 v198, v109, v108, s49
    v_perm_b32 v206, v109, v108, s50
    v_perm_b32 v199, v111, v110, s49
    v_perm_b32 v207, v111, v110, s50
    s_waitcnt lgkmcnt(0)
    v_perm_b32 v228, v113, v112, s49
    v_perm_b32 v236, v113, v112, s50
    v_perm_b32 v229, v115, v114, s49
    v_perm_b32 v237, v115, v114, s50
    v_perm_b32 v230, v117, v116, s49
    v_perm_b32 v238, v117, v116, s50
    v_perm_b32 v231, v119, v118, s49
    v_perm_b32 v239, v119, v118, s50
    s_xor_b32 s32, s59, 0x380000
    s_add_u32 m0, s47, 0
    s_add_u32 s33, s32, 262144
    buffer_load_dwordx4 v92, s[8:11], s33 offen  lds
    s_add_u32 m0, s47, 1024
    s_add_u32 s33, s32, 327680
    buffer_load_dwordx4 v92, s[8:11], s33 offen  lds
    s_add_u32 m0, s47, 2048
    s_add_u32 s33, s32, 393216
    buffer_load_dwordx4 v92, s[8:11], s33 offen  lds
    s_add_u32 m0, s47, 3072
    s_add_u32 s33, s32, 458752
    buffer_load_dwordx4 v92, s[8:11], s33 offen  lds
    s_waitcnt vmcnt(32)
    ds_read_b64 v[104:105], v86 offset:512
    ds_read_b64 v[106:107], v86 offset:0
    ds_read_b64 v[108:109], v86 offset:640
    ds_read_b64 v[110:111], v86 offset:128
    ds_read_b64 v[112:113], v86 offset:1536
    ds_read_b64 v[114:115], v86 offset:1024
    ds_read_b64 v[116:117], v86 offset:1664
    ds_read_b64 v[118:119], v86 offset:1152
    s_waitcnt lgkmcnt(6)
    v_perm_b32 v96, v106, v104, s49
    v_perm_b32 v97, v106, v104, s50
    v_perm_b32 v98, v107, v105, s49
    v_perm_b32 v99, v107, v105, s50
    v_accvgpr_write_b32 a68, v96
    v_accvgpr_write_b32 a76, v97
    v_accvgpr_write_b32 a84, v98
    v_accvgpr_write_b32 a92, v99
    s_waitcnt lgkmcnt(4)
    v_perm_b32 v96, v110, v108, s49
    v_perm_b32 v97, v110, v108, s50
    v_perm_b32 v98, v111, v109, s49
    v_perm_b32 v99, v111, v109, s50
    v_accvgpr_write_b32 a69, v96
    v_accvgpr_write_b32 a77, v97
    v_accvgpr_write_b32 a85, v98
    v_accvgpr_write_b32 a93, v99
    s_waitcnt lgkmcnt(2)
    v_perm_b32 v96, v114, v112, s49
    v_perm_b32 v97, v114, v112, s50
    v_perm_b32 v98, v115, v113, s49
    v_perm_b32 v99, v115, v113, s50
    v_accvgpr_write_b32 a70, v96
    v_accvgpr_write_b32 a78, v97
    v_accvgpr_write_b32 a86, v98
    v_accvgpr_write_b32 a94, v99
    s_waitcnt lgkmcnt(0)
    v_perm_b32 v96, v118, v116, s49
    v_perm_b32 v97, v118, v116, s50
    v_perm_b32 v98, v119, v117, s49
    v_perm_b32 v99, v119, v117, s50
    v_accvgpr_write_b32 a71, v96
    v_accvgpr_write_b32 a79, v97
    v_accvgpr_write_b32 a87, v98
    v_accvgpr_write_b32 a95, v99
    s_xor_b32 s32, s60, 0x0
    s_add_u32 m0, s46, 0
    s_add_u32 s33, s32, 0
    buffer_load_dwordx4 v94, s[24:27], s33 offen  lds
    s_add_u32 m0, s46, 1024
    s_add_u32 s33, s32, 4096
    buffer_load_dwordx4 v94, s[24:27], s33 offen  lds
    s_add_u32 m0, s46, 2048
    s_add_u32 s33, s32, 8192
    buffer_load_dwordx4 v94, s[24:27], s33 offen  lds
    s_add_u32 m0, s46, 3072
    s_add_u32 s33, s32, 12288
    buffer_load_dwordx4 v94, s[24:27], s33 offen  lds
    s_waitcnt vmcnt(32)
    s_barrier
    ds_read_b32 v104, v88 offset:12800
    ds_read_b32 v105, v88 offset:12288
    ds_read_b32 v106, v88 offset:12928
    ds_read_b32 v107, v88 offset:12416
    ds_read_b32 v108, v88 offset:13824
    ds_read_b32 v109, v88 offset:13312
    ds_read_b32 v110, v88 offset:13952
    ds_read_b32 v111, v88 offset:13440
    ds_read_b32 v112, v84 offset:12800
    ds_read_b32 v113, v84 offset:12288
    ds_read_b32 v114, v84 offset:12928
    ds_read_b32 v115, v84 offset:12416
    ds_read_b32 v116, v84 offset:13824
    ds_read_b32 v117, v84 offset:13312
    ds_read_b32 v118, v84 offset:13952
    ds_read_b32 v119, v84 offset:13440
    s_waitcnt lgkmcnt(8)
    v_perm_b32 v208, v105, v104, s49
    v_perm_b32 v216, v105, v104, s50
    v_perm_b32 v209, v107, v106, s49
    v_perm_b32 v217, v107, v106, s50
    v_perm_b32 v210, v109, v108, s49
    v_perm_b32 v218, v109, v108, s50
    v_perm_b32 v211, v111, v110, s49
    v_perm_b32 v219, v111, v110, s50
    s_waitcnt lgkmcnt(0)
    v_perm_b32 v240, v113, v112, s49
    v_perm_b32 v248, v113, v112, s50
    v_perm_b32 v241, v115, v114, s49
    v_perm_b32 v249, v115, v114, s50
    v_perm_b32 v242, v117, v116, s49
    v_perm_b32 v250, v117, v116, s50
    v_perm_b32 v243, v119, v118, s49
    v_perm_b32 v251, v119, v118, s50
    s_xor_b32 s32, s60, 0x0
    s_add_u32 m0, s46, 4096
    s_add_u32 s33, s32, 16384
    buffer_load_dwordx4 v94, s[24:27], s33 offen  lds
    s_add_u32 m0, s46, 5120
    s_add_u32 s33, s32, 20480
    buffer_load_dwordx4 v94, s[24:27], s33 offen  lds
    s_add_u32 m0, s46, 6144
    s_add_u32 s33, s32, 24576
    buffer_load_dwordx4 v94, s[24:27], s33 offen  lds
    s_add_u32 m0, s46, 7168
    s_add_u32 s33, s32, 28672
    buffer_load_dwordx4 v94, s[24:27], s33 offen  lds
    v_mbcnt_lo_u32_b32 v70, -1, 0
    v_mbcnt_hi_u32_b32 v70, -1, v70
    v_and_b32 v70, 15, v70
    v_lshlrev_b32 v70, 3, v70
    buffer_load_dwordx2 v[68:69], v70, s[16:19], 0 offen offset:128 sc1
    buffer_load_ushort v78, v95, s[12:15], 0 offen offset:8
    buffer_load_ushort v79, v95, s[12:15], 0 offen
    s_waitcnt vmcnt(35)
    ds_read_b64 v[104:105], v86 offset:8704
    ds_read_b64 v[106:107], v86 offset:8192
    ds_read_b64 v[108:109], v86 offset:8832
    ds_read_b64 v[110:111], v86 offset:8320
    ds_read_b64 v[112:113], v86 offset:9728
    ds_read_b64 v[114:115], v86 offset:9216
    ds_read_b64 v[116:117], v86 offset:9856
    ds_read_b64 v[118:119], v86 offset:9344
    s_waitcnt lgkmcnt(6)
    v_perm_b32 v96, v106, v104, s49
    v_perm_b32 v97, v106, v104, s50
    v_perm_b32 v98, v107, v105, s49
    v_perm_b32 v99, v107, v105, s50
    v_accvgpr_write_b32 a96, v96
    v_accvgpr_write_b32 a104, v97
    v_accvgpr_write_b32 a112, v98
    v_accvgpr_write_b32 a120, v99
    s_waitcnt lgkmcnt(4)
    v_perm_b32 v96, v110, v108, s49
    v_perm_b32 v97, v110, v108, s50
    v_perm_b32 v98, v111, v109, s49
    v_perm_b32 v99, v111, v109, s50
    v_accvgpr_write_b32 a97, v96
    v_accvgpr_write_b32 a105, v97
    v_accvgpr_write_b32 a113, v98
    v_accvgpr_write_b32 a121, v99
    s_waitcnt lgkmcnt(2)
    v_perm_b32 v96, v114, v112, s49
    v_perm_b32 v97, v114, v112, s50
    v_perm_b32 v98, v115, v113, s49
    v_perm_b32 v99, v115, v113, s50
    v_accvgpr_write_b32 a98, v96
    v_accvgpr_write_b32 a106, v97
    v_accvgpr_write_b32 a114, v98
    v_accvgpr_write_b32 a122, v99
    s_waitcnt lgkmcnt(0)
    v_perm_b32 v96, v118, v116, s49
    v_perm_b32 v97, v118, v116, s50
    v_perm_b32 v98, v119, v117, s49
    v_perm_b32 v99, v119, v117, s50
    v_accvgpr_write_b32 a99, v96
    v_accvgpr_write_b32 a107, v97
    v_accvgpr_write_b32 a115, v98
    v_accvgpr_write_b32 a123, v99
    s_xor_b32 s32, s60, 0x8000
    s_add_u32 m0, s46, 8192
    s_add_u32 s33, s32, 0
    buffer_load_dwordx4 v94, s[24:27], s33 offen  lds
    s_add_u32 m0, s46, 9216
    s_add_u32 s33, s32, 4096
    buffer_load_dwordx4 v94, s[24:27], s33 offen  lds
    s_add_u32 m0, s46, 10240
    s_add_u32 s33, s32, 8192
    buffer_load_dwordx4 v94, s[24:27], s33 offen  lds
    s_add_u32 m0, s46, 11264
    s_add_u32 s33, s32, 12288
    buffer_load_dwordx4 v94, s[24:27], s33 offen  lds
    s_waitcnt vmcnt(35)
    s_barrier
    ds_read_b32 v104, v88 offset:20992
    ds_read_b32 v105, v88 offset:20480
    ds_read_b32 v106, v88 offset:21120
    ds_read_b32 v107, v88 offset:20608
    ds_read_b32 v108, v88 offset:22016
    ds_read_b32 v109, v88 offset:21504
    ds_read_b32 v110, v88 offset:22144
    ds_read_b32 v111, v88 offset:21632
    ds_read_b32 v112, v84 offset:20992
    ds_read_b32 v113, v84 offset:20480
    ds_read_b32 v114, v84 offset:21120
    ds_read_b32 v115, v84 offset:20608
    ds_read_b32 v116, v84 offset:22016
    ds_read_b32 v117, v84 offset:21504
    ds_read_b32 v118, v84 offset:22144
    ds_read_b32 v119, v84 offset:21632
    s_waitcnt lgkmcnt(8)
    v_perm_b32 v212, v105, v104, s49
    v_perm_b32 v220, v105, v104, s50
    v_perm_b32 v213, v107, v106, s49
    v_perm_b32 v221, v107, v106, s50
    v_perm_b32 v214, v109, v108, s49
    v_perm_b32 v222, v109, v108, s50
    v_perm_b32 v215, v111, v110, s49
    v_perm_b32 v223, v111, v110, s50
    s_waitcnt lgkmcnt(0)
    v_perm_b32 v244, v113, v112, s49
    v_perm_b32 v252, v113, v112, s50
    v_perm_b32 v245, v115, v114, s49
    v_perm_b32 v253, v115, v114, s50
    v_perm_b32 v246, v117, v116, s49
    v_perm_b32 v254, v117, v116, s50
    v_perm_b32 v247, v119, v118, s49
    v_perm_b32 v255, v119, v118, s50
    s_xor_b32 s32, s60, 0x8000
    s_add_u32 m0, s46, 12288
    s_add_u32 s33, s32, 16384
    buffer_load_dwordx4 v94, s[24:27], s33 offen  lds
    s_add_u32 m0, s46, 13312
    s_add_u32 s33, s32, 20480
    buffer_load_dwordx4 v94, s[24:27], s33 offen  lds
    s_add_u32 m0, s46, 14336
    s_add_u32 s33, s32, 24576
    buffer_load_dwordx4 v94, s[24:27], s33 offen  lds
    s_add_u32 m0, s46, 15360
    s_add_u32 s33, s32, 28672
    buffer_load_dwordx4 v94, s[24:27], s33 offen  lds
    s_waitcnt vmcnt(35)
    ds_read_b64 v[104:105], v86 offset:16896
    ds_read_b64 v[106:107], v86 offset:16384
    ds_read_b64 v[108:109], v86 offset:17024
    ds_read_b64 v[110:111], v86 offset:16512
    ds_read_b64 v[112:113], v86 offset:17920
    ds_read_b64 v[114:115], v86 offset:17408
    ds_read_b64 v[116:117], v86 offset:18048
    ds_read_b64 v[118:119], v86 offset:17536
    s_waitcnt lgkmcnt(6)
    v_perm_b32 v96, v106, v104, s49
    v_perm_b32 v97, v106, v104, s50
    v_perm_b32 v98, v107, v105, s49
    v_perm_b32 v99, v107, v105, s50
    v_accvgpr_write_b32 a100, v96
    v_accvgpr_write_b32 a108, v97
    v_accvgpr_write_b32 a116, v98
    v_accvgpr_write_b32 a124, v99
    s_waitcnt lgkmcnt(4)
    v_perm_b32 v96, v110, v108, s49
    v_perm_b32 v97, v110, v108, s50
    v_perm_b32 v98, v111, v109, s49
    v_perm_b32 v99, v111, v109, s50
    v_accvgpr_write_b32 a101, v96
    v_accvgpr_write_b32 a109, v97
    v_accvgpr_write_b32 a117, v98
    v_accvgpr_write_b32 a125, v99
    s_waitcnt lgkmcnt(2)
    v_perm_b32 v96, v114, v112, s49
    v_perm_b32 v97, v114, v112, s50
    v_perm_b32 v98, v115, v113, s49
    v_perm_b32 v99, v115, v113, s50
    v_accvgpr_write_b32 a102, v96
    v_accvgpr_write_b32 a110, v97
    v_accvgpr_write_b32 a118, v98
    v_accvgpr_write_b32 a126, v99
    s_waitcnt lgkmcnt(0)
    v_perm_b32 v96, v118, v116, s49
    v_perm_b32 v97, v118, v116, s50
    v_perm_b32 v98, v119, v117, s49
    v_perm_b32 v99, v119, v117, s50
    v_accvgpr_write_b32 a103, v96
    v_accvgpr_write_b32 a111, v97
    v_accvgpr_write_b32 a119, v98
    v_accvgpr_write_b32 a127, v99
    s_waitcnt vmcnt(31)
    ds_read_b64 v[104:105], v86 offset:29184
    ds_read_b64 v[106:107], v86 offset:28672
    ds_read_b64 v[108:109], v86 offset:29312
    ds_read_b64 v[110:111], v86 offset:28800
    ds_read_b64 v[112:113], v86 offset:30208
    ds_read_b64 v[114:115], v86 offset:29696
    ds_read_b64 v[116:117], v86 offset:30336
    ds_read_b64 v[118:119], v86 offset:29824
    s_waitcnt lgkmcnt(6)
    v_perm_b32 v96, v106, v104, s49
    v_perm_b32 v97, v106, v104, s50
    v_perm_b32 v98, v107, v105, s49
    v_perm_b32 v99, v107, v105, s50
    v_accvgpr_write_b32 a128, v96
    v_accvgpr_write_b32 a136, v97
    v_accvgpr_write_b32 a144, v98
    v_accvgpr_write_b32 a152, v99
    s_waitcnt lgkmcnt(4)
    v_perm_b32 v96, v110, v108, s49
    v_perm_b32 v97, v110, v108, s50
    v_perm_b32 v98, v111, v109, s49
    v_perm_b32 v99, v111, v109, s50
    v_accvgpr_write_b32 a129, v96
    v_accvgpr_write_b32 a137, v97
    v_accvgpr_write_b32 a145, v98
    v_accvgpr_write_b32 a153, v99
    s_waitcnt lgkmcnt(2)
    v_perm_b32 v96, v114, v112, s49
    v_perm_b32 v97, v114, v112, s50
    v_perm_b32 v98, v115, v113, s49
    v_perm_b32 v99, v115, v113, s50
    v_accvgpr_write_b32 a130, v96
    v_accvgpr_write_b32 a138, v97
    v_accvgpr_write_b32 a146, v98
    v_accvgpr_write_b32 a154, v99
    s_waitcnt lgkmcnt(0)
    v_perm_b32 v96, v118, v116, s49
    v_perm_b32 v97, v118, v116, s50
    v_perm_b32 v98, v119, v117, s49
    v_perm_b32 v99, v119, v117, s50
    v_accvgpr_write_b32 a131, v96
    v_accvgpr_write_b32 a139, v97
    v_accvgpr_write_b32 a147, v98
    v_accvgpr_write_b32 a155, v99
    s_waitcnt vmcnt(27)
    ds_read_b64 v[104:105], v86 offset:25088
    ds_read_b64 v[106:107], v86 offset:24576
    ds_read_b64 v[108:109], v86 offset:25216
    ds_read_b64 v[110:111], v86 offset:24704
    ds_read_b64 v[112:113], v86 offset:26112
    ds_read_b64 v[114:115], v86 offset:25600
    ds_read_b64 v[116:117], v86 offset:26240
    ds_read_b64 v[118:119], v86 offset:25728
    s_waitcnt lgkmcnt(6)
    v_perm_b32 v96, v106, v104, s49
    v_perm_b32 v97, v106, v104, s50
    v_perm_b32 v98, v107, v105, s49
    v_perm_b32 v99, v107, v105, s50
    v_accvgpr_write_b32 a132, v96
    v_accvgpr_write_b32 a140, v97
    v_accvgpr_write_b32 a148, v98
    v_accvgpr_write_b32 a156, v99
    s_waitcnt lgkmcnt(4)
    v_perm_b32 v96, v110, v108, s49
    v_perm_b32 v97, v110, v108, s50
    v_perm_b32 v98, v111, v109, s49
    v_perm_b32 v99, v111, v109, s50
    v_accvgpr_write_b32 a133, v96
    v_accvgpr_write_b32 a141, v97
    v_accvgpr_write_b32 a149, v98
    v_accvgpr_write_b32 a157, v99
    s_waitcnt lgkmcnt(2)
    v_perm_b32 v96, v114, v112, s49
    v_perm_b32 v97, v114, v112, s50
    v_perm_b32 v98, v115, v113, s49
    v_perm_b32 v99, v115, v113, s50
    v_accvgpr_write_b32 a134, v96
    v_accvgpr_write_b32 a142, v97
    v_accvgpr_write_b32 a150, v98
    v_accvgpr_write_b32 a158, v99
    s_waitcnt lgkmcnt(0)
    v_perm_b32 v96, v118, v116, s49
    v_perm_b32 v97, v118, v116, s50
    v_perm_b32 v98, v119, v117, s49
    v_perm_b32 v99, v119, v117, s50
    v_accvgpr_write_b32 a135, v96
    v_accvgpr_write_b32 a143, v97
    v_accvgpr_write_b32 a151, v98
    v_accvgpr_write_b32 a159, v99
    s_barrier
    s_waitcnt vmcnt(23)
    ds_read_b64 v[104:105], v87 offset:4608
    ds_read_b64 v[106:107], v87 offset:4096
    ds_read_b64 v[108:109], v87 offset:4736
    ds_read_b64 v[110:111], v87 offset:4224
    ds_read_b64 v[112:113], v87 offset:5632
    ds_read_b64 v[114:115], v87 offset:5120
    ds_read_b64 v[116:117], v87 offset:5760
    ds_read_b64 v[118:119], v87 offset:5248
    s_waitcnt lgkmcnt(6)
    v_perm_b32 v96, v106, v104, s49
    v_perm_b32 v97, v106, v104, s50
    v_perm_b32 v98, v107, v105, s49
    v_perm_b32 v99, v107, v105, s50
    v_accvgpr_write_b32 a160, v96
    v_accvgpr_write_b32 a168, v97
    v_accvgpr_write_b32 a176, v98
    v_accvgpr_write_b32 a184, v99
    s_waitcnt lgkmcnt(4)
    v_perm_b32 v96, v110, v108, s49
    v_perm_b32 v97, v110, v108, s50
    v_perm_b32 v98, v111, v109, s49
    v_perm_b32 v99, v111, v109, s50
    v_accvgpr_write_b32 a161, v96
    v_accvgpr_write_b32 a169, v97
    v_accvgpr_write_b32 a177, v98
    v_accvgpr_write_b32 a185, v99
    s_waitcnt lgkmcnt(2)
    v_perm_b32 v96, v114, v112, s49
    v_perm_b32 v97, v114, v112, s50
    v_perm_b32 v98, v115, v113, s49
    v_perm_b32 v99, v115, v113, s50
    v_accvgpr_write_b32 a162, v96
    v_accvgpr_write_b32 a170, v97
    v_accvgpr_write_b32 a178, v98
    v_accvgpr_write_b32 a186, v99
    s_waitcnt lgkmcnt(0)
    v_perm_b32 v96, v118, v116, s49
    v_perm_b32 v97, v118, v116, s50
    v_perm_b32 v98, v119, v117, s49
    v_perm_b32 v99, v119, v117, s50
    v_accvgpr_write_b32 a163, v96
    v_accvgpr_write_b32 a171, v97
    v_accvgpr_write_b32 a179, v98
    v_accvgpr_write_b32 a187, v99
    s_xor_b32 s32, s60, 0x10000
    s_add_u32 m0, s47, 4096
    s_add_u32 s33, s32, 0
    buffer_load_dwordx4 v94, s[24:27], s33 offen  lds
    s_add_u32 m0, s47, 5120
    s_add_u32 s33, s32, 4096
    buffer_load_dwordx4 v94, s[24:27], s33 offen  lds
    s_add_u32 m0, s47, 6144
    s_add_u32 s33, s32, 8192
    buffer_load_dwordx4 v94, s[24:27], s33 offen  lds
    s_add_u32 m0, s47, 7168
    s_add_u32 s33, s32, 12288
    buffer_load_dwordx4 v94, s[24:27], s33 offen  lds
    s_waitcnt vmcnt(23)
    ds_read_b64 v[104:105], v87 offset:512
    ds_read_b64 v[106:107], v87 offset:0
    ds_read_b64 v[108:109], v87 offset:640
    ds_read_b64 v[110:111], v87 offset:128
    ds_read_b64 v[112:113], v87 offset:1536
    ds_read_b64 v[114:115], v87 offset:1024
    ds_read_b64 v[116:117], v87 offset:1664
    ds_read_b64 v[118:119], v87 offset:1152
    s_waitcnt lgkmcnt(6)
    v_perm_b32 v96, v106, v104, s49
    v_perm_b32 v97, v106, v104, s50
    v_perm_b32 v98, v107, v105, s49
    v_perm_b32 v99, v107, v105, s50
    v_accvgpr_write_b32 a164, v96
    v_accvgpr_write_b32 a172, v97
    v_accvgpr_write_b32 a180, v98
    v_accvgpr_write_b32 a188, v99
    s_waitcnt lgkmcnt(4)
    v_perm_b32 v96, v110, v108, s49
    v_perm_b32 v97, v110, v108, s50
    v_perm_b32 v98, v111, v109, s49
    v_perm_b32 v99, v111, v109, s50
    v_accvgpr_write_b32 a165, v96
    v_accvgpr_write_b32 a173, v97
    v_accvgpr_write_b32 a181, v98
    v_accvgpr_write_b32 a189, v99
    s_waitcnt lgkmcnt(2)
    v_perm_b32 v96, v114, v112, s49
    v_perm_b32 v97, v114, v112, s50
    v_perm_b32 v98, v115, v113, s49
    v_perm_b32 v99, v115, v113, s50
    v_accvgpr_write_b32 a166, v96
    v_accvgpr_write_b32 a174, v97
    v_accvgpr_write_b32 a182, v98
    v_accvgpr_write_b32 a190, v99
    s_waitcnt lgkmcnt(0)
    v_perm_b32 v96, v118, v116, s49
    v_perm_b32 v97, v118, v116, s50
    v_perm_b32 v98, v119, v117, s49
    v_perm_b32 v99, v119, v117, s50
    v_accvgpr_write_b32 a167, v96
    v_accvgpr_write_b32 a175, v97
    v_accvgpr_write_b32 a183, v98
    v_accvgpr_write_b32 a191, v99
    s_xor_b32 s32, s60, 0x10000
    s_add_u32 m0, s47, 0
    s_add_u32 s33, s32, 16384
    buffer_load_dwordx4 v94, s[24:27], s33 offen  lds
    s_add_u32 m0, s47, 1024
    s_add_u32 s33, s32, 20480
    buffer_load_dwordx4 v94, s[24:27], s33 offen  lds
    s_add_u32 m0, s47, 2048
    s_add_u32 s33, s32, 24576
    buffer_load_dwordx4 v94, s[24:27], s33 offen  lds
    s_add_u32 m0, s47, 3072
    s_add_u32 s33, s32, 28672
    buffer_load_dwordx4 v94, s[24:27], s33 offen  lds
    s_waitcnt vmcnt(23)
    ds_read_b128 v[104:107], v90 offset:0
    ds_read_b128 v[108:111], v90 offset:256
    ds_read_b128 v[112:115], v90 offset:512
    ds_read_b128 v[116:119], v90 offset:768
    s_waitcnt lgkmcnt(0)
    v_perm_b32 v96, v108, v104, s49
    v_perm_b32 v97, v108, v104, s50
    v_perm_b32 v98, v116, v112, s49
    v_perm_b32 v99, v116, v112, s50
    v_accvgpr_write_b32 a192, v96
    v_accvgpr_write_b32 a193, v97
    v_accvgpr_write_b32 a194, v98
    v_accvgpr_write_b32 a195, v99
    v_perm_b32 v100, v109, v105, s49
    v_perm_b32 v101, v109, v105, s50
    v_perm_b32 v102, v117, v113, s49
    v_perm_b32 v103, v117, v113, s50
    v_accvgpr_write_b32 a200, v100
    v_accvgpr_write_b32 a201, v101
    v_accvgpr_write_b32 a202, v102
    v_accvgpr_write_b32 a203, v103
    v_perm_b32 v96, v110, v106, s49
    v_perm_b32 v97, v110, v106, s50
    v_perm_b32 v98, v118, v114, s49
    v_perm_b32 v99, v118, v114, s50
    v_accvgpr_write_b32 a208, v96
    v_accvgpr_write_b32 a209, v97
    v_accvgpr_write_b32 a210, v98
    v_accvgpr_write_b32 a211, v99
    v_perm_b32 v100, v111, v107, s49
    v_perm_b32 v101, v111, v107, s50
    v_perm_b32 v102, v119, v115, s49
    v_perm_b32 v103, v119, v115, s50
    v_accvgpr_write_b32 a216, v100
    v_accvgpr_write_b32 a217, v101
    v_accvgpr_write_b32 a218, v102
    v_accvgpr_write_b32 a219, v103
    s_waitcnt lgkmcnt(0)
    s_xor_b32 s32, s60, 0x18000
    s_add_u32 m0, s46, 0
    s_add_u32 s33, s32, 0
    buffer_load_dwordx4 v94, s[24:27], s33 offen  lds
    s_add_u32 m0, s46, 1024
    s_add_u32 s33, s32, 4096
    buffer_load_dwordx4 v94, s[24:27], s33 offen  lds
    s_add_u32 m0, s46, 2048
    s_add_u32 s33, s32, 8192
    buffer_load_dwordx4 v94, s[24:27], s33 offen  lds
    s_add_u32 m0, s46, 3072
    s_add_u32 s33, s32, 12288
    buffer_load_dwordx4 v94, s[24:27], s33 offen  lds
    s_waitcnt vmcnt(23)
    ds_read_b128 v[104:107], v90 offset:4096
    ds_read_b128 v[108:111], v90 offset:4352
    ds_read_b128 v[112:115], v90 offset:4608
    ds_read_b128 v[116:119], v90 offset:4864
    s_waitcnt lgkmcnt(0)
    v_perm_b32 v96, v108, v104, s49
    v_perm_b32 v97, v108, v104, s50
    v_perm_b32 v98, v116, v112, s49
    v_perm_b32 v99, v116, v112, s50
    v_accvgpr_write_b32 a196, v96
    v_accvgpr_write_b32 a197, v97
    v_accvgpr_write_b32 a198, v98
    v_accvgpr_write_b32 a199, v99
    v_perm_b32 v100, v109, v105, s49
    v_perm_b32 v101, v109, v105, s50
    v_perm_b32 v102, v117, v113, s49
    v_perm_b32 v103, v117, v113, s50
    v_accvgpr_write_b32 a204, v100
    v_accvgpr_write_b32 a205, v101
    v_accvgpr_write_b32 a206, v102
    v_accvgpr_write_b32 a207, v103
    v_perm_b32 v96, v110, v106, s49
    v_perm_b32 v97, v110, v106, s50
    v_perm_b32 v98, v118, v114, s49
    v_perm_b32 v99, v118, v114, s50
    v_accvgpr_write_b32 a212, v96
    v_accvgpr_write_b32 a213, v97
    v_accvgpr_write_b32 a214, v98
    v_accvgpr_write_b32 a215, v99
    v_perm_b32 v100, v111, v107, s49
    v_perm_b32 v101, v111, v107, s50
    v_perm_b32 v102, v119, v115, s49
    v_perm_b32 v103, v119, v115, s50
    v_accvgpr_write_b32 a220, v100
    v_accvgpr_write_b32 a221, v101
    v_accvgpr_write_b32 a222, v102
    v_accvgpr_write_b32 a223, v103
    s_waitcnt lgkmcnt(0)
    s_xor_b32 s32, s60, 0x18000
    s_add_u32 m0, s46, 4096
    s_add_u32 s33, s32, 16384
    buffer_load_dwordx4 v94, s[24:27], s33 offen  lds
    s_add_u32 m0, s46, 5120
    s_add_u32 s33, s32, 20480
    buffer_load_dwordx4 v94, s[24:27], s33 offen  lds
    s_add_u32 m0, s46, 6144
    s_add_u32 s33, s32, 24576
    buffer_load_dwordx4 v94, s[24:27], s33 offen  lds
    s_add_u32 m0, s46, 7168
    s_add_u32 s33, s32, 28672
    buffer_load_dwordx4 v94, s[24:27], s33 offen  lds
    s_waitcnt vmcnt(20)
    ds_read_b128 v[104:107], v90 offset:8192
    ds_read_b128 v[108:111], v90 offset:8448
    ds_read_b128 v[112:115], v90 offset:8704
    ds_read_b128 v[116:119], v90 offset:8960
    s_waitcnt lgkmcnt(0)
    v_perm_b32 v96, v108, v104, s49
    v_perm_b32 v97, v108, v104, s50
    v_perm_b32 v98, v116, v112, s49
    v_perm_b32 v99, v116, v112, s50
    ds_write_b128 v120, v[96:99] offset:22528
    v_perm_b32 v100, v109, v105, s49
    v_perm_b32 v101, v109, v105, s50
    v_perm_b32 v102, v117, v113, s49
    v_perm_b32 v103, v117, v113, s50
    v_accvgpr_write_b32 a248, v100
    v_accvgpr_write_b32 a249, v101
    v_accvgpr_write_b32 a250, v102
    v_accvgpr_write_b32 a251, v103
    v_perm_b32 v96, v110, v106, s49
    v_perm_b32 v97, v110, v106, s50
    v_perm_b32 v98, v118, v114, s49
    v_perm_b32 v99, v118, v114, s50
    ds_write_b128 v120, v[96:99] offset:16384
    v_perm_b32 v100, v111, v107, s49
    v_perm_b32 v101, v111, v107, s50
    v_perm_b32 v102, v119, v115, s49
    v_perm_b32 v103, v119, v115, s50
    v_accvgpr_write_b32 a224, v100
    v_accvgpr_write_b32 a225, v101
    v_accvgpr_write_b32 a226, v102
    v_accvgpr_write_b32 a227, v103
    s_waitcnt lgkmcnt(0)
    s_xor_b32 s32, s59, 0x100000
    s_add_u32 m0, s46, 8192
    s_add_u32 s33, s32, 0
    buffer_load_dwordx4 v92, s[8:11], s33 offen  lds
    s_add_u32 m0, s46, 9216
    s_add_u32 s33, s32, 65536
    buffer_load_dwordx4 v92, s[8:11], s33 offen  lds
    s_add_u32 m0, s46, 10240
    s_add_u32 s33, s32, 131072
    buffer_load_dwordx4 v92, s[8:11], s33 offen  lds
    s_add_u32 m0, s46, 11264
    s_add_u32 s33, s32, 196608
    buffer_load_dwordx4 v92, s[8:11], s33 offen  lds
    s_waitcnt vmcnt(20)
    ds_read_b128 v[104:107], v90 offset:12288
    ds_read_b128 v[108:111], v90 offset:12544
    ds_read_b128 v[112:115], v90 offset:12800
    ds_read_b128 v[116:119], v90 offset:13056
    s_waitcnt lgkmcnt(0)
    v_perm_b32 v96, v108, v104, s49
    v_perm_b32 v97, v108, v104, s50
    v_perm_b32 v98, v116, v112, s49
    v_perm_b32 v99, v116, v112, s50
    ds_write_b128 v120, v[96:99] offset:23552
    v_perm_b32 v100, v109, v105, s49
    v_perm_b32 v101, v109, v105, s50
    v_perm_b32 v102, v117, v113, s49
    v_perm_b32 v103, v117, v113, s50
    v_accvgpr_write_b32 a252, v100
    v_accvgpr_write_b32 a253, v101
    v_accvgpr_write_b32 a254, v102
    v_accvgpr_write_b32 a255, v103
    v_perm_b32 v96, v110, v106, s49
    v_perm_b32 v97, v110, v106, s50
    v_perm_b32 v98, v118, v114, s49
    v_perm_b32 v99, v118, v114, s50
    ds_write_b128 v120, v[96:99] offset:17408
    v_perm_b32 v100, v111, v107, s49
    v_perm_b32 v101, v111, v107, s50
    v_perm_b32 v102, v119, v115, s49
    v_perm_b32 v103, v119, v115, s50
    v_accvgpr_write_b32 a228, v100
    v_accvgpr_write_b32 a229, v101
    v_accvgpr_write_b32 a230, v102
    v_accvgpr_write_b32 a231, v103
    s_waitcnt lgkmcnt(0)
    s_lshl_b32 s62, s43, 5
    s_or_b32 s62, s62, 127
    s_mov_b32 s32, 0
    s_branch L_wac_4
L_wa_3:
    v_mbcnt_lo_u32_b32 v70, -1, 0
    v_mbcnt_hi_u32_b32 v70, -1, v70
    v_and_b32 v70, 15, v70
    v_lshlrev_b32 v70, 3, v70
    buffer_load_dwordx2 v[68:69], v70, s[16:19], 0 offen offset:128 sc1
    s_add_u32 s32, s32, 1
    s_cmp_gt_u32 s32, 262144
    s_cbranch_scc1 L_fail
    s_waitcnt vmcnt(0)
L_wac_4:
    v_lshrrev_b32 v71, 24, v69
    v_cmp_ne_u32 vcc, 32, v71
    s_and_b32 s33, vcc_lo, s62
    s_cmp_lg_u32 s33, 0
    s_cbranch_scc0 L_wac_4_ok
    s_sleep 8
    s_branch L_wa_3
L_wac_4_ok:
    s_nop 3
    v_readlane_b32 s34, v68, s43
    v_readlane_b32 s35, v69, s43
    s_mul_i32 s32, s31, 6
    s_lshl_b64 s[36:37], 32, s32
    s_or_b32 s37, s37, 0x20000000
    s_cmp_eq_u64 s[34:35], s[36:37]
    s_cselect_b32 s61, 1, 0
    s_cmp_eq_u32 s43, 0
    s_cselect_b32 s61, s61, 0
    s_cselect_b32 s38, 0, 0
    s_cselect_b32 s42, 63, 0
    s_lshl_b32 s32, s29, 8
    s_lshl_b32 s33, s28, 6
    s_add_u32 s32, s32, s33
    s_add_u32 s45, s32, 0x100000
    s_mov_b32 s57, s45
    v_lshl_or_b32 v78, v79, 16, v78
    v_min_u32 v78, -2, v78
    s_mov_b64 exec, s[54:55]
    s_cmp_eq_u32 s61, 0
    s_cbranch_scc1 L_m0s_5
    buffer_store_dword v78, v1, s[4:7], s57 offen
    s_branch L_m0j_6
L_m0s_5:
    buffer_store_dword v78, v1, s[4:7], s57 offen sc1
L_m0j_6:
    s_mov_b64 exec, -1
    s_add_u32 s32, s45, 8192
    buffer_load_dword v70, v1, s[4:7], s32 offen sc1
    buffer_load_dwordx4 v[72:75], v122, s[4:7], s44 offen offset:0 sc1
    buffer_load_dwordx4 v[72:75], v122, s[4:7], s44 offen offset:1024 sc1
    s_lshl_b32 s32, s29, 19
    s_add_u32 s32, s32, 0x5001000
    buffer_load_dword v70, off, s[4:7], s32 sc1
    buffer_load_dwordx2 v[68:69], off, s[4:7], s63 sc1
    s_xor_b32 s32, s59, 0x100000
    s_add_u32 m0, s46, 12288
    s_add_u32 s33, s32, 262144
    buffer_load_dwordx4 v92, s[8:11], s33 offen  lds
    s_add_u32 m0, s46, 13312
    s_add_u32 s33, s32, 327680
    buffer_load_dwordx4 v92, s[8:11], s33 offen  lds
    s_add_u32 m0, s46, 14336
    s_add_u32 s33, s32, 393216
    buffer_load_dwordx4 v92, s[8:11], s33 offen  lds
    s_add_u32 m0, s46, 15360
    s_add_u32 s33, s32, 458752
    buffer_load_dwordx4 v92, s[8:11], s33 offen  lds
    s_waitcnt vmcnt(26)
    ds_read_b128 v[104:107], v91 offset:4096
    ds_read_b128 v[108:111], v91 offset:4352
    ds_read_b128 v[112:115], v91 offset:4608
    ds_read_b128 v[116:119], v91 offset:4864
    s_waitcnt lgkmcnt(0)
    v_perm_b32 v96, v108, v104, s49
    v_perm_b32 v97, v108, v104, s50
    v_perm_b32 v98, v116, v112, s49
    v_perm_b32 v99, v116, v112, s50
    ds_write_b128 v120, v[96:99] offset:24576
    v_perm_b32 v100, v109, v105, s49
    v_perm_b32 v101, v109, v105, s50
    v_perm_b32 v102, v117, v113, s49
    v_perm_b32 v103, v117, v113, s50
    ds_write_b128 v120, v[100:103] offset:28672
    v_perm_b32 v96, v110, v106, s49
    v_perm_b32 v97, v110, v106, s50
    v_perm_b32 v98, v118, v114, s49
    v_perm_b32 v99, v118, v114, s50
    ds_write_b128 v120, v[96:99] offset:18432
    v_perm_b32 v100, v111, v107, s49
    v_perm_b32 v101, v111, v107, s50
    v_perm_b32 v102, v119, v115, s49
    v_perm_b32 v103, v119, v115, s50
    v_accvgpr_write_b32 a232, v100
    v_accvgpr_write_b32 a233, v101
    v_accvgpr_write_b32 a234, v102
    v_accvgpr_write_b32 a235, v103
    s_waitcnt lgkmcnt(0)
    s_xor_b32 s32, s59, 0x300000
    s_add_u32 m0, s47, 4096
    s_add_u32 s33, s32, 0
    buffer_load_dwordx4 v92, s[8:11], s33 offen  lds
    s_add_u32 m0, s47, 5120
    s_add_u32 s33, s32, 65536
    buffer_load_dwordx4 v92, s[8:11], s33 offen  lds
    s_add_u32 m0, s47, 6144
    s_add_u32 s33, s32, 131072
    buffer_load_dwordx4 v92, s[8:11], s33 offen  lds
    s_add_u32 m0, s47, 7168
    s_add_u32 s33, s32, 196608
    buffer_load_dwordx4 v92, s[8:11], s33 offen  lds
    s_waitcnt vmcnt(26)
    ds_read_b128 v[104:107], v91 offset:0
    ds_read_b128 v[108:111], v91 offset:256
    ds_read_b128 v[112:115], v91 offset:512
    ds_read_b128 v[116:119], v91 offset:768
    s_waitcnt lgkmcnt(0)
    v_perm_b32 v96, v108, v104, s49
    v_perm_b32 v97, v108, v104, s50
    v_perm_b32 v98, v116, v112, s49
    v_perm_b32 v99, v116, v112, s50
    ds_write_b128 v120, v[96:99] offset:25600
    v_perm_b32 v100, v109, v105, s49
    v_perm_b32 v101, v109, v105, s50
    v_perm_b32 v102, v117, v113, s49
    v_perm_b32 v103, v117, v113, s50
    ds_write_b128 v120, v[100:103] offset:29696
    v_perm_b32 v96, v110, v106, s49
    v_perm_b32 v97, v110, v106, s50
    v_perm_b32 v98, v118, v114, s49
    v_perm_b32 v99, v118, v114, s50
    ds_write_b128 v120, v[96:99] offset:19456
    v_perm_b32 v100, v111, v107, s49
    v_perm_b32 v101, v111, v107, s50
    v_perm_b32 v102, v119, v115, s49
    v_perm_b32 v103, v119, v115, s50
    v_accvgpr_write_b32 a236, v100
    v_accvgpr_write_b32 a237, v101
    v_accvgpr_write_b32 a238, v102
    v_accvgpr_write_b32 a239, v103
    s_waitcnt lgkmcnt(0)
    s_xor_b32 s32, s59, 0x300000
    s_add_u32 m0, s47, 0
    s_add_u32 s33, s32, 262144
    buffer_load_dwordx4 v92, s[8:11], s33 offen  lds
    s_add_u32 m0, s47, 1024
    s_add_u32 s33, s32, 327680
    buffer_load_dwordx4 v92, s[8:11], s33 offen  lds
    s_add_u32 m0, s47, 2048
    s_add_u32 s33, s32, 393216
    buffer_load_dwordx4 v92, s[8:11], s33 offen  lds
    s_add_u32 m0, s47, 3072
    s_add_u32 s33, s32, 458752
    buffer_load_dwordx4 v92, s[8:11], s33 offen  lds
    s_waitcnt vmcnt(26)
    ds_read_b128 v[104:107], v90 offset:0
    ds_read_b128 v[108:111], v90 offset:256
    ds_read_b128 v[112:115], v90 offset:512
    ds_read_b128 v[116:119], v90 offset:768
    s_waitcnt lgkmcnt(0)
    v_perm_b32 v96, v108, v104, s49
    v_perm_b32 v97, v108, v104, s50
    v_perm_b32 v98, v116, v112, s49
    v_perm_b32 v99, v116, v112, s50
    ds_write_b128 v120, v[96:99] offset:26624
    v_perm_b32 v100, v109, v105, s49
    v_perm_b32 v101, v109, v105, s50
    v_perm_b32 v102, v117, v113, s49
    v_perm_b32 v103, v117, v113, s50
    ds_write_b128 v120, v[100:103] offset:30720
    v_perm_b32 v96, v110, v106, s49
    v_perm_b32 v97, v110, v106, s50
    v_perm_b32 v98, v118, v114, s49
    v_perm_b32 v99, v118, v114, s50
    ds_write_b128 v120, v[96:99] offset:20480
    v_perm_b32 v100, v111, v107, s49
    v_perm_b32 v101, v111, v107, s50
    v_perm_b32 v102, v119, v115, s49
    v_perm_b32 v103, v119, v115, s50
    v_accvgpr_write_b32 a240, v100
    v_accvgpr_write_b32 a241, v101
    v_accvgpr_write_b32 a242, v102
    v_accvgpr_write_b32 a243, v103
    s_waitcnt lgkmcnt(0)
    s_waitcnt vmcnt(22)
    ds_read_b128 v[104:107], v90 offset:4096
    ds_read_b128 v[108:111], v90 offset:4352
    ds_read_b128 v[112:115], v90 offset:4608
    ds_read_b128 v[116:119], v90 offset:4864
    s_waitcnt lgkmcnt(0)
    v_perm_b32 v96, v108, v104, s49
    v_perm_b32 v97, v108, v104, s50
    v_perm_b32 v98, v116, v112, s49
    v_perm_b32 v99, v116, v112, s50
    ds_write_b128 v120, v[96:99] offset:27648
    v_perm_b32 v100, v109, v105, s49
    v_perm_b32 v101, v109, v105, s50
    v_perm_b32 v102, v117, v113, s49
    v_perm_b32 v103, v117, v113, s50
    ds_write_b128 v120, v[100:103] offset:31744
    v_perm_b32 v96, v110, v106, s49
    v_perm_b32 v97, v110, v106, s50
    v_perm_b32 v98, v118, v114, s49
    v_perm_b32 v99, v118, v114, s50
    ds_write_b128 v120, v[96:99] offset:21504
    v_perm_b32 v100, v111, v107, s49
    v_perm_b32 v101, v111, v107, s50
    v_perm_b32 v102, v119, v115, s49
    v_perm_b32 v103, v119, v115, s50
    v_accvgpr_write_b32 a244, v100
    v_accvgpr_write_b32 a245, v101
    v_accvgpr_write_b32 a246, v102
    v_accvgpr_write_b32 a247, v103
    s_waitcnt lgkmcnt(0)
    s_waitcnt vmcnt(18)
    ds_read_b64 v[104:105], v86 offset:8704
    ds_read_b64 v[106:107], v86 offset:8192
    ds_read_b64 v[108:109], v86 offset:8832
    ds_read_b64 v[110:111], v86 offset:8320
    ds_read_b64 v[112:113], v86 offset:9728
    ds_read_b64 v[114:115], v86 offset:9216
    ds_read_b64 v[116:117], v86 offset:9856
    ds_read_b64 v[118:119], v86 offset:9344
    s_waitcnt lgkmcnt(6)
    v_perm_b32 v4, v106, v104, s49
    v_perm_b32 v8, v106, v104, s50
    v_perm_b32 v12, v107, v105, s49
    v_perm_b32 v16, v107, v105, s50
    s_waitcnt lgkmcnt(4)
    v_perm_b32 v5, v110, v108, s49
    v_perm_b32 v9, v110, v108, s50
    v_perm_b32 v13, v111, v109, s49
    v_perm_b32 v17, v111, v109, s50
    s_waitcnt lgkmcnt(2)
    v_perm_b32 v6, v114, v112, s49
    v_perm_b32 v10, v114, v112, s50
    v_perm_b32 v14, v115, v113, s49
    v_perm_b32 v18, v115, v113, s50
    s_waitcnt lgkmcnt(0)
    v_perm_b32 v7, v118, v116, s49
    v_perm_b32 v11, v118, v116, s50
    v_perm_b32 v15, v119, v117, s49
    v_perm_b32 v19, v119, v117, s50
    s_waitcnt vmcnt(8)
    ds_read_b64 v[104:105], v86 offset:12800
    ds_read_b64 v[106:107], v86 offset:12288
    ds_read_b64 v[108:109], v86 offset:12928
    ds_read_b64 v[110:111], v86 offset:12416
    ds_read_b64 v[112:113], v86 offset:13824
    ds_read_b64 v[114:115], v86 offset:13312
    ds_read_b64 v[116:117], v86 offset:13952
    ds_read_b64 v[118:119], v86 offset:13440
    s_waitcnt lgkmcnt(6)
    v_perm_b32 v20, v106, v104, s49
    v_perm_b32 v24, v106, v104, s50
    v_perm_b32 v28, v107, v105, s49
    v_perm_b32 v32, v107, v105, s50
    s_waitcnt lgkmcnt(4)
    v_perm_b32 v21, v110, v108, s49
    v_perm_b32 v25, v110, v108, s50
    v_perm_b32 v29, v111, v109, s49
    v_perm_b32 v33, v111, v109, s50
    s_waitcnt lgkmcnt(2)
    v_perm_b32 v22, v114, v112, s49
    v_perm_b32 v26, v114, v112, s50
    v_perm_b32 v30, v115, v113, s49
    v_perm_b32 v34, v115, v113, s50
    s_waitcnt lgkmcnt(0)
    v_perm_b32 v23, v118, v116, s49
    v_perm_b32 v27, v118, v116, s50
    v_perm_b32 v31, v119, v117, s49
    v_perm_b32 v35, v119, v117, s50
    s_waitcnt vmcnt(4)
    ds_read_b64 v[104:105], v87 offset:4608
    ds_read_b64 v[106:107], v87 offset:4096
    ds_read_b64 v[108:109], v87 offset:4736
    ds_read_b64 v[110:111], v87 offset:4224
    ds_read_b64 v[112:113], v87 offset:5632
    ds_read_b64 v[114:115], v87 offset:5120
    ds_read_b64 v[116:117], v87 offset:5760
    ds_read_b64 v[118:119], v87 offset:5248
    s_waitcnt lgkmcnt(6)
    v_perm_b32 v36, v106, v104, s49
    v_perm_b32 v40, v106, v104, s50
    v_perm_b32 v44, v107, v105, s49
    v_perm_b32 v48, v107, v105, s50
    s_waitcnt lgkmcnt(4)
    v_perm_b32 v37, v110, v108, s49
    v_perm_b32 v41, v110, v108, s50
    v_perm_b32 v45, v111, v109, s49
    v_perm_b32 v49, v111, v109, s50
    s_waitcnt lgkmcnt(2)
    v_perm_b32 v38, v114, v112, s49
    v_perm_b32 v42, v114, v112, s50
    v_perm_b32 v46, v115, v113, s49
    v_perm_b32 v50, v115, v113, s50
    s_waitcnt lgkmcnt(0)
    v_perm_b32 v39, v118, v116, s49
    v_perm_b32 v43, v118, v116, s50
    v_perm_b32 v47, v119, v117, s49
    v_perm_b32 v51, v119, v117, s50
    s_waitcnt vmcnt(0)
    ds_read_b64 v[104:105], v87 offset:512
    ds_read_b64 v[106:107], v87 offset:0
    ds_read_b64 v[108:109], v87 offset:640
    ds_read_b64 v[110:111], v87 offset:128
    ds_read_b64 v[112:113], v87 offset:1536
    ds_read_b64 v[114:115], v87 offset:1024
    ds_read_b64 v[116:117], v87 offset:1664
    ds_read_b64 v[118:119], v87 offset:1152
    s_waitcnt lgkmcnt(6)
    v_perm_b32 v52, v106, v104, s49
    v_perm_b32 v56, v106, v104, s50
    v_perm_b32 v60, v107, v105, s49
    v_perm_b32 v64, v107, v105, s50
    s_waitcnt lgkmcnt(4)
    v_perm_b32 v53, v110, v108, s49
    v_perm_b32 v57, v110, v108, s50
    v_perm_b32 v61, v111, v109, s49
    v_perm_b32 v65, v111, v109, s50
    s_waitcnt lgkmcnt(2)
    v_perm_b32 v54, v114, v112, s49
    v_perm_b32 v58, v114, v112, s50
    v_perm_b32 v62, v115, v113, s49
    v_perm_b32 v66, v115, v113, s50
    s_waitcnt lgkmcnt(0)
    v_perm_b32 v55, v118, v116, s49
    v_perm_b32 v59, v118, v116, s50
    v_perm_b32 v63, v119, v117, s49
    v_perm_b32 v67, v119, v117, s50
    ds_write_b128 v120, v[4:7] offset:0
    ds_write_b128 v120, v[8:11] offset:2048
    ds_write_b128 v120, v[12:15] offset:4096
    ds_write_b128 v120, v[16:19] offset:6144
    ds_write_b128 v120, v[20:23] offset:1024
    ds_write_b128 v120, v[24:27] offset:3072
    ds_write_b128 v120, v[28:31] offset:5120
    ds_write_b128 v120, v[32:35] offset:7168
    ds_write_b128 v120, v[36:39] offset:8192
    ds_write_b128 v120, v[40:43] offset:10240
    ds_write_b128 v120, v[44:47] offset:12288
    ds_write_b128 v120, v[48:51] offset:14336
    ds_write_b128 v120, v[52:55] offset:9216
    ds_write_b128 v120, v[56:59] offset:11264
    ds_write_b128 v120, v[60:63] offset:13312
    ds_write_b128 v120, v[64:67] offset:15360
    s_barrier
    ds_write_b128 v122, v[80:83] offset:30720
    s_waitcnt lgkmcnt(0)
    s_cmp_eq_u32 s28, 0
    s_cselect_b64 s[8:9], -1, 0
    s_cmp_eq_u32 s28, 1
    s_cselect_b64 s[10:11], -1, 0
    s_cmp_eq_u32 s28, 2
    s_cselect_b64 s[12:13], -1, 0
    s_cmp_eq_u32 s28, 3
    s_cselect_b64 s[14:15], -1, 0
    s_lshl_b32 s34, s38, 13
    s_add_u32 s45, s45, s34
    s_add_u32 s45, s45, 8192
    s_mov_b32 s3, 0
    s_mov_b32 s56, 262144
    s_add_u32 s39, s34, 0xdc000
    s_lshl_b32 s33, s43, 16
    s_add_u32 s40, s33, 0x200000
    s_add_u32 s41, s33, 0x202000
    s_lshl_b32 s32, s29, 19
    s_add_u32 s32, s32, s34
    s_add_u32 s46, s32, 0xfdc000
    s_add_u32 s47, s32, 0x1fdc000
    s_lshl_b32 s33, s29, 13
    s_sub_u32 s51, s32, s33
    s_add_u32 s51, s51, 0x4d00000
    s_lshl_b32 s32, s28, 10
    s_add_u32 s49, s33, s32
    s_add_u32 s49, s49, 0x2e0000
    s_lshl_b32 s32, s28, 9
    s_add_u32 s50, s32, 0x16800
    s_lshl_b32 s48, s28, 11
    s_add_u32 s48, s48, 0x20000
    s_add_u32 s62, s38, 2
    v_min_u32 v68, v68, v69
    s_nop 0
    v_readfirstlane_b32 s57, v68
    s_nop 3
    s_cmp_ge_u32 s57, s62
    s_cbranch_scc1 L_kv0_7
    s_min_u32 s62, s62, 64
    s_mov_b32 s58, 0
L_kvp_8:
    buffer_load_dwordx2 v[12:13], off, s[4:7], s63 sc1
    s_add_u32 s58, s58, 1
    s_cmp_gt_u32 s58, 262144
    s_cbranch_scc1 L_fail
    s_waitcnt vmcnt(0)
    v_min_u32 v12, v12, v13
    s_nop 0
    v_readfirstlane_b32 s57, v12
    s_nop 3
    s_cmp_lt_u32 s57, s62
    s_cbranch_scc1 L_kvp_8
L_kv0_7:
    s_mov_b32 m0, s48
    buffer_load_dwordx4 v[104:107], v121, s[4:7], s47 offen sc1
    buffer_load_dwordx4 v[108:111], v121, s[4:7], s47 offen offset:1024 sc1
    buffer_load_dwordx4 v121, s[4:7], s46 offen sc1 lds
    buffer_load_dwordx4 v121, s[4:7], s46 offen offset:1024 sc1 lds
    s_add_u32 s46, s46, 8192
    s_add_u32 s47, s47, 8192
    s_xor_b32 s48, s48, 0x2000
    s_mov_b32 m0, s48
    s_add_u32 s59, s45, 8192
    v_mov_b32 v36, 0
    v_mov_b32 v37, 0
    v_mov_b32 v38, 0
    v_mov_b32 v39, 0
    v_mov_b32 v40, 0
    v_mov_b32 v41, 0
    v_mov_b32 v42, 0
    v_mov_b32 v43, 0
    v_mov_b32 v44, 0
    v_mov_b32 v45, 0
    v_mov_b32 v46, 0
    v_mov_b32 v47, 0
    v_mov_b32 v48, 0
    v_mov_b32 v49, 0
    v_mov_b32 v50, 0
    v_mov_b32 v51, 0
    v_mov_b32 v84, 0
    v_mov_b32 v85, 0
    v_mov_b32 v86, 0
    v_mov_b32 v87, 0
    v_mov_b32 v88, 0
    v_mov_b32 v89, 0
    v_mov_b32 v90, 0
    v_mov_b32 v91, 0
    v_xor_b32 v93, 2048, v121
    v_xor_b32 v94, 4096, v121
    v_xor_b32 v95, 6144, v121
    v_lshrrev_b32 v100, 1, v122
    v_add_u32 v100, s50, v100
    v_xor_b32 v101, 16, v124
    s_add_u32 s62, s38, 2
    ds_read_b128 v[52:55], v120 offset:0
    ds_read_b128 v[56:59], v120 offset:1024
    ds_read_b128 v[60:63], v120 offset:2048
    ds_read_b128 v[64:67], v120 offset:3072
    ds_read_b128 v[68:71], v120 offset:4096
    ds_read_b128 v[72:75], v120 offset:5120
    ds_read_b128 v[76:79], v120 offset:6144
    ds_read_b128 v[80:83], v120 offset:7168
    buffer_load_dwordx4 v[4:7], v121, s[4:7], s39 offen sc1
    buffer_load_dwordx4 v[8:11], v121, s[4:7], s39 offen offset:1024 sc1
    s_waitcnt lgkmcnt(0)
L_chain_loops:
    s_cmp_eq_u32 s61, 0
    s_cbranch_scc1 L_slow_9
    s_branch L_step_11
    .p2align 6
L_retA_12:
    s_mov_b64 exec, vcc
    buffer_load_dwordx4 v[4:7], v121, s[4:7], s39 offen sc1
    buffer_load_dwordx4 v[8:11], v121, s[4:7], s39 offen offset:1024 sc1
    s_mov_b64 exec, -1
    s_sub_u32 s56, s56, 1
    s_cbranch_scc1 L_fail
L_step_11:
    s_waitcnt vmcnt(0)
    v_max_u32 v92, v4, v8
    v_cmp_eq_u32 vcc, -1, v92
    s_cbranch_vccnz L_retA_12
L_step_11_ok:
    ds_write_b128 v121, v[4:7]
    ds_write_b128 v121, v[8:11] offset:1024
    v_smfmac_f32_16x16x64_bf16 v[36:39], v[4:7], a[0:7], v3
    v_smfmac_f32_16x16x64_bf16 v[40:43], v[4:7], a[8:15], v3
    v_smfmac_f32_16x16x64_bf16 v[44:47], v[4:7], a[16:23], v3
    v_smfmac_f32_16x16x64_bf16 v[48:51], v[4:7], a[24:31], v3
    buffer_load_dwordx4 v[112:115], v121, s[4:7], s47 offen sc1
    buffer_load_dwordx4 v[116:119], v121, s[4:7], s47 offen offset:1024 sc1
    s_waitcnt lgkmcnt(0)
    s_barrier
    ds_read_b128 v[12:15], v93 offset:0
    v_smfmac_f32_16x16x64_bf16 v[36:39], v[8:11], a[32:39], v3
    ds_read_b128 v[16:19], v93 offset:1024
    v_smfmac_f32_16x16x64_bf16 v[40:43], v[8:11], a[40:47], v3
    ds_read_b128 v[20:23], v94 offset:0
    v_smfmac_f32_16x16x64_bf16 v[44:47], v[8:11], a[48:55], v3
    ds_read_b128 v[24:27], v94 offset:1024
    v_smfmac_f32_16x16x64_bf16 v[48:51], v[8:11], a[56:63], v3
    ds_read_b128 v[28:31], v95 offset:0
    v_smfmac_f32_16x16x64_bf16 v[84:87], v[4:7], v[128:135], v3
    ds_read_b128 v[32:35], v95 offset:1024
    v_smfmac_f32_16x16x64_bf16 v[88:91], v[4:7], v[136:143], v3
    s_waitcnt lgkmcnt(5)
    v_smfmac_f32_16x16x64_bf16 v[36:39], v[12:15], v[52:59], v3
    buffer_load_dwordx4 v121, s[4:7], s46 offen sc1 lds
    v_smfmac_f32_16x16x64_bf16 v[40:43], v[12:15], v[60:67], v3
    ds_read_b128 v[52:55], v120 offset:8192
    v_smfmac_f32_16x16x64_bf16 v[44:47], v[12:15], v[68:75], v3
    buffer_load_dwordx4 v121, s[4:7], s46 offen offset:1024 sc1 lds
    v_smfmac_f32_16x16x64_bf16 v[48:51], v[12:15], v[76:83], v3
    s_waitcnt lgkmcnt(1)
    v_smfmac_f32_16x16x64_bf16 v[36:39], v[16:19], a[64:71], v3
    v_smfmac_f32_16x16x64_bf16 v[40:43], v[16:19], a[72:79], v3
    ds_read_b128 v[56:59], v120 offset:9216
    v_smfmac_f32_16x16x64_bf16 v[44:47], v[16:19], a[80:87], v3
    ds_read_b128 v[60:63], v120 offset:10240
    v_smfmac_f32_16x16x64_bf16 v[48:51], v[16:19], a[88:95], v3
    ds_read_b128 v[64:67], v120 offset:11264
    v_smfmac_f32_16x16x64_bf16 v[36:39], v[20:23], a[96:103], v3
    ds_read_b128 v[68:71], v120 offset:12288
    v_smfmac_f32_16x16x64_bf16 v[40:43], v[20:23], a[104:111], v3
    ds_read_b128 v[72:75], v120 offset:13312
    v_smfmac_f32_16x16x64_bf16 v[44:47], v[20:23], a[112:119], v3
    ds_read_b128 v[76:79], v120 offset:14336
    v_smfmac_f32_16x16x64_bf16 v[48:51], v[20:23], a[120:127], v3
    ds_read_b128 v[80:83], v120 offset:15360
    v_smfmac_f32_16x16x64_bf16 v[36:39], v[24:27], a[128:135], v3
    v_smfmac_f32_16x16x64_bf16 v[40:43], v[24:27], a[136:143], v3
    v_smfmac_f32_16x16x64_bf16 v[44:47], v[24:27], a[144:151], v3
    buffer_load_dword v2, v1, s[4:7], s59 offen sc1
    v_smfmac_f32_16x16x64_bf16 v[48:51], v[24:27], a[152:159], v3
    v_smfmac_f32_16x16x64_bf16 v[36:39], v[32:35], a[160:167], v3
    buffer_load_dword v2, v1, s[4:7], s63 offen sc1
    v_smfmac_f32_16x16x64_bf16 v[40:43], v[32:35], a[168:175], v3
    v_smfmac_f32_16x16x64_bf16 v[44:47], v[32:35], a[176:183], v3
    v_smfmac_f32_16x16x64_bf16 v[48:51], v[32:35], a[184:191], v3
    s_waitcnt lgkmcnt(0)
    v_smfmac_f32_16x16x64_bf16 v[36:39], v[28:31], v[52:59], v3
    s_nop 0
    v_smfmac_f32_16x16x64_bf16 v[40:43], v[28:31], v[60:67], v3
    s_nop 0
    v_smfmac_f32_16x16x64_bf16 v[44:47], v[28:31], v[68:75], v3
    ds_read_b128 v[52:55], v123
    v_smfmac_f32_16x16x64_bf16 v[48:51], v[28:31], v[76:83], v3
    ds_read_b128 v[56:59], v123 offset:1024
    v_smfmac_f32_16x16x64_bf16 v[84:87], v[8:11], v[144:151], v3
    v_add_f32 v36, v36, v38
    v_smfmac_f32_16x16x64_bf16 v[88:91], v[8:11], v[152:159], v3
    v_add_f32 v37, v37, v39
    v_add_f32 v38, v40, v42
    v_add_f32 v39, v41, v43
    v_add_f32 v44, v44, v46
    v_add_f32 v45, v45, v47
    v_cvt_pk_bf16_f32 v40, v36, v38
    v_cvt_pk_bf16_f32 v42, v37, v39
    v_add_f32 v46, v48, v50
    v_add_f32 v47, v49, v51
    v_cvt_pk_bf16_f32 v41, v44, v46
    ds_write_b64 v124, v[40:41]
    v_cvt_pk_bf16_f32 v43, v45, v47
    ds_write_b64 v101, v[42:43]
    v_smfmac_f32_16x16x64_bf16 v[84:87], v[12:15], v[160:167], v3
    v_smfmac_f32_16x16x64_bf16 v[88:91], v[12:15], v[168:175], v3
    ds_read_b128 v[60:63], v123 offset:2048
    v_smfmac_f32_16x16x64_bf16 v[84:87], v[16:19], v[176:183], v3
    ds_read_b128 v[64:67], v123 offset:3072
    v_smfmac_f32_16x16x64_bf16 v[88:91], v[16:19], v[184:191], v3
    buffer_store_dwordx4 v[96:99], v122, s[4:7], s49 offen sc1
    s_waitcnt lgkmcnt(2)
    s_barrier
    ds_read_b128 v[36:39], v125 offset:0
    v_smfmac_f32_16x16x64_bf16 v[84:87], v[20:23], v[192:199], v3
    ds_read_b128 v[40:43], v126 offset:0
    v_smfmac_f32_16x16x64_bf16 v[88:91], v[20:23], v[200:207], v3
    ds_read_b128 v[44:47], v125 offset:1024
    v_smfmac_f32_16x16x64_bf16 v[84:87], v[24:27], v[208:215], v3
    ds_read_b128 v[48:51], v126 offset:1024
    v_smfmac_f32_16x16x64_bf16 v[88:91], v[24:27], v[216:223], v3
    ds_read_b128 v[4:7], v123 offset:4096
    v_smfmac_f32_16x16x64_bf16 v[84:87], v[28:31], v[224:231], v3
    ds_read_b128 v[8:11], v123 offset:5120
    v_smfmac_f32_16x16x64_bf16 v[88:91], v[28:31], v[232:239], v3
    ds_read_b128 v[12:15], v123 offset:6144
    v_smfmac_f32_16x16x64_bf16 v[84:87], v[32:35], v[240:247], v3
    ds_read_b128 v[16:19], v123 offset:7168
    v_smfmac_f32_16x16x64_bf16 v[88:91], v[32:35], v[248:255], v3
    s_waitcnt lgkmcnt(4)
    v_mfma_f32_16x16x32_bf16 v[92:95], v[52:55], v[36:39], 0
    ds_read_b128 v[20:23], v125 offset:2048
    v_mfma_f32_16x16x32_bf16 v[92:95], v[56:59], v[40:43], v[92:95]
    ds_read_b128 v[24:27], v126 offset:2048
    v_mfma_f32_16x16x32_bf16 v[92:95], v[60:63], v[44:47], v[92:95]
    ds_read_b128 v[28:31], v125 offset:3072
    v_mfma_f32_16x16x32_bf16 v[92:95], v[64:67], v[48:51], v[92:95]
    ds_read_b128 v[32:35], v126 offset:3072
    s_waitcnt lgkmcnt(4)
    v_mfma_f32_16x16x32_bf16 v[96:99], v[4:7], v[36:39], 0
    v_add_f32 v84, v84, v86
    ds_read_b128 v[68:71], v120 offset:20480
    v_mfma_f32_16x16x32_bf16 v[96:99], v[8:11], v[40:43], v[96:99]
    v_add_f32 v85, v85, v87
    ds_read_b128 v[72:75], v120 offset:21504
    v_mfma_f32_16x16x32_bf16 v[96:99], v[12:15], v[44:47], v[96:99]
    v_add_f32 v86, v88, v90
    ds_read_b128 v[76:79], v120 offset:22528
    v_mfma_f32_16x16x32_bf16 v[96:99], v[16:19], v[48:51], v[96:99]
    v_add_f32 v87, v89, v91
    s_waitcnt lgkmcnt(3)
    v_mfma_f32_16x16x32_bf16 v[100:103], v[20:23], v[36:39], 0
    v_cvt_pk_bf16_f32 v88, v84, v85
    ds_read_b128 v[80:83], v120 offset:23552
    v_mfma_f32_16x16x32_bf16 v[100:103], v[24:27], v[40:43], v[100:103]
    v_cvt_pk_bf16_f32 v89, v86, v87
    ds_read_b128 v[52:55], v120 offset:16384
    v_mfma_f32_16x16x32_bf16 v[100:103], v[28:31], v[44:47], v[100:103]
    v_max3_f32 v14, v92, v93, v94
    ds_read_b128 v[56:59], v120 offset:17408
    v_mfma_f32_16x16x32_bf16 v[100:103], v[32:35], v[48:51], v[100:103]
    v_max3_f32 v15, v97, v98, v99
    ds_read_b128 v[60:63], v120 offset:18432
    v_max3_f32 v14, v14, v95, v96
    v_cvt_pk_bf16_f32 v90, v86, v87
    v_cvt_pk_bf16_f32 v91, v84, v85
    v_max_f32 v14, v14, v15
    v_mov_b32 v9, 0
    ds_read_b128 v[64:67], v120 offset:19456
    s_nop 1
    v_max3_f32 v15, v14, v100, v101
    v_max3_f32 v14, v14, v100, v101
    v_mov_b64 v[36:37], 0
    v_mov_b64 v[38:39], 0
    v_permlane16_swap_b32 v14, v15
    v_max_f32 v16, v14, v15
    v_max_f32 v14, v14, v15
    v_mov_b64 v[40:41], 0
    v_mov_b64 v[42:43], 0
    v_permlane32_swap_b32 v14, v16
    v_max_f32 v14, v14, v16
    v_mul_f32 v16, s52, v14
    v_pk_fma_f32 v[92:93], v[92:93], s[52:53], v[16:17] op_sel_hi:[1,1,0] neg_lo:[0,0,1] neg_hi:[0,0,1]
    v_pk_fma_f32 v[94:95], v[94:95], s[52:53], v[16:17] op_sel_hi:[1,1,0] neg_lo:[0,0,1] neg_hi:[0,0,1]
    v_pk_fma_f32 v[96:97], v[96:97], s[52:53], v[16:17] op_sel_hi:[1,1,0] neg_lo:[0,0,1] neg_hi:[0,0,1]
    v_pk_fma_f32 v[98:99], v[98:99], s[52:53], v[16:17] op_sel_hi:[1,1,0] neg_lo:[0,0,1] neg_hi:[0,0,1]
    v_pk_fma_f32 v[100:101], v[100:101], s[52:53], v[16:17] op_sel_hi:[1,1,0] neg_lo:[0,0,1] neg_hi:[0,0,1]
    v_exp_f32 v92, v92
    v_exp_f32 v93, v93
    v_exp_f32 v94, v94
    v_exp_f32 v95, v95
    v_cvt_pk_bf16_f32 v4, v92, v93
    v_exp_f32 v96, v96
    v_exp_f32 v97, v97
    v_cvt_pk_bf16_f32 v5, v94, v95
    v_exp_f32 v98, v98
    v_exp_f32 v99, v99
    v_cvt_pk_bf16_f32 v6, v96, v97
    v_exp_f32 v100, v100
    v_exp_f32 v101, v101
    v_cvt_pk_bf16_f32 v7, v98, v99
    v_pk_add_f32 v[92:93], v[92:93], v[94:95]
    v_cvt_pk_bf16_f32 v8, v100, v101
    v_mfma_f32_16x16x32_bf16 v[20:23], v[104:107], v[4:7], 0
    v_add_f32 v96, v96, v98
    v_add_f32 v97, v97, v99
    v_mfma_f32_16x16x32_bf16 v[24:27], v[108:111], v[4:7], 0
    v_add_f32 v92, v92, v100
    v_add_f32 v93, v93, v101
    v_mfma_f32_16x16x16_bf16 v[20:23], v[88:89], v[8:9], v[20:23]
    v_add_f32 v96, v96, v97
    v_add_f32 v92, v92, v93
    v_mfma_f32_16x16x16_bf16 v[24:27], v[90:91], v[8:9], v[24:27]
    v_add_f32 v17, v92, v96
    v_add_f32 v18, v92, v96
    s_add_u32 s38, s38, 1
    v_mov_b64 v[44:45], 0
    v_permlane16_swap_b32 v17, v18
    v_add_f32 v15, v17, v18
    v_add_f32 v18, v17, v18
    v_mov_b64 v[46:47], 0
    v_mov_b64 v[48:49], 0
    v_permlane32_swap_b32 v15, v18
    v_add_f32 v17, v15, v18
    v_rcp_f32 v16, v17
    v_mov_b64 v[50:51], 0
    v_pk_mul_f32 v[20:21], v[20:21], v[16:17] op_sel_hi:[1,0]
    v_pk_mul_f32 v[22:23], v[22:23], v[16:17] op_sel_hi:[1,0]
    v_pk_mul_f32 v[24:25], v[24:25], v[16:17] op_sel_hi:[1,0]
    v_pk_mul_f32 v[26:27], v[26:27], v[16:17] op_sel_hi:[1,0]
    v_cvt_pk_bf16_f32 v28, v20, v24
    v_cvt_pk_bf16_f32 v29, v21, v25
    v_cvt_pk_bf16_f32 v30, v22, v26
    v_cvt_pk_bf16_f32 v31, v23, v27
    ds_write_b128 v127, v[28:31]
    v_xor_b32 v93, 512, v127
    v_smfmac_f32_16x16x64_bf16 v[44:47], v[28:31], a[208:215], v3
    v_xor_b32 v94, 1024, v127
    s_add_u32 s46, s46, 8192
    v_smfmac_f32_16x16x64_bf16 v[36:39], v[28:31], a[192:199], v3
    v_xor_b32 v95, 1536, v127
    s_add_u32 s39, s39, 8192
    v_smfmac_f32_16x16x64_bf16 v[48:51], v[28:31], a[216:223], v3
    ds_read_b128 v[4:7], v120 offset:24576
    ds_read_b128 v[8:11], v120 offset:25600
    ds_read_b128 v[12:15], v120 offset:26624
    ds_read_b128 v[16:19], v120 offset:27648
    s_waitcnt lgkmcnt(4)
    s_barrier
    ds_read_b128 v[104:107], v93
    ds_read_b128 v[108:111], v94
    ds_read_b128 v[32:35], v95
    v_smfmac_f32_16x16x64_bf16 v[40:43], v[28:31], a[200:207], v3
    v_lshrrev_b32 v100, 1, v122
    v_mov_b64 v[102:103], v[88:89]
    v_add_u32 v100, s50, v100
    v_xor_b32 v123, 0x2000, v123
    v_xor_b32 v101, 16, v124
    s_waitcnt lgkmcnt(2)
    v_smfmac_f32_16x16x64_bf16 v[44:47], v[104:107], v[52:59], v3
    v_smfmac_f32_16x16x64_bf16 v[36:39], v[104:107], v[76:83], v3
    s_waitcnt lgkmcnt(1)
    v_smfmac_f32_16x16x64_bf16 v[44:47], v[108:111], v[60:67], v3
    ds_read_b128 v[52:55], v120 offset:28672
    s_waitcnt lgkmcnt(1)
    v_smfmac_f32_16x16x64_bf16 v[36:39], v[108:111], v[4:11], v3
    ds_read_b128 v[56:59], v120 offset:29696
    v_smfmac_f32_16x16x64_bf16 v[44:47], v[32:35], v[68:75], v3
    ds_read_b128 v[60:63], v120 offset:30720
    v_smfmac_f32_16x16x64_bf16 v[36:39], v[32:35], v[12:19], v3
    ds_read_b128 v[64:67], v120 offset:31744
    v_smfmac_f32_16x16x64_bf16 v[48:51], v[104:107], a[224:231], v3
    v_xor_b32 v93, 2048, v121
    v_smfmac_f32_16x16x64_bf16 v[40:43], v[104:107], a[248:255], v3
    v_xor_b32 v94, 4096, v121
    v_smfmac_f32_16x16x64_bf16 v[48:51], v[108:111], a[232:239], v3
    s_waitcnt lgkmcnt(0)
    v_cvt_pk_bf16_f32 v84, v44, v45
    v_cvt_pk_bf16_f32 v85, v46, v47
    v_cvt_pk_bf16_f32 v86, v36, v37
    v_cvt_pk_bf16_f32 v87, v38, v39
    v_bfi_b32 v84, 1, s3, v84
    v_smfmac_f32_16x16x64_bf16 v[40:43], v[108:111], v[52:59], v3
    buffer_store_dwordx4 v[84:87], v0, s[4:7], s40 offen
    v_smfmac_f32_16x16x64_bf16 v[48:51], v[32:35], a[240:247], v3
    v_xor_b32 v95, 6144, v121
    v_smfmac_f32_16x16x64_bf16 v[40:43], v[32:35], v[60:67], v3
    ds_read_b128 v[96:99], v122 offset:30720
    ds_read_b128 v[68:71], v120 offset:4096
    ds_read_b128 v[72:75], v120 offset:5120
    ds_read_b128 v[76:79], v120 offset:6144
    ds_read_b128 v[80:83], v120 offset:7168
    s_xor_b32 s48, s48, 0x2000
    v_cvt_pk_bf16_f32 v88, v48, v49
    v_cvt_pk_bf16_f32 v89, v50, v51
    v_bfi_b32 v88, 1, s3, v88
    v_cvt_pk_bf16_f32 v91, v42, v43
    v_cvt_pk_bf16_f32 v90, v40, v41
    buffer_store_dwordx4 v[88:91], v0, s[4:7], s41 offen
    ds_read_b128 v[52:55], v120 offset:0
    ds_read_b128 v[56:59], v120 offset:1024
    ds_read_b128 v[60:63], v120 offset:2048
    ds_read_b128 v[64:67], v120 offset:3072
    s_mov_b32 s56, 262144
    s_add_u32 s47, s47, 8192
    s_add_u32 s49, s49, s51
    s_mov_b32 s51, 8192
    s_nop 15
    s_nop 15
    s_nop 15
    s_nop 15
    s_nop 7
    buffer_load_dwordx4 v[20:23], v122, s[4:7], s44 offen offset:0 sc1
    buffer_load_dwordx4 v[24:27], v122, s[4:7], s44 offen offset:1024 sc1
    v_mov_b64 v[84:85], 0
    v_mov_b64 v[86:87], 0
    v_mov_b64 v[88:89], 0
    v_mov_b64 v[90:91], 0
    v_mov_b64 v[36:37], 0
    v_mov_b64 v[38:39], 0
    v_mov_b64 v[40:41], 0
    v_mov_b64 v[42:43], 0
    v_mov_b64 v[44:45], 0
    v_mov_b64 v[46:47], 0
    v_mov_b64 v[48:49], 0
    v_mov_b64 v[50:51], 0
    s_waitcnt vmcnt(9)
    v_mov_b64 v[104:105], v[112:113]
    v_mov_b64 v[106:107], v[114:115]
    v_mov_b64 v[108:109], v[116:117]
    v_mov_b64 v[110:111], v[118:119]
    s_waitcnt lgkmcnt(8)
    s_branch L_okB_14
    .p2align 6
L_retB_13:
    s_mov_b64 exec, vcc
    buffer_load_dwordx4 v[20:23], v122, s[4:7], s44 offen offset:0 sc1
    buffer_load_dwordx4 v[24:27], v122, s[4:7], s44 offen offset:1024 sc1
    s_mov_b64 exec, -1
    s_sub_u32 s56, s56, 1
    s_cbranch_scc1 L_fail
L_okB_14:
    s_waitcnt vmcnt(1)
    v_mfma_f32_16x16x32_bf16 v[12:15], v[96:99], v[20:23], 0
    s_waitcnt vmcnt(0)
    v_mfma_f32_16x16x32_bf16 v[12:15], v[96:99], v[24:27], v[12:15]
    v_bitop3_b32 v92, v20, v24, s3 bitop3:0x7e
    v_and_b32 v92, 1, v92
    v_cmp_ne_u32 vcc, 0, v92
    s_cbranch_vccnz L_retB_13
L_okB_14_ok:
    s_mov_b32 s56, 262144
    v_readlane_b32 s57, v2, 0
    v_readlane_b32 s60, v2, 1
    s_xor_b32 s3, s3, 1
    v_add_f32_dpp v12, v12, v12 row_ror:4 row_mask:0xf bank_mask:0xf
    v_add_f32_dpp v13, v13, v13 row_ror:4 row_mask:0xf bank_mask:0xf
    s_nop 0
    v_add_f32_dpp v12, v12, v12 row_ror:8 row_mask:0xf bank_mask:0xf
    v_add_f32_dpp v13, v13, v13 row_ror:8 row_mask:0xf bank_mask:0xf
    v_cvt_pk_bf16_f32 v92, v12, v13
    buffer_store_dword v92, v1, s[4:7], s45 offen
    s_mov_b64 exec, -1
    s_add_u32 s45, s45, 8192
    s_min_u32 s57, s57, s60
    s_add_u32 s62, s38, 2
    s_min_u32 s62, s62, 64
    ds_read_b64 v[96:97], v100
    v_mov_b64 v[98:99], v[102:103]
    s_nop 15
    s_nop 15
    s_nop 15
    s_nop 15
    s_nop 7
    buffer_load_dwordx4 v[4:7], v121, s[4:7], s39 offen sc1
    buffer_load_dwordx4 v[8:11], v121, s[4:7], s39 offen offset:1024 sc1
    s_cmp_lt_u32 s57, s62
    s_cbranch_scc1 L_kvs_15
L_kvb_16:
    s_mov_b32 m0, s48
    s_add_u32 s59, s45, 8192
    s_waitcnt lgkmcnt(0)
    s_cmp_lt_u32 s38, s42
    s_cbranch_scc1 L_step_11
    s_branch L_fin_17
    .p2align 6
L_retA2_18:
    s_mov_b64 exec, vcc
    buffer_load_dwordx4 v[4:7], v121, s[4:7], s39 offen sc1
    buffer_load_dwordx4 v[8:11], v121, s[4:7], s39 offen offset:1024 sc1
    s_mov_b64 exec, -1
    s_sub_u32 s56, s56, 1
    s_cbranch_scc1 L_fail
L_fin_17:
    s_waitcnt vmcnt(0)
    v_max_u32 v92, v4, v8
    v_cmp_eq_u32 vcc, -1, v92
    s_cbranch_vccnz L_retA2_18
L_fin_17_ok:
    ds_write_b128 v121, v[4:7]
    ds_write_b128 v121, v[8:11] offset:1024
    v_smfmac_f32_16x16x64_bf16 v[36:39], v[4:7], a[0:7], v3
    v_smfmac_f32_16x16x64_bf16 v[40:43], v[4:7], a[8:15], v3
    v_smfmac_f32_16x16x64_bf16 v[44:47], v[4:7], a[16:23], v3
    v_smfmac_f32_16x16x64_bf16 v[48:51], v[4:7], a[24:31], v3
    s_waitcnt lgkmcnt(0)
    s_barrier
    ds_read_b128 v[12:15], v93 offset:0
    v_smfmac_f32_16x16x64_bf16 v[36:39], v[8:11], a[32:39], v3
    ds_read_b128 v[16:19], v93 offset:1024
    v_smfmac_f32_16x16x64_bf16 v[40:43], v[8:11], a[40:47], v3
    ds_read_b128 v[20:23], v94 offset:0
    v_smfmac_f32_16x16x64_bf16 v[44:47], v[8:11], a[48:55], v3
    ds_read_b128 v[24:27], v94 offset:1024
    v_smfmac_f32_16x16x64_bf16 v[48:51], v[8:11], a[56:63], v3
    ds_read_b128 v[28:31], v95 offset:0
    v_smfmac_f32_16x16x64_bf16 v[84:87], v[4:7], v[128:135], v3
    ds_read_b128 v[32:35], v95 offset:1024
    v_smfmac_f32_16x16x64_bf16 v[88:91], v[4:7], v[136:143], v3
    s_waitcnt lgkmcnt(5)
    v_smfmac_f32_16x16x64_bf16 v[36:39], v[12:15], v[52:59], v3
    v_smfmac_f32_16x16x64_bf16 v[40:43], v[12:15], v[60:67], v3
    ds_read_b128 v[52:55], v120 offset:8192
    v_smfmac_f32_16x16x64_bf16 v[44:47], v[12:15], v[68:75], v3
    v_smfmac_f32_16x16x64_bf16 v[48:51], v[12:15], v[76:83], v3
    s_waitcnt lgkmcnt(1)
    v_smfmac_f32_16x16x64_bf16 v[36:39], v[16:19], a[64:71], v3
    v_smfmac_f32_16x16x64_bf16 v[40:43], v[16:19], a[72:79], v3
    ds_read_b128 v[56:59], v120 offset:9216
    v_smfmac_f32_16x16x64_bf16 v[44:47], v[16:19], a[80:87], v3
    ds_read_b128 v[60:63], v120 offset:10240
    v_smfmac_f32_16x16x64_bf16 v[48:51], v[16:19], a[88:95], v3
    ds_read_b128 v[64:67], v120 offset:11264
    v_smfmac_f32_16x16x64_bf16 v[36:39], v[20:23], a[96:103], v3
    ds_read_b128 v[68:71], v120 offset:12288
    v_smfmac_f32_16x16x64_bf16 v[40:43], v[20:23], a[104:111], v3
    ds_read_b128 v[72:75], v120 offset:13312
    v_smfmac_f32_16x16x64_bf16 v[44:47], v[20:23], a[112:119], v3
    ds_read_b128 v[76:79], v120 offset:14336
    v_smfmac_f32_16x16x64_bf16 v[48:51], v[20:23], a[120:127], v3
    ds_read_b128 v[80:83], v120 offset:15360
    v_smfmac_f32_16x16x64_bf16 v[36:39], v[24:27], a[128:135], v3
    v_smfmac_f32_16x16x64_bf16 v[40:43], v[24:27], a[136:143], v3
    v_smfmac_f32_16x16x64_bf16 v[44:47], v[24:27], a[144:151], v3
    v_smfmac_f32_16x16x64_bf16 v[48:51], v[24:27], a[152:159], v3
    v_smfmac_f32_16x16x64_bf16 v[36:39], v[32:35], a[160:167], v3
    v_smfmac_f32_16x16x64_bf16 v[40:43], v[32:35], a[168:175], v3
    v_smfmac_f32_16x16x64_bf16 v[44:47], v[32:35], a[176:183], v3
    v_smfmac_f32_16x16x64_bf16 v[48:51], v[32:35], a[184:191], v3
    s_waitcnt lgkmcnt(0)
    v_smfmac_f32_16x16x64_bf16 v[36:39], v[28:31], v[52:59], v3
    s_nop 0
    v_smfmac_f32_16x16x64_bf16 v[40:43], v[28:31], v[60:67], v3
    s_nop 0
    v_smfmac_f32_16x16x64_bf16 v[44:47], v[28:31], v[68:75], v3
    s_nop 0
    v_smfmac_f32_16x16x64_bf16 v[48:51], v[28:31], v[76:83], v3
    s_nop 0
    v_smfmac_f32_16x16x64_bf16 v[84:87], v[8:11], v[144:151], v3
    v_add_f32 v36, v36, v38
    v_smfmac_f32_16x16x64_bf16 v[88:91], v[8:11], v[152:159], v3
    v_add_f32 v37, v37, v39
    v_add_f32 v38, v40, v42
    v_add_f32 v39, v41, v43
    v_add_f32 v44, v44, v46
    v_add_f32 v45, v45, v47
    v_cvt_pk_bf16_f32 v40, v36, v38
    v_cvt_pk_bf16_f32 v42, v37, v39
    v_add_f32 v46, v48, v50
    v_add_f32 v47, v49, v51
    v_cvt_pk_bf16_f32 v41, v44, v46
    ds_write_b64 v124, v[40:41]
    v_cvt_pk_bf16_f32 v43, v45, v47
    ds_write_b64 v101, v[42:43]
    v_smfmac_f32_16x16x64_bf16 v[84:87], v[12:15], v[160:167], v3
    v_smfmac_f32_16x16x64_bf16 v[88:91], v[12:15], v[168:175], v3
    buffer_store_dwordx4 v[96:99], v122, s[4:7], s49 offen sc1
    v_smfmac_f32_16x16x64_bf16 v[84:87], v[16:19], v[176:183], v3
    v_smfmac_f32_16x16x64_bf16 v[88:91], v[16:19], v[184:191], v3
    s_waitcnt lgkmcnt(0)
    s_barrier
    ds_read_b64 v[96:97], v100
    v_smfmac_f32_16x16x64_bf16 v[84:87], v[20:23], v[192:199], v3
    v_smfmac_f32_16x16x64_bf16 v[88:91], v[20:23], v[200:207], v3
    v_smfmac_f32_16x16x64_bf16 v[84:87], v[24:27], v[208:215], v3
    v_smfmac_f32_16x16x64_bf16 v[88:91], v[24:27], v[216:223], v3
    v_smfmac_f32_16x16x64_bf16 v[84:87], v[28:31], v[224:231], v3
    v_smfmac_f32_16x16x64_bf16 v[88:91], v[28:31], v[232:239], v3
    v_smfmac_f32_16x16x64_bf16 v[84:87], v[32:35], v[240:247], v3
    v_smfmac_f32_16x16x64_bf16 v[88:91], v[32:35], v[248:255], v3
    s_add_u32 s49, s49, s51
    s_nop 6
    v_add_f32 v84, v84, v86
    v_add_f32 v85, v85, v87
    v_add_f32 v86, v88, v90
    v_add_f32 v87, v89, v91
    v_cvt_pk_bf16_f32 v98, v84, v85
    v_cvt_pk_bf16_f32 v99, v86, v87
    s_waitcnt lgkmcnt(0)
    buffer_store_dwordx4 v[96:99], v122, s[4:7], s49 offen sc1
    s_branch L_chdone_10
L_kvs_15:
    s_min_u32 s62, s62, 64
    s_mov_b32 s58, 0
L_kvp_19:
    buffer_load_dwordx2 v[12:13], off, s[4:7], s63 sc1
    s_add_u32 s58, s58, 1
    s_cmp_gt_u32 s58, 262144
    s_cbranch_scc1 L_fail
    s_waitcnt vmcnt(0)
    v_min_u32 v12, v12, v13
    s_nop 0
    v_readfirstlane_b32 s57, v12
    s_nop 3
    s_cmp_lt_u32 s57, s62
    s_cbranch_scc1 L_kvp_19
    s_branch L_kvb_16
L_slow_9:
    s_branch L_step_20
    .p2align 6
L_retA_21:
    s_mov_b64 exec, vcc
    buffer_load_dwordx4 v[4:7], v121, s[4:7], s39 offen sc1
    buffer_load_dwordx4 v[8:11], v121, s[4:7], s39 offen offset:1024 sc1
    s_mov_b64 exec, -1
    s_sub_u32 s56, s56, 1
    s_cbranch_scc1 L_fail
L_step_20:
    s_waitcnt vmcnt(0)
    v_max3_u32 v92, v4, v5, v6
    v_max3_u32 v2, v7, v8, v9
    v_max3_u32 v92, v92, v10, v11
    v_max_u32 v92, v92, v2
    v_cmp_eq_u32 vcc, -1, v92
    s_cbranch_vccnz L_retA_21
L_step_20_ok:
    ds_write_b128 v121, v[4:7]
    ds_write_b128 v121, v[8:11] offset:1024
    v_smfmac_f32_16x16x64_bf16 v[36:39], v[4:7], a[0:7], v3
    v_smfmac_f32_16x16x64_bf16 v[40:43], v[4:7], a[8:15], v3
    v_smfmac_f32_16x16x64_bf16 v[44:47], v[4:7], a[16:23], v3
    v_smfmac_f32_16x16x64_bf16 v[48:51], v[4:7], a[24:31], v3
    buffer_load_dwordx4 v[112:115], v121, s[4:7], s47 offen sc1
    buffer_load_dwordx4 v[116:119], v121, s[4:7], s47 offen offset:1024 sc1
    s_waitcnt lgkmcnt(0)
    s_barrier
    ds_read_b128 v[12:15], v93 offset:0
    v_smfmac_f32_16x16x64_bf16 v[36:39], v[8:11], a[32:39], v3
    ds_read_b128 v[16:19], v93 offset:1024
    v_smfmac_f32_16x16x64_bf16 v[40:43], v[8:11], a[40:47], v3
    ds_read_b128 v[20:23], v94 offset:0
    v_smfmac_f32_16x16x64_bf16 v[44:47], v[8:11], a[48:55], v3
    ds_read_b128 v[24:27], v94 offset:1024
    v_smfmac_f32_16x16x64_bf16 v[48:51], v[8:11], a[56:63], v3
    ds_read_b128 v[28:31], v95 offset:0
    v_smfmac_f32_16x16x64_bf16 v[84:87], v[4:7], v[128:135], v3
    ds_read_b128 v[32:35], v95 offset:1024
    v_smfmac_f32_16x16x64_bf16 v[88:91], v[4:7], v[136:143], v3
    s_waitcnt lgkmcnt(5)
    v_smfmac_f32_16x16x64_bf16 v[36:39], v[12:15], v[52:59], v3
    buffer_load_dwordx4 v121, s[4:7], s46 offen sc1 lds
    v_smfmac_f32_16x16x64_bf16 v[40:43], v[12:15], v[60:67], v3
    ds_read_b128 v[52:55], v120 offset:8192
    v_smfmac_f32_16x16x64_bf16 v[44:47], v[12:15], v[68:75], v3
    buffer_load_dwordx4 v121, s[4:7], s46 offen offset:1024 sc1 lds
    v_smfmac_f32_16x16x64_bf16 v[48:51], v[12:15], v[76:83], v3
    s_waitcnt lgkmcnt(1)
    v_smfmac_f32_16x16x64_bf16 v[36:39], v[16:19], a[64:71], v3
    v_smfmac_f32_16x16x64_bf16 v[40:43], v[16:19], a[72:79], v3
    ds_read_b128 v[56:59], v120 offset:9216
    v_smfmac_f32_16x16x64_bf16 v[44:47], v[16:19], a[80:87], v3
    ds_read_b128 v[60:63], v120 offset:10240
    v_smfmac_f32_16x16x64_bf16 v[48:51], v[16:19], a[88:95], v3
    ds_read_b128 v[64:67], v120 offset:11264
    v_smfmac_f32_16x16x64_bf16 v[36:39], v[20:23], a[96:103], v3
    ds_read_b128 v[68:71], v120 offset:12288
    v_smfmac_f32_16x16x64_bf16 v[40:43], v[20:23], a[104:111], v3
    ds_read_b128 v[72:75], v120 offset:13312
    v_smfmac_f32_16x16x64_bf16 v[44:47], v[20:23], a[112:119], v3
    ds_read_b128 v[76:79], v120 offset:14336
    v_smfmac_f32_16x16x64_bf16 v[48:51], v[20:23], a[120:127], v3
    ds_read_b128 v[80:83], v120 offset:15360
    v_smfmac_f32_16x16x64_bf16 v[36:39], v[24:27], a[128:135], v3
    v_smfmac_f32_16x16x64_bf16 v[40:43], v[24:27], a[136:143], v3
    v_smfmac_f32_16x16x64_bf16 v[44:47], v[24:27], a[144:151], v3
    buffer_load_dword v2, v1, s[4:7], s59 offen sc1
    v_smfmac_f32_16x16x64_bf16 v[48:51], v[24:27], a[152:159], v3
    v_smfmac_f32_16x16x64_bf16 v[36:39], v[32:35], a[160:167], v3
    buffer_load_dword v2, v1, s[4:7], s63 offen sc1
    v_smfmac_f32_16x16x64_bf16 v[40:43], v[32:35], a[168:175], v3
    v_smfmac_f32_16x16x64_bf16 v[44:47], v[32:35], a[176:183], v3
    v_smfmac_f32_16x16x64_bf16 v[48:51], v[32:35], a[184:191], v3
    s_waitcnt lgkmcnt(0)
    v_smfmac_f32_16x16x64_bf16 v[36:39], v[28:31], v[52:59], v3
    s_nop 0
    v_smfmac_f32_16x16x64_bf16 v[40:43], v[28:31], v[60:67], v3
    s_nop 0
    v_smfmac_f32_16x16x64_bf16 v[44:47], v[28:31], v[68:75], v3
    ds_read_b128 v[52:55], v123
    v_smfmac_f32_16x16x64_bf16 v[48:51], v[28:31], v[76:83], v3
    ds_read_b128 v[56:59], v123 offset:1024
    v_smfmac_f32_16x16x64_bf16 v[84:87], v[8:11], v[144:151], v3
    v_add_f32 v36, v36, v38
    v_smfmac_f32_16x16x64_bf16 v[88:91], v[8:11], v[152:159], v3
    v_add_f32 v37, v37, v39
    v_add_f32 v38, v40, v42
    v_add_f32 v39, v41, v43
    v_add_f32 v44, v44, v46
    v_add_f32 v45, v45, v47
    v_cvt_pk_bf16_f32 v40, v36, v38
    v_cvt_pk_bf16_f32 v42, v37, v39
    v_add_f32 v46, v48, v50
    v_add_f32 v47, v49, v51
    v_cvt_pk_bf16_f32 v41, v44, v46
    ds_write_b64 v124, v[40:41]
    v_cvt_pk_bf16_f32 v43, v45, v47
    ds_write_b64 v101, v[42:43]
    v_smfmac_f32_16x16x64_bf16 v[84:87], v[12:15], v[160:167], v3
    v_smfmac_f32_16x16x64_bf16 v[88:91], v[12:15], v[168:175], v3
    ds_read_b128 v[60:63], v123 offset:2048
    v_smfmac_f32_16x16x64_bf16 v[84:87], v[16:19], v[176:183], v3
    ds_read_b128 v[64:67], v123 offset:3072
    v_smfmac_f32_16x16x64_bf16 v[88:91], v[16:19], v[184:191], v3
    buffer_store_dwordx4 v[96:99], v122, s[4:7], s49 offen sc1
    s_waitcnt lgkmcnt(2)
    s_barrier
    ds_read_b128 v[36:39], v125 offset:0
    v_smfmac_f32_16x16x64_bf16 v[84:87], v[20:23], v[192:199], v3
    ds_read_b128 v[40:43], v126 offset:0
    v_smfmac_f32_16x16x64_bf16 v[88:91], v[20:23], v[200:207], v3
    ds_read_b128 v[44:47], v125 offset:1024
    v_smfmac_f32_16x16x64_bf16 v[84:87], v[24:27], v[208:215], v3
    ds_read_b128 v[48:51], v126 offset:1024
    v_smfmac_f32_16x16x64_bf16 v[88:91], v[24:27], v[216:223], v3
    ds_read_b128 v[4:7], v123 offset:4096
    v_smfmac_f32_16x16x64_bf16 v[84:87], v[28:31], v[224:231], v3
    ds_read_b128 v[8:11], v123 offset:5120
    v_smfmac_f32_16x16x64_bf16 v[88:91], v[28:31], v[232:239], v3
    ds_read_b128 v[12:15], v123 offset:6144
    v_smfmac_f32_16x16x64_bf16 v[84:87], v[32:35], v[240:247], v3
    ds_read_b128 v[16:19], v123 offset:7168
    v_smfmac_f32_16x16x64_bf16 v[88:91], v[32:35], v[248:255], v3
    s_waitcnt lgkmcnt(4)
    v_mfma_f32_16x16x32_bf16 v[92:95], v[52:55], v[36:39], 0
    ds_read_b128 v[20:23], v125 offset:2048
    v_mfma_f32_16x16x32_bf16 v[92:95], v[56:59], v[40:43], v[92:95]
    ds_read_b128 v[24:27], v126 offset:2048
    v_mfma_f32_16x16x32_bf16 v[92:95], v[60:63], v[44:47], v[92:95]
    ds_read_b128 v[28:31], v125 offset:3072
    v_mfma_f32_16x16x32_bf16 v[92:95], v[64:67], v[48:51], v[92:95]
    ds_read_b128 v[32:35], v126 offset:3072
    s_waitcnt lgkmcnt(4)
    v_mfma_f32_16x16x32_bf16 v[96:99], v[4:7], v[36:39], 0
    v_add_f32 v84, v84, v86
    ds_read_b128 v[68:71], v120 offset:20480
    v_mfma_f32_16x16x32_bf16 v[96:99], v[8:11], v[40:43], v[96:99]
    v_add_f32 v85, v85, v87
    ds_read_b128 v[72:75], v120 offset:21504
    v_mfma_f32_16x16x32_bf16 v[96:99], v[12:15], v[44:47], v[96:99]
    v_add_f32 v86, v88, v90
    ds_read_b128 v[76:79], v120 offset:22528
    v_mfma_f32_16x16x32_bf16 v[96:99], v[16:19], v[48:51], v[96:99]
    v_add_f32 v87, v89, v91
    s_waitcnt lgkmcnt(3)
    v_mfma_f32_16x16x32_bf16 v[100:103], v[20:23], v[36:39], 0
    v_cvt_pk_bf16_f32 v88, v84, v85
    ds_read_b128 v[80:83], v120 offset:23552
    v_mfma_f32_16x16x32_bf16 v[100:103], v[24:27], v[40:43], v[100:103]
    v_cvt_pk_bf16_f32 v89, v86, v87
    ds_read_b128 v[52:55], v120 offset:16384
    v_mfma_f32_16x16x32_bf16 v[100:103], v[28:31], v[44:47], v[100:103]
    v_max3_f32 v14, v92, v93, v94
    ds_read_b128 v[56:59], v120 offset:17408
    v_mfma_f32_16x16x32_bf16 v[100:103], v[32:35], v[48:51], v[100:103]
    v_max3_f32 v15, v97, v98, v99
    ds_read_b128 v[60:63], v120 offset:18432
    v_max3_f32 v14, v14, v95, v96
    v_cvt_pk_bf16_f32 v90, v86, v87
    v_cvt_pk_bf16_f32 v91, v84, v85
    v_max_f32 v14, v14, v15
    v_mov_b32 v9, 0
    ds_read_b128 v[64:67], v120 offset:19456
    s_nop 1
    v_max3_f32 v15, v14, v100, v101
    v_max3_f32 v14, v14, v100, v101
    v_mov_b64 v[36:37], 0
    v_mov_b64 v[38:39], 0
    v_permlane16_swap_b32 v14, v15
    v_max_f32 v16, v14, v15
    v_max_f32 v14, v14, v15
    v_mov_b64 v[40:41], 0
    v_mov_b64 v[42:43], 0
    v_permlane32_swap_b32 v14, v16
    v_max_f32 v14, v14, v16
    v_mul_f32 v16, s52, v14
    v_pk_fma_f32 v[92:93], v[92:93], s[52:53], v[16:17] op_sel_hi:[1,1,0] neg_lo:[0,0,1] neg_hi:[0,0,1]
    v_pk_fma_f32 v[94:95], v[94:95], s[52:53], v[16:17] op_sel_hi:[1,1,0] neg_lo:[0,0,1] neg_hi:[0,0,1]
    v_pk_fma_f32 v[96:97], v[96:97], s[52:53], v[16:17] op_sel_hi:[1,1,0] neg_lo:[0,0,1] neg_hi:[0,0,1]
    v_pk_fma_f32 v[98:99], v[98:99], s[52:53], v[16:17] op_sel_hi:[1,1,0] neg_lo:[0,0,1] neg_hi:[0,0,1]
    v_pk_fma_f32 v[100:101], v[100:101], s[52:53], v[16:17] op_sel_hi:[1,1,0] neg_lo:[0,0,1] neg_hi:[0,0,1]
    v_exp_f32 v92, v92
    v_exp_f32 v93, v93
    v_exp_f32 v94, v94
    v_exp_f32 v95, v95
    v_cvt_pk_bf16_f32 v4, v92, v93
    v_exp_f32 v96, v96
    v_exp_f32 v97, v97
    v_cvt_pk_bf16_f32 v5, v94, v95
    v_exp_f32 v98, v98
    v_exp_f32 v99, v99
    v_cvt_pk_bf16_f32 v6, v96, v97
    v_exp_f32 v100, v100
    v_exp_f32 v101, v101
    v_cvt_pk_bf16_f32 v7, v98, v99
    v_pk_add_f32 v[92:93], v[92:93], v[94:95]
    v_cvt_pk_bf16_f32 v8, v100, v101
    v_mfma_f32_16x16x32_bf16 v[20:23], v[104:107], v[4:7], 0
    v_add_f32 v96, v96, v98
    v_add_f32 v97, v97, v99
    v_mfma_f32_16x16x32_bf16 v[24:27], v[108:111], v[4:7], 0
    v_add_f32 v92, v92, v100
    v_add_f32 v93, v93, v101
    v_mfma_f32_16x16x16_bf16 v[20:23], v[88:89], v[8:9], v[20:23]
    v_add_f32 v96, v96, v97
    v_add_f32 v92, v92, v93
    v_mfma_f32_16x16x16_bf16 v[24:27], v[90:91], v[8:9], v[24:27]
    v_add_f32 v17, v92, v96
    v_add_f32 v18, v92, v96
    s_add_u32 s38, s38, 1
    v_mov_b64 v[44:45], 0
    v_permlane16_swap_b32 v17, v18
    v_add_f32 v15, v17, v18
    v_add_f32 v18, v17, v18
    v_mov_b64 v[46:47], 0
    v_mov_b64 v[48:49], 0
    v_permlane32_swap_b32 v15, v18
    v_add_f32 v17, v15, v18
    v_rcp_f32 v16, v17
    v_mov_b64 v[50:51], 0
    v_pk_mul_f32 v[20:21], v[20:21], v[16:17] op_sel_hi:[1,0]
    v_pk_mul_f32 v[22:23], v[22:23], v[16:17] op_sel_hi:[1,0]
    v_pk_mul_f32 v[24:25], v[24:25], v[16:17] op_sel_hi:[1,0]
    v_pk_mul_f32 v[26:27], v[26:27], v[16:17] op_sel_hi:[1,0]
    v_cvt_pk_bf16_f32 v28, v20, v24
    v_cvt_pk_bf16_f32 v29, v21, v25
    v_cvt_pk_bf16_f32 v30, v22, v26
    v_cvt_pk_bf16_f32 v31, v23, v27
    ds_write_b128 v127, v[28:31]
    v_xor_b32 v93, 512, v127
    v_smfmac_f32_16x16x64_bf16 v[44:47], v[28:31], a[208:215], v3
    v_xor_b32 v94, 1024, v127
    s_add_u32 s46, s46, 8192
    v_smfmac_f32_16x16x64_bf16 v[36:39], v[28:31], a[192:199], v3
    v_xor_b32 v95, 1536, v127
    s_add_u32 s39, s39, 8192
    v_smfmac_f32_16x16x64_bf16 v[48:51], v[28:31], a[216:223], v3
    ds_read_b128 v[4:7], v120 offset:24576
    ds_read_b128 v[8:11], v120 offset:25600
    ds_read_b128 v[12:15], v120 offset:26624
    ds_read_b128 v[16:19], v120 offset:27648
    s_waitcnt lgkmcnt(4)
    s_barrier
    ds_read_b128 v[104:107], v93
    ds_read_b128 v[108:111], v94
    ds_read_b128 v[32:35], v95
    v_smfmac_f32_16x16x64_bf16 v[40:43], v[28:31], a[200:207], v3
    v_lshrrev_b32 v100, 1, v122
    v_mov_b64 v[102:103], v[88:89]
    v_add_u32 v100, s50, v100
    v_xor_b32 v123, 0x2000, v123
    v_xor_b32 v101, 16, v124
    s_waitcnt lgkmcnt(2)
    v_smfmac_f32_16x16x64_bf16 v[44:47], v[104:107], v[52:59], v3
    v_smfmac_f32_16x16x64_bf16 v[36:39], v[104:107], v[76:83], v3
    s_waitcnt lgkmcnt(1)
    v_smfmac_f32_16x16x64_bf16 v[44:47], v[108:111], v[60:67], v3
    ds_read_b128 v[52:55], v120 offset:28672
    s_waitcnt lgkmcnt(1)
    v_smfmac_f32_16x16x64_bf16 v[36:39], v[108:111], v[4:11], v3
    ds_read_b128 v[56:59], v120 offset:29696
    v_smfmac_f32_16x16x64_bf16 v[44:47], v[32:35], v[68:75], v3
    ds_read_b128 v[60:63], v120 offset:30720
    v_smfmac_f32_16x16x64_bf16 v[36:39], v[32:35], v[12:19], v3
    ds_read_b128 v[64:67], v120 offset:31744
    v_smfmac_f32_16x16x64_bf16 v[48:51], v[104:107], a[224:231], v3
    v_xor_b32 v93, 2048, v121
    v_smfmac_f32_16x16x64_bf16 v[40:43], v[104:107], a[248:255], v3
    v_xor_b32 v94, 4096, v121
    v_smfmac_f32_16x16x64_bf16 v[48:51], v[108:111], a[232:239], v3
    s_waitcnt lgkmcnt(0)
    v_cvt_pk_bf16_f32 v84, v44, v45
    v_cvt_pk_bf16_f32 v85, v46, v47
    v_cvt_pk_bf16_f32 v86, v36, v37
    v_cvt_pk_bf16_f32 v87, v38, v39
    v_bfi_b32 v84, 1, s3, v84
    v_smfmac_f32_16x16x64_bf16 v[40:43], v[108:111], v[52:59], v3
    buffer_store_dwordx4 v[84:87], v0, s[4:7], s40 offen sc1
    v_smfmac_f32_16x16x64_bf16 v[48:51], v[32:35], a[240:247], v3
    v_xor_b32 v95, 6144, v121
    v_smfmac_f32_16x16x64_bf16 v[40:43], v[32:35], v[60:67], v3
    ds_read_b128 v[96:99], v122 offset:30720
    ds_read_b128 v[68:71], v120 offset:4096
    ds_read_b128 v[72:75], v120 offset:5120
    ds_read_b128 v[76:79], v120 offset:6144
    ds_read_b128 v[80:83], v120 offset:7168
    s_xor_b32 s48, s48, 0x2000
    v_cvt_pk_bf16_f32 v88, v48, v49
    v_cvt_pk_bf16_f32 v89, v50, v51
    v_bfi_b32 v88, 1, s3, v88
    v_cvt_pk_bf16_f32 v91, v42, v43
    v_cvt_pk_bf16_f32 v90, v40, v41
    buffer_store_dwordx4 v[88:91], v0, s[4:7], s41 offen sc1
    ds_read_b128 v[52:55], v120 offset:0
    ds_read_b128 v[56:59], v120 offset:1024
    ds_read_b128 v[60:63], v120 offset:2048
    ds_read_b128 v[64:67], v120 offset:3072
    s_mov_b32 s56, 262144
    s_add_u32 s47, s47, 8192
    s_add_u32 s49, s49, s51
    s_mov_b32 s51, 8192
    s_nop 15
    s_nop 15
    s_nop 15
    s_nop 15
    s_nop 15
    s_nop 15
    s_nop 15
    s_nop 15
    s_nop 15
    s_nop 5
    buffer_load_dwordx4 v[20:23], v122, s[4:7], s44 offen offset:0 sc1
    buffer_load_dwordx4 v[24:27], v122, s[4:7], s44 offen offset:1024 sc1
    v_mov_b64 v[84:85], 0
    v_mov_b64 v[86:87], 0
    v_mov_b64 v[88:89], 0
    v_mov_b64 v[90:91], 0
    v_mov_b64 v[36:37], 0
    v_mov_b64 v[38:39], 0
    v_mov_b64 v[40:41], 0
    v_mov_b64 v[42:43], 0
    v_mov_b64 v[44:45], 0
    v_mov_b64 v[46:47], 0
    v_mov_b64 v[48:49], 0
    v_mov_b64 v[50:51], 0
    s_waitcnt vmcnt(9)
    v_mov_b64 v[104:105], v[112:113]
    v_mov_b64 v[106:107], v[114:115]
    v_mov_b64 v[108:109], v[116:117]
    v_mov_b64 v[110:111], v[118:119]
    s_waitcnt lgkmcnt(8)
    s_branch L_okB_23
    .p2align 6
L_retB_22:
    s_mov_b64 exec, vcc
    buffer_load_dwordx4 v[20:23], v122, s[4:7], s44 offen offset:0 sc1
    buffer_load_dwordx4 v[24:27], v122, s[4:7], s44 offen offset:1024 sc1
    s_mov_b64 exec, -1
    s_sub_u32 s56, s56, 1
    s_cbranch_scc1 L_fail
L_okB_23:
    s_waitcnt vmcnt(1)
    v_mfma_f32_16x16x32_bf16 v[12:15], v[96:99], v[20:23], 0
    s_waitcnt vmcnt(0)
    v_mfma_f32_16x16x32_bf16 v[12:15], v[96:99], v[24:27], v[12:15]
    v_bitop3_b32 v92, v20, v24, s3 bitop3:0x7e
    v_and_b32 v92, 1, v92
    v_cmp_ne_u32 vcc, 0, v92
    s_cbranch_vccnz L_retB_22
L_okB_23_ok:
    s_mov_b32 s56, 262144
    v_readlane_b32 s57, v2, 0
    v_readlane_b32 s60, v2, 1
    s_xor_b32 s3, s3, 1
    v_add_f32_dpp v12, v12, v12 row_ror:4 row_mask:0xf bank_mask:0xf
    v_add_f32_dpp v13, v13, v13 row_ror:4 row_mask:0xf bank_mask:0xf
    s_nop 0
    v_add_f32_dpp v12, v12, v12 row_ror:8 row_mask:0xf bank_mask:0xf
    v_add_f32_dpp v13, v13, v13 row_ror:8 row_mask:0xf bank_mask:0xf
    v_cvt_pk_bf16_f32 v92, v12, v13
    buffer_store_dword v92, v1, s[4:7], s45 offen sc1
    s_mov_b64 exec, -1
    s_add_u32 s45, s45, 8192
    s_min_u32 s57, s57, s60
    s_add_u32 s62, s38, 2
    s_min_u32 s62, s62, 64
    ds_read_b64 v[96:97], v100
    v_mov_b64 v[98:99], v[102:103]
    s_nop 15
    s_nop 15
    s_nop 15
    s_nop 15
    s_nop 15
    s_nop 15
    s_nop 15
    s_nop 15
    s_nop 15
    s_nop 5
    buffer_load_dwordx4 v[4:7], v121, s[4:7], s39 offen sc1
    buffer_load_dwordx4 v[8:11], v121, s[4:7], s39 offen offset:1024 sc1
    s_cmp_lt_u32 s57, s62
    s_cbranch_scc1 L_kvs_24
L_kvb_25:
    s_mov_b32 m0, s48
    s_add_u32 s59, s45, 8192
    s_waitcnt lgkmcnt(0)
    s_cmp_lt_u32 s38, s42
    s_cbranch_scc1 L_step_20
    s_branch L_fin_26
    .p2align 6
L_retA2_27:
    s_mov_b64 exec, vcc
    buffer_load_dwordx4 v[4:7], v121, s[4:7], s39 offen sc1
    buffer_load_dwordx4 v[8:11], v121, s[4:7], s39 offen offset:1024 sc1
    s_mov_b64 exec, -1
    s_sub_u32 s56, s56, 1
    s_cbranch_scc1 L_fail
L_fin_26:
    s_waitcnt vmcnt(0)
    v_max3_u32 v92, v4, v5, v6
    v_max3_u32 v2, v7, v8, v9
    v_max3_u32 v92, v92, v10, v11
    v_max_u32 v92, v92, v2
    v_cmp_eq_u32 vcc, -1, v92
    s_cbranch_vccnz L_retA2_27
L_fin_26_ok:
    ds_write_b128 v121, v[4:7]
    ds_write_b128 v121, v[8:11] offset:1024
    v_smfmac_f32_16x16x64_bf16 v[36:39], v[4:7], a[0:7], v3
    v_smfmac_f32_16x16x64_bf16 v[40:43], v[4:7], a[8:15], v3
    v_smfmac_f32_16x16x64_bf16 v[44:47], v[4:7], a[16:23], v3
    v_smfmac_f32_16x16x64_bf16 v[48:51], v[4:7], a[24:31], v3
    s_waitcnt lgkmcnt(0)
    s_barrier
    ds_read_b128 v[12:15], v93 offset:0
    v_smfmac_f32_16x16x64_bf16 v[36:39], v[8:11], a[32:39], v3
    ds_read_b128 v[16:19], v93 offset:1024
    v_smfmac_f32_16x16x64_bf16 v[40:43], v[8:11], a[40:47], v3
    ds_read_b128 v[20:23], v94 offset:0
    v_smfmac_f32_16x16x64_bf16 v[44:47], v[8:11], a[48:55], v3
    ds_read_b128 v[24:27], v94 offset:1024
    v_smfmac_f32_16x16x64_bf16 v[48:51], v[8:11], a[56:63], v3
    ds_read_b128 v[28:31], v95 offset:0
    v_smfmac_f32_16x16x64_bf16 v[84:87], v[4:7], v[128:135], v3
    ds_read_b128 v[32:35], v95 offset:1024
    v_smfmac_f32_16x16x64_bf16 v[88:91], v[4:7], v[136:143], v3
    s_waitcnt lgkmcnt(5)
    v_smfmac_f32_16x16x64_bf16 v[36:39], v[12:15], v[52:59], v3
    v_smfmac_f32_16x16x64_bf16 v[40:43], v[12:15], v[60:67], v3
    ds_read_b128 v[52:55], v120 offset:8192
    v_smfmac_f32_16x16x64_bf16 v[44:47], v[12:15], v[68:75], v3
    v_smfmac_f32_16x16x64_bf16 v[48:51], v[12:15], v[76:83], v3
    s_waitcnt lgkmcnt(1)
    v_smfmac_f32_16x16x64_bf16 v[36:39], v[16:19], a[64:71], v3
    v_smfmac_f32_16x16x64_bf16 v[40:43], v[16:19], a[72:79], v3
    ds_read_b128 v[56:59], v120 offset:9216
    v_smfmac_f32_16x16x64_bf16 v[44:47], v[16:19], a[80:87], v3
    ds_read_b128 v[60:63], v120 offset:10240
    v_smfmac_f32_16x16x64_bf16 v[48:51], v[16:19], a[88:95], v3
    ds_read_b128 v[64:67], v120 offset:11264
    v_smfmac_f32_16x16x64_bf16 v[36:39], v[20:23], a[96:103], v3
    ds_read_b128 v[68:71], v120 offset:12288
    v_smfmac_f32_16x16x64_bf16 v[40:43], v[20:23], a[104:111], v3
    ds_read_b128 v[72:75], v120 offset:13312
    v_smfmac_f32_16x16x64_bf16 v[44:47], v[20:23], a[112:119], v3
    ds_read_b128 v[76:79], v120 offset:14336
    v_smfmac_f32_16x16x64_bf16 v[48:51], v[20:23], a[120:127], v3
    ds_read_b128 v[80:83], v120 offset:15360
    v_smfmac_f32_16x16x64_bf16 v[36:39], v[24:27], a[128:135], v3
    v_smfmac_f32_16x16x64_bf16 v[40:43], v[24:27], a[136:143], v3
    v_smfmac_f32_16x16x64_bf16 v[44:47], v[24:27], a[144:151], v3
    v_smfmac_f32_16x16x64_bf16 v[48:51], v[24:27], a[152:159], v3
    v_smfmac_f32_16x16x64_bf16 v[36:39], v[32:35], a[160:167], v3
    v_smfmac_f32_16x16x64_bf16 v[40:43], v[32:35], a[168:175], v3
    v_smfmac_f32_16x16x64_bf16 v[44:47], v[32:35], a[176:183], v3
    v_smfmac_f32_16x16x64_bf16 v[48:51], v[32:35], a[184:191], v3
    s_waitcnt lgkmcnt(0)
    v_smfmac_f32_16x16x64_bf16 v[36:39], v[28:31], v[52:59], v3
    s_nop 0
    v_smfmac_f32_16x16x64_bf16 v[40:43], v[28:31], v[60:67], v3
    s_nop 0
    v_smfmac_f32_16x16x64_bf16 v[44:47], v[28:31], v[68:75], v3
    s_nop 0
    v_smfmac_f32_16x16x64_bf16 v[48:51], v[28:31], v[76:83], v3
    s_nop 0
    v_smfmac_f32_16x16x64_bf16 v[84:87], v[8:11], v[144:151], v3
    v_add_f32 v36, v36, v38
    v_smfmac_f32_16x16x64_bf16 v[88:91], v[8:11], v[152:159], v3
    v_add_f32 v37, v37, v39
    v_add_f32 v38, v40, v42
    v_add_f32 v39, v41, v43
    v_add_f32 v44, v44, v46
    v_add_f32 v45, v45, v47
    v_cvt_pk_bf16_f32 v40, v36, v38
    v_cvt_pk_bf16_f32 v42, v37, v39
    v_add_f32 v46, v48, v50
    v_add_f32 v47, v49, v51
    v_cvt_pk_bf16_f32 v41, v44, v46
    ds_write_b64 v124, v[40:41]
    v_cvt_pk_bf16_f32 v43, v45, v47
    ds_write_b64 v101, v[42:43]
    v_smfmac_f32_16x16x64_bf16 v[84:87], v[12:15], v[160:167], v3
    v_smfmac_f32_16x16x64_bf16 v[88:91], v[12:15], v[168:175], v3
    buffer_store_dwordx4 v[96:99], v122, s[4:7], s49 offen sc1
    v_smfmac_f32_16x16x64_bf16 v[84:87], v[16:19], v[176:183], v3
    v_smfmac_f32_16x16x64_bf16 v[88:91], v[16:19], v[184:191], v3
    s_waitcnt lgkmcnt(0)
    s_barrier
    ds_read_b64 v[96:97], v100
    v_smfmac_f32_16x16x64_bf16 v[84:87], v[20:23], v[192:199], v3
    v_smfmac_f32_16x16x64_bf16 v[88:91], v[20:23], v[200:207], v3
    v_smfmac_f32_16x16x64_bf16 v[84:87], v[24:27], v[208:215], v3
    v_smfmac_f32_16x16x64_bf16 v[88:91], v[24:27], v[216:223], v3
    v_smfmac_f32_16x16x64_bf16 v[84:87], v[28:31], v[224:231], v3
    v_smfmac_f32_16x16x64_bf16 v[88:91], v[28:31], v[232:239], v3
    v_smfmac_f32_16x16x64_bf16 v[84:87], v[32:35], v[240:247], v3
    v_smfmac_f32_16x16x64_bf16 v[88:91], v[32:35], v[248:255], v3
    s_add_u32 s49, s49, s51
    s_nop 6
    v_add_f32 v84, v84, v86
    v_add_f32 v85, v85, v87
    v_add_f32 v86, v88, v90
    v_add_f32 v87, v89, v91
    v_cvt_pk_bf16_f32 v98, v84, v85
    v_cvt_pk_bf16_f32 v99, v86, v87
    s_waitcnt lgkmcnt(0)
    buffer_store_dwordx4 v[96:99], v122, s[4:7], s49 offen sc1
    s_branch L_chdone_10
L_kvs_24:
    s_min_u32 s62, s62, 64
    s_mov_b32 s58, 0
L_kvp_28:
    buffer_load_dwordx2 v[12:13], off, s[4:7], s63 sc1
    s_add_u32 s58, s58, 1
    s_cmp_gt_u32 s58, 262144
    s_cbranch_scc1 L_fail
    s_waitcnt vmcnt(0)
    v_min_u32 v12, v12, v13
    s_nop 0
    v_readfirstlane_b32 s57, v12
    s_nop 3
    s_cmp_lt_u32 s57, s62
    s_cbranch_scc1 L_kvp_28
    s_branch L_kvb_25
L_chdone_10:
    s_endpgm
L_other:
    s_waitcnt lgkmcnt(0)
    s_mov_b32 s4, s100
    s_and_b32 s5, s101, 0xffff
    s_mov_b32 s6, 0x10000000
    s_mov_b32 s7, 0x20000
    s_mov_b32 s16, s98
    s_and_b32 s17, s99, 0xffff
    s_mov_b32 s18, 0x100
    s_mov_b32 s19, 0x20000
    s_cmp_le_u32 s30, 2
    s_cbranch_scc1 L_kv
    s_cmp_eq_u32 s30, 7
    s_cbranch_scc1 L_parta
    s_cmp_ge_u32 s30, 3
    s_cselect_b32 s32, 1, 0
    s_cmp_le_u32 s30, 6
    s_cselect_b32 s32, s32, 0
    s_cmp_eq_u32 s32, 1
    s_cbranch_scc1 L_w2
L_exit:
    s_endpgm
L_fail:
    s_mov_b64 exec, 1
    v_mov_b32 v4, 0xdead
    v_mov_b32 v5, 252
    buffer_store_dword v4, v5, s[16:19], 0 offen
    s_endpgm
L_kv:
    s_cmp_eq_u32 s30, 1
    s_cselect_b32 s8, s88, s90
    s_cselect_b32 s9, s89, s91
    s_and_b32 s9, s9, 0xffff
    s_mov_b32 s10, 0x400000
    s_mov_b32 s11, 0x20000
    s_mov_b32 s12, s82
    s_and_b32 s13, s83, 0xffff
    s_mov_b32 s14, 0x200000
    s_mov_b32 s15, 0x20000
    s_mov_b32 s43, 0x05040100
    s_mov_b32 s44, 0x07060302
    v_and_b32 v100, 63, v0
    v_and_b32 v101, 15, v100
    v_lshrrev_b32 v102, 4, v100
    v_lshrrev_b32 v103, 4, v100
    v_and_b32 v104, 7, v100
    v_xor_b32 v103, v103, v104
    s_and_b32 s32, s28, 1
    s_lshl_b32 s32, s32, 2
    v_xor_b32 v103, s32, v103
    v_lshlrev_b32 v103, 4, v103
    v_lshrrev_b32 v104, 3, v100
    v_lshl_add_u32 v103, v104, 10, v103
    s_lshl_b32 s32, s28, 13
    v_add_u32 v1, s32, v103
    v_lshrrev_b32 v103, 1, v101
    v_xor_b32 v103, v103, v102
    v_lshlrev_b32 v103, 4, v103
    v_lshl_add_u32 v2, v101, 7, v103
    v_xor_b32 v3, 64, v2
    v_lshlrev_b32 v4, 4, v100
    v_lshlrev_b32 v103, 16, v102
    v_lshl_add_u32 v103, v101, 2, v103
    s_lshl_b32 s32, s29, 8
    s_lshl_b32 s33, s28, 6
    s_add_u32 s32, s32, s33
    v_add_u32 v105, s32, v103
    s_sub_u32 s32, s30, 1
    s_lshl_b32 s33, s32, 2
    s_lshl_b32 s34, s29, 8
    s_add_u32 s33, s33, s34
    s_add_u32 s42, s33, 0x0
    v_mov_b32 v106, 0
    buffer_store_dword v106, off, s[4:7], s42 sc1
    s_lshl_b32 s32, s32, 24
    s_lshl_b32 s33, s29, 19
    s_add_u32 s32, s32, s33
    s_add_u32 s41, s32, 0x1000000
    s_mov_b32 s39, 0
    s_lshl_b32 s40, s28, 10
    s_add_u32 m0, s40, 0
    s_add_u32 s45, s39, 0
    buffer_load_dwordx4 v1, s[12:15], s45 offen lds
    s_add_u32 m0, s40, 4096
    s_add_u32 s45, s39, 128
    buffer_load_dwordx4 v1, s[12:15], s45 offen lds
    s_add_u32 m0, s40, 8192
    s_add_u32 s45, s39, 256
    buffer_load_dwordx4 v1, s[12:15], s45 offen lds
    s_add_u32 m0, s40, 12288
    s_add_u32 s45, s39, 384
    buffer_load_dwordx4 v1, s[12:15], s45 offen lds
    s_add_u32 m0, s40, 16384
    s_add_u32 s45, s39, 512
    buffer_load_dwordx4 v1, s[12:15], s45 offen lds
    s_add_u32 m0, s40, 20480
    s_add_u32 s45, s39, 640
    buffer_load_dwordx4 v1, s[12:15], s45 offen lds
    s_add_u32 m0, s40, 24576
    s_add_u32 s45, s39, 768
    buffer_load_dwordx4 v1, s[12:15], s45 offen lds
    s_add_u32 m0, s40, 28672
    s_add_u32 s45, s39, 896
    buffer_load_dwordx4 v1, s[12:15], s45 offen lds
    s_add_u32 s39, s39, 32768
    s_add_u32 s40, s40, 32768
    s_and_b32 s40, s40, 0x1ffff
    s_add_u32 m0, s40, 0
    s_add_u32 s45, s39, 0
    buffer_load_dwordx4 v1, s[12:15], s45 offen lds
    s_add_u32 m0, s40, 4096
    s_add_u32 s45, s39, 128
    buffer_load_dwordx4 v1, s[12:15], s45 offen lds
    s_add_u32 m0, s40, 8192
    s_add_u32 s45, s39, 256
    buffer_load_dwordx4 v1, s[12:15], s45 offen lds
    s_add_u32 m0, s40, 12288
    s_add_u32 s45, s39, 384
    buffer_load_dwordx4 v1, s[12:15], s45 offen lds
    s_add_u32 m0, s40, 16384
    s_add_u32 s45, s39, 512
    buffer_load_dwordx4 v1, s[12:15], s45 offen lds
    s_add_u32 m0, s40, 20480
    s_add_u32 s45, s39, 640
    buffer_load_dwordx4 v1, s[12:15], s45 offen lds
    s_add_u32 m0, s40, 24576
    s_add_u32 s45, s39, 768
    buffer_load_dwordx4 v1, s[12:15], s45 offen lds
    s_add_u32 m0, s40, 28672
    s_add_u32 s45, s39, 896
    buffer_load_dwordx4 v1, s[12:15], s45 offen lds
    s_add_u32 s39, s39, 32768
    s_add_u32 s40, s40, 32768
    s_and_b32 s40, s40, 0x1ffff
    s_add_u32 m0, s40, 0
    s_add_u32 s45, s39, 0
    buffer_load_dwordx4 v1, s[12:15], s45 offen lds
    s_add_u32 m0, s40, 4096
    s_add_u32 s45, s39, 128
    buffer_load_dwordx4 v1, s[12:15], s45 offen lds
    s_add_u32 m0, s40, 8192
    s_add_u32 s45, s39, 256
    buffer_load_dwordx4 v1, s[12:15], s45 offen lds
    s_add_u32 m0, s40, 12288
    s_add_u32 s45, s39, 384
    buffer_load_dwordx4 v1, s[12:15], s45 offen lds
    s_add_u32 m0, s40, 16384
    s_add_u32 s45, s39, 512
    buffer_load_dwordx4 v1, s[12:15], s45 offen lds
    s_add_u32 m0, s40, 20480
    s_add_u32 s45, s39, 640
    buffer_load_dwordx4 v1, s[12:15], s45 offen lds
    s_add_u32 m0, s40, 24576
    s_add_u32 s45, s39, 768
    buffer_load_dwordx4 v1, s[12:15], s45 offen lds
    s_add_u32 m0, s40, 28672
    s_add_u32 s45, s39, 896
    buffer_load_dwordx4 v1, s[12:15], s45 offen lds
    s_add_u32 s39, s39, 32768
    s_add_u32 s40, s40, 32768
    s_and_b32 s40, s40, 0x1ffff
    s_mov_b32 s33, 0
    buffer_load_dword v8, v105, s[8:11], s33 offen
    s_mov_b32 s33, 8192
    buffer_load_dword v9, v105, s[8:11], s33 offen
    s_mov_b32 s33, 16384
    buffer_load_dword v10, v105, s[8:11], s33 offen
    s_mov_b32 s33, 24576
    buffer_load_dword v11, v105, s[8:11], s33 offen
    s_mov_b32 s33, 32768
    buffer_load_dword v12, v105, s[8:11], s33 offen
    s_mov_b32 s33, 40960
    buffer_load_dword v13, v105, s[8:11], s33 offen
    s_mov_b32 s33, 49152
    buffer_load_dword v14, v105, s[8:11], s33 offen
    s_mov_b32 s33, 57344
    buffer_load_dword v15, v105, s[8:11], s33 offen
    s_mov_b32 s33, 262144
    buffer_load_dword v16, v105, s[8:11], s33 offen
    s_mov_b32 s33, 270336
    buffer_load_dword v17, v105, s[8:11], s33 offen
    s_mov_b32 s33, 278528
    buffer_load_dword v18, v105, s[8:11], s33 offen
    s_mov_b32 s33, 286720
    buffer_load_dword v19, v105, s[8:11], s33 offen
    s_mov_b32 s33, 294912
    buffer_load_dword v20, v105, s[8:11], s33 offen
    s_mov_b32 s33, 303104
    buffer_load_dword v21, v105, s[8:11], s33 offen
    s_mov_b32 s33, 311296
    buffer_load_dword v22, v105, s[8:11], s33 offen
    s_mov_b32 s33, 319488
    buffer_load_dword v23, v105, s[8:11], s33 offen
    s_mov_b32 s33, 524288
    buffer_load_dword v24, v105, s[8:11], s33 offen
    s_mov_b32 s33, 532480
    buffer_load_dword v25, v105, s[8:11], s33 offen
    s_mov_b32 s33, 540672
    buffer_load_dword v26, v105, s[8:11], s33 offen
    s_mov_b32 s33, 548864
    buffer_load_dword v27, v105, s[8:11], s33 offen
    s_mov_b32 s33, 557056
    buffer_load_dword v28, v105, s[8:11], s33 offen
    s_mov_b32 s33, 565248
    buffer_load_dword v29, v105, s[8:11], s33 offen
    s_mov_b32 s33, 573440
    buffer_load_dword v30, v105, s[8:11], s33 offen
    s_mov_b32 s33, 581632
    buffer_load_dword v31, v105, s[8:11], s33 offen
    s_mov_b32 s33, 786432
    buffer_load_dword v32, v105, s[8:11], s33 offen
    s_mov_b32 s33, 794624
    buffer_load_dword v33, v105, s[8:11], s33 offen
    s_mov_b32 s33, 802816
    buffer_load_dword v34, v105, s[8:11], s33 offen
    s_mov_b32 s33, 811008
    buffer_load_dword v35, v105, s[8:11], s33 offen
    s_mov_b32 s33, 819200
    buffer_load_dword v36, v105, s[8:11], s33 offen
    s_mov_b32 s33, 827392
    buffer_load_dword v37, v105, s[8:11], s33 offen
    s_mov_b32 s33, 835584
    buffer_load_dword v38, v105, s[8:11], s33 offen
    s_mov_b32 s33, 843776
    buffer_load_dword v39, v105, s[8:11], s33 offen
    s_mov_b32 s33, 1048576
    buffer_load_dword v40, v105, s[8:11], s33 offen
    s_mov_b32 s33, 1056768
    buffer_load_dword v41, v105, s[8:11], s33 offen
    s_mov_b32 s33, 1064960
    buffer_load_dword v42, v105, s[8:11], s33 offen
    s_mov_b32 s33, 1073152
    buffer_load_dword v43, v105, s[8:11], s33 offen
    s_mov_b32 s33, 1081344
    buffer_load_dword v44, v105, s[8:11], s33 offen
    s_mov_b32 s33, 1089536
    buffer_load_dword v45, v105, s[8:11], s33 offen
    s_mov_b32 s33, 1097728
    buffer_load_dword v46, v105, s[8:11], s33 offen
    s_mov_b32 s33, 1105920
    buffer_load_dword v47, v105, s[8:11], s33 offen
    s_waitcnt vmcnt(63)
    s_barrier
    s_cmp_lg_u32 s28, 0
    s_cbranch_scc1 L_arr_29
    s_mul_i32 s32, s31, 6
    s_lshl_b64 s[34:35], 1, s32
    s_or_b32 s35, s35, 0x01000000
    s_lshl_b32 s32, s30, 3
    v_mov_b32 v106, s34
    v_mov_b32 v107, s35
    v_mov_b32 v108, s32
    s_mov_b64 s[36:37], exec
    s_mov_b64 exec, 1
    buffer_atomic_add_x2 v[106:107], v108, s[16:19], 0 offen offset:128
    s_mov_b64 exec, s[36:37]
L_arr_29:
    s_mov_b32 s33, 1310720
    buffer_load_dword v48, v105, s[8:11], s33 offen
    s_mov_b32 s33, 1318912
    buffer_load_dword v49, v105, s[8:11], s33 offen
    s_mov_b32 s33, 1327104
    buffer_load_dword v50, v105, s[8:11], s33 offen
    s_mov_b32 s33, 1335296
    buffer_load_dword v51, v105, s[8:11], s33 offen
    s_mov_b32 s33, 1343488
    buffer_load_dword v52, v105, s[8:11], s33 offen
    s_mov_b32 s33, 1351680
    buffer_load_dword v53, v105, s[8:11], s33 offen
    s_mov_b32 s33, 1359872
    buffer_load_dword v54, v105, s[8:11], s33 offen
    s_mov_b32 s33, 1368064
    buffer_load_dword v55, v105, s[8:11], s33 offen
    s_waitcnt vmcnt(40)
    v_perm_b32 v128, v9, v8, s43
    v_perm_b32 v132, v9, v8, s44
    v_perm_b32 v129, v11, v10, s43
    v_perm_b32 v133, v11, v10, s44
    v_perm_b32 v130, v13, v12, s43
    v_perm_b32 v134, v13, v12, s44
    v_perm_b32 v131, v15, v14, s43
    v_perm_b32 v135, v15, v14, s44
    s_mov_b32 s33, 1572864
    buffer_load_dword v8, v105, s[8:11], s33 offen
    s_mov_b32 s33, 1581056
    buffer_load_dword v9, v105, s[8:11], s33 offen
    s_mov_b32 s33, 1589248
    buffer_load_dword v10, v105, s[8:11], s33 offen
    s_mov_b32 s33, 1597440
    buffer_load_dword v11, v105, s[8:11], s33 offen
    s_mov_b32 s33, 1605632
    buffer_load_dword v12, v105, s[8:11], s33 offen
    s_mov_b32 s33, 1613824
    buffer_load_dword v13, v105, s[8:11], s33 offen
    s_mov_b32 s33, 1622016
    buffer_load_dword v14, v105, s[8:11], s33 offen
    s_mov_b32 s33, 1630208
    buffer_load_dword v15, v105, s[8:11], s33 offen
    s_waitcnt vmcnt(40)
    v_perm_b32 v136, v17, v16, s43
    v_perm_b32 v140, v17, v16, s44
    v_perm_b32 v137, v19, v18, s43
    v_perm_b32 v141, v19, v18, s44
    v_perm_b32 v138, v21, v20, s43
    v_perm_b32 v142, v21, v20, s44
    v_perm_b32 v139, v23, v22, s43
    v_perm_b32 v143, v23, v22, s44
    s_mov_b32 s33, 1835008
    buffer_load_dword v16, v105, s[8:11], s33 offen
    s_mov_b32 s33, 1843200
    buffer_load_dword v17, v105, s[8:11], s33 offen
    s_mov_b32 s33, 1851392
    buffer_load_dword v18, v105, s[8:11], s33 offen
    s_mov_b32 s33, 1859584
    buffer_load_dword v19, v105, s[8:11], s33 offen
    s_mov_b32 s33, 1867776
    buffer_load_dword v20, v105, s[8:11], s33 offen
    s_mov_b32 s33, 1875968
    buffer_load_dword v21, v105, s[8:11], s33 offen
    s_mov_b32 s33, 1884160
    buffer_load_dword v22, v105, s[8:11], s33 offen
    s_mov_b32 s33, 1892352
    buffer_load_dword v23, v105, s[8:11], s33 offen
    s_waitcnt vmcnt(40)
    v_perm_b32 v144, v25, v24, s43
    v_perm_b32 v148, v25, v24, s44
    v_perm_b32 v145, v27, v26, s43
    v_perm_b32 v149, v27, v26, s44
    v_perm_b32 v146, v29, v28, s43
    v_perm_b32 v150, v29, v28, s44
    v_perm_b32 v147, v31, v30, s43
    v_perm_b32 v151, v31, v30, s44
    s_mov_b32 s33, 2097152
    buffer_load_dword v24, v105, s[8:11], s33 offen
    s_mov_b32 s33, 2105344
    buffer_load_dword v25, v105, s[8:11], s33 offen
    s_mov_b32 s33, 2113536
    buffer_load_dword v26, v105, s[8:11], s33 offen
    s_mov_b32 s33, 2121728
    buffer_load_dword v27, v105, s[8:11], s33 offen
    s_mov_b32 s33, 2129920
    buffer_load_dword v28, v105, s[8:11], s33 offen
    s_mov_b32 s33, 2138112
    buffer_load_dword v29, v105, s[8:11], s33 offen
    s_mov_b32 s33, 2146304
    buffer_load_dword v30, v105, s[8:11], s33 offen
    s_mov_b32 s33, 2154496
    buffer_load_dword v31, v105, s[8:11], s33 offen
    s_waitcnt vmcnt(40)
    v_perm_b32 v152, v33, v32, s43
    v_perm_b32 v156, v33, v32, s44
    v_perm_b32 v153, v35, v34, s43
    v_perm_b32 v157, v35, v34, s44
    v_perm_b32 v154, v37, v36, s43
    v_perm_b32 v158, v37, v36, s44
    v_perm_b32 v155, v39, v38, s43
    v_perm_b32 v159, v39, v38, s44
    s_mov_b32 s33, 2359296
    buffer_load_dword v32, v105, s[8:11], s33 offen
    s_mov_b32 s33, 2367488
    buffer_load_dword v33, v105, s[8:11], s33 offen
    s_mov_b32 s33, 2375680
    buffer_load_dword v34, v105, s[8:11], s33 offen
    s_mov_b32 s33, 2383872
    buffer_load_dword v35, v105, s[8:11], s33 offen
    s_mov_b32 s33, 2392064
    buffer_load_dword v36, v105, s[8:11], s33 offen
    s_mov_b32 s33, 2400256
    buffer_load_dword v37, v105, s[8:11], s33 offen
    s_mov_b32 s33, 2408448
    buffer_load_dword v38, v105, s[8:11], s33 offen
    s_mov_b32 s33, 2416640
    buffer_load_dword v39, v105, s[8:11], s33 offen
    s_waitcnt vmcnt(40)
    v_perm_b32 v160, v41, v40, s43
    v_perm_b32 v164, v41, v40, s44
    v_perm_b32 v161, v43, v42, s43
    v_perm_b32 v165, v43, v42, s44
    v_perm_b32 v162, v45, v44, s43
    v_perm_b32 v166, v45, v44, s44
    v_perm_b32 v163, v47, v46, s43
    v_perm_b32 v167, v47, v46, s44
    s_mov_b32 s33, 2621440
    buffer_load_dword v40, v105, s[8:11], s33 offen
    s_mov_b32 s33, 2629632
    buffer_load_dword v41, v105, s[8:11], s33 offen
    s_mov_b32 s33, 2637824
    buffer_load_dword v42, v105, s[8:11], s33 offen
    s_mov_b32 s33, 2646016
    buffer_load_dword v43, v105, s[8:11], s33 offen
    s_mov_b32 s33, 2654208
    buffer_load_dword v44, v105, s[8:11], s33 offen
    s_mov_b32 s33, 2662400
    buffer_load_dword v45, v105, s[8:11], s33 offen
    s_mov_b32 s33, 2670592
    buffer_load_dword v46, v105, s[8:11], s33 offen
    s_mov_b32 s33, 2678784
    buffer_load_dword v47, v105, s[8:11], s33 offen
    s_waitcnt vmcnt(40)
    v_perm_b32 v168, v49, v48, s43
    v_perm_b32 v172, v49, v48, s44
    v_perm_b32 v169, v51, v50, s43
    v_perm_b32 v173, v51, v50, s44
    v_perm_b32 v170, v53, v52, s43
    v_perm_b32 v174, v53, v52, s44
    v_perm_b32 v171, v55, v54, s43
    v_perm_b32 v175, v55, v54, s44
    s_mov_b32 s33, 2883584
    buffer_load_dword v48, v105, s[8:11], s33 offen
    s_mov_b32 s33, 2891776
    buffer_load_dword v49, v105, s[8:11], s33 offen
    s_mov_b32 s33, 2899968
    buffer_load_dword v50, v105, s[8:11], s33 offen
    s_mov_b32 s33, 2908160
    buffer_load_dword v51, v105, s[8:11], s33 offen
    s_mov_b32 s33, 2916352
    buffer_load_dword v52, v105, s[8:11], s33 offen
    s_mov_b32 s33, 2924544
    buffer_load_dword v53, v105, s[8:11], s33 offen
    s_mov_b32 s33, 2932736
    buffer_load_dword v54, v105, s[8:11], s33 offen
    s_mov_b32 s33, 2940928
    buffer_load_dword v55, v105, s[8:11], s33 offen
    s_waitcnt vmcnt(40)
    v_perm_b32 v176, v9, v8, s43
    v_perm_b32 v180, v9, v8, s44
    v_perm_b32 v177, v11, v10, s43
    v_perm_b32 v181, v11, v10, s44
    v_perm_b32 v178, v13, v12, s43
    v_perm_b32 v182, v13, v12, s44
    v_perm_b32 v179, v15, v14, s43
    v_perm_b32 v183, v15, v14, s44
    s_mov_b32 s33, 3145728
    buffer_load_dword v8, v105, s[8:11], s33 offen
    s_mov_b32 s33, 3153920
    buffer_load_dword v9, v105, s[8:11], s33 offen
    s_mov_b32 s33, 3162112
    buffer_load_dword v10, v105, s[8:11], s33 offen
    s_mov_b32 s33, 3170304
    buffer_load_dword v11, v105, s[8:11], s33 offen
    s_mov_b32 s33, 3178496
    buffer_load_dword v12, v105, s[8:11], s33 offen
    s_mov_b32 s33, 3186688
    buffer_load_dword v13, v105, s[8:11], s33 offen
    s_mov_b32 s33, 3194880
    buffer_load_dword v14, v105, s[8:11], s33 offen
    s_mov_b32 s33, 3203072
    buffer_load_dword v15, v105, s[8:11], s33 offen
    s_waitcnt vmcnt(40)
    v_perm_b32 v184, v17, v16, s43
    v_perm_b32 v188, v17, v16, s44
    v_perm_b32 v185, v19, v18, s43
    v_perm_b32 v189, v19, v18, s44
    v_perm_b32 v186, v21, v20, s43
    v_perm_b32 v190, v21, v20, s44
    v_perm_b32 v187, v23, v22, s43
    v_perm_b32 v191, v23, v22, s44
    s_mov_b32 s33, 3407872
    buffer_load_dword v16, v105, s[8:11], s33 offen
    s_mov_b32 s33, 3416064
    buffer_load_dword v17, v105, s[8:11], s33 offen
    s_mov_b32 s33, 3424256
    buffer_load_dword v18, v105, s[8:11], s33 offen
    s_mov_b32 s33, 3432448
    buffer_load_dword v19, v105, s[8:11], s33 offen
    s_mov_b32 s33, 3440640
    buffer_load_dword v20, v105, s[8:11], s33 offen
    s_mov_b32 s33, 3448832
    buffer_load_dword v21, v105, s[8:11], s33 offen
    s_mov_b32 s33, 3457024
    buffer_load_dword v22, v105, s[8:11], s33 offen
    s_mov_b32 s33, 3465216
    buffer_load_dword v23, v105, s[8:11], s33 offen
    s_waitcnt vmcnt(40)
    v_perm_b32 v192, v25, v24, s43
    v_perm_b32 v196, v25, v24, s44
    v_perm_b32 v193, v27, v26, s43
    v_perm_b32 v197, v27, v26, s44
    v_perm_b32 v194, v29, v28, s43
    v_perm_b32 v198, v29, v28, s44
    v_perm_b32 v195, v31, v30, s43
    v_perm_b32 v199, v31, v30, s44
    s_mov_b32 s33, 3670016
    buffer_load_dword v24, v105, s[8:11], s33 offen
    s_mov_b32 s33, 3678208
    buffer_load_dword v25, v105, s[8:11], s33 offen
    s_mov_b32 s33, 3686400
    buffer_load_dword v26, v105, s[8:11], s33 offen
    s_mov_b32 s33, 3694592
    buffer_load_dword v27, v105, s[8:11], s33 offen
    s_mov_b32 s33, 3702784
    buffer_load_dword v28, v105, s[8:11], s33 offen
    s_mov_b32 s33, 3710976
    buffer_load_dword v29, v105, s[8:11], s33 offen
    s_mov_b32 s33, 3719168
    buffer_load_dword v30, v105, s[8:11], s33 offen
    s_mov_b32 s33, 3727360
    buffer_load_dword v31, v105, s[8:11], s33 offen
    s_waitcnt vmcnt(40)
    v_perm_b32 v200, v33, v32, s43
    v_perm_b32 v204, v33, v32, s44
    v_perm_b32 v201, v35, v34, s43
    v_perm_b32 v205, v35, v34, s44
    v_perm_b32 v202, v37, v36, s43
    v_perm_b32 v206, v37, v36, s44
    v_perm_b32 v203, v39, v38, s43
    v_perm_b32 v207, v39, v38, s44
    s_mov_b32 s33, 3932160
    buffer_load_dword v32, v105, s[8:11], s33 offen
    s_mov_b32 s33, 3940352
    buffer_load_dword v33, v105, s[8:11], s33 offen
    s_mov_b32 s33, 3948544
    buffer_load_dword v34, v105, s[8:11], s33 offen
    s_mov_b32 s33, 3956736
    buffer_load_dword v35, v105, s[8:11], s33 offen
    s_mov_b32 s33, 3964928
    buffer_load_dword v36, v105, s[8:11], s33 offen
    s_mov_b32 s33, 3973120
    buffer_load_dword v37, v105, s[8:11], s33 offen
    s_mov_b32 s33, 3981312
    buffer_load_dword v38, v105, s[8:11], s33 offen
    s_mov_b32 s33, 3989504
    buffer_load_dword v39, v105, s[8:11], s33 offen
    s_waitcnt vmcnt(40)
    v_perm_b32 v208, v41, v40, s43
    v_perm_b32 v212, v41, v40, s44
    v_perm_b32 v209, v43, v42, s43
    v_perm_b32 v213, v43, v42, s44
    v_perm_b32 v210, v45, v44, s43
    v_perm_b32 v214, v45, v44, s44
    v_perm_b32 v211, v47, v46, s43
    v_perm_b32 v215, v47, v46, s44
    s_waitcnt vmcnt(32)
    v_perm_b32 v216, v49, v48, s43
    v_perm_b32 v220, v49, v48, s44
    v_perm_b32 v217, v51, v50, s43
    v_perm_b32 v221, v51, v50, s44
    v_perm_b32 v218, v53, v52, s43
    v_perm_b32 v222, v53, v52, s44
    v_perm_b32 v219, v55, v54, s43
    v_perm_b32 v223, v55, v54, s44
    s_waitcnt vmcnt(24)
    v_perm_b32 v224, v9, v8, s43
    v_perm_b32 v228, v9, v8, s44
    v_perm_b32 v225, v11, v10, s43
    v_perm_b32 v229, v11, v10, s44
    v_perm_b32 v226, v13, v12, s43
    v_perm_b32 v230, v13, v12, s44
    v_perm_b32 v227, v15, v14, s43
    v_perm_b32 v231, v15, v14, s44
    s_waitcnt vmcnt(16)
    v_perm_b32 v232, v17, v16, s43
    v_perm_b32 v236, v17, v16, s44
    v_perm_b32 v233, v19, v18, s43
    v_perm_b32 v237, v19, v18, s44
    v_perm_b32 v234, v21, v20, s43
    v_perm_b32 v238, v21, v20, s44
    v_perm_b32 v235, v23, v22, s43
    v_perm_b32 v239, v23, v22, s44
    s_waitcnt vmcnt(8)
    v_perm_b32 v240, v25, v24, s43
    v_perm_b32 v244, v25, v24, s44
    v_perm_b32 v241, v27, v26, s43
    v_perm_b32 v245, v27, v26, s44
    v_perm_b32 v242, v29, v28, s43
    v_perm_b32 v246, v29, v28, s44
    v_perm_b32 v243, v31, v30, s43
    v_perm_b32 v247, v31, v30, s44
    s_waitcnt vmcnt(0)
    v_perm_b32 v248, v33, v32, s43
    v_perm_b32 v252, v33, v32, s44
    v_perm_b32 v249, v35, v34, s43
    v_perm_b32 v253, v35, v34, s44
    v_perm_b32 v250, v37, v36, s43
    v_perm_b32 v254, v37, v36, s44
    v_perm_b32 v251, v39, v38, s43
    v_perm_b32 v255, v39, v38, s44
    s_mov_b32 s38, 0
    s_mov_b32 s46, s41
    v_lshlrev_b32 v108, 3, v4
    s_cmp_eq_u32 s30, 2
    s_cbranch_scc1 L_kv_v_30
    s_lshl_b32 s32, s28, 10
    s_add_u32 s41, s41, s32
    s_waitcnt vmcnt(0)
    s_branch L_kvent_32
    .p2align 6
L_kvtop_31:
    s_waitcnt vmcnt(11)
L_kvent_32:
    s_barrier
    s_cmp_lg_u32 s38, 17
    s_cbranch_scc1 L_kvh_33
    s_mov_b32 s32, 0
L_wa_34:
    v_mbcnt_lo_u32_b32 v112, -1, 0
    v_mbcnt_hi_u32_b32 v112, -1, v112
    v_and_b32 v112, 15, v112
    v_lshlrev_b32 v112, 3, v112
    buffer_load_dwordx2 v[110:111], v112, s[16:19], 0 offen offset:128 sc1
    s_add_u32 s32, s32, 1
    s_cmp_gt_u32 s32, 262144
    s_cbranch_scc1 L_fail
    s_waitcnt vmcnt(0)
L_wac_35:
    v_lshrrev_b32 v113, 24, v111
    v_cmp_ne_u32 vcc, 32, v113
    s_and_b32 s33, vcc_lo, 3840
    s_cmp_lg_u32 s33, 0
    s_cbranch_scc0 L_wac_35_ok
    s_sleep 8
    s_branch L_wa_34
L_wac_35_ok:
    s_nop 3
    v_readlane_b32 s34, v110, s30
    v_readlane_b32 s35, v111, s30
    s_mul_i32 s32, s31, 6
    s_lshl_b64 s[36:37], 32, s32
    s_or_b32 s37, s37, 0x20000000
    s_cmp_eq_u64 s[34:35], s[36:37]
    s_cselect_b32 s45, 1, 0
L_kvh_33:
    s_max_u32 s32, s38, 1
    s_sub_u32 s32, s32, 1
    v_mov_b32 v106, s32
    buffer_store_dword v106, off, s[4:7], s42 sc1
    ds_read_b128 v[8:11], v2 offset:0
    ds_read_b128 v[12:15], v2 offset:2048
    ds_read_b128 v[16:19], v3 offset:0
    ds_read_b128 v[20:23], v3 offset:2048
    ds_read_b128 v[24:27], v2 offset:4096
    ds_read_b128 v[28:31], v2 offset:6144
    s_waitcnt lgkmcnt(4)
    v_mfma_f32_16x16x32_bf16 v[40:43], v[128:131], v[8:11], 0
    ds_read_b128 v[32:35], v3 offset:4096
    v_mfma_f32_16x16x32_bf16 v[44:47], v[132:135], v[8:11], 0
    v_mfma_f32_16x16x32_bf16 v[48:51], v[128:131], v[12:15], 0
    ds_read_b128 v[36:39], v3 offset:6144
    v_mfma_f32_16x16x32_bf16 v[52:55], v[132:135], v[12:15], 0
    s_waitcnt lgkmcnt(4)
    v_mfma_f32_16x16x32_bf16 v[40:43], v[136:139], v[16:19], v[40:43]
    ds_read_b128 v[8:11], v2 offset:8192
    v_mfma_f32_16x16x32_bf16 v[44:47], v[140:143], v[16:19], v[44:47]
    v_mfma_f32_16x16x32_bf16 v[48:51], v[136:139], v[20:23], v[48:51]
    ds_read_b128 v[12:15], v2 offset:10240
    v_mfma_f32_16x16x32_bf16 v[52:55], v[140:143], v[20:23], v[52:55]
    s_add_u32 m0, s40, 0
    s_add_u32 s45, s39, 0
    buffer_load_dwordx4 v1, s[12:15], s45 offen lds
    s_waitcnt lgkmcnt(4)
    v_mfma_f32_16x16x32_bf16 v[40:43], v[144:147], v[24:27], v[40:43]
    ds_read_b128 v[16:19], v3 offset:8192
    v_mfma_f32_16x16x32_bf16 v[44:47], v[148:151], v[24:27], v[44:47]
    v_mfma_f32_16x16x32_bf16 v[48:51], v[144:147], v[28:31], v[48:51]
    ds_read_b128 v[20:23], v3 offset:10240
    v_mfma_f32_16x16x32_bf16 v[52:55], v[148:151], v[28:31], v[52:55]
    s_waitcnt lgkmcnt(4)
    v_mfma_f32_16x16x32_bf16 v[40:43], v[152:155], v[32:35], v[40:43]
    ds_read_b128 v[24:27], v2 offset:12288
    v_mfma_f32_16x16x32_bf16 v[44:47], v[156:159], v[32:35], v[44:47]
    v_mfma_f32_16x16x32_bf16 v[48:51], v[152:155], v[36:39], v[48:51]
    ds_read_b128 v[28:31], v2 offset:14336
    v_mfma_f32_16x16x32_bf16 v[52:55], v[156:159], v[36:39], v[52:55]
    s_add_u32 m0, s40, 4096
    s_add_u32 s45, s39, 128
    buffer_load_dwordx4 v1, s[12:15], s45 offen lds
    s_waitcnt lgkmcnt(4)
    v_mfma_f32_16x16x32_bf16 v[40:43], v[160:163], v[8:11], v[40:43]
    ds_read_b128 v[32:35], v3 offset:12288
    v_mfma_f32_16x16x32_bf16 v[44:47], v[164:167], v[8:11], v[44:47]
    v_mfma_f32_16x16x32_bf16 v[48:51], v[160:163], v[12:15], v[48:51]
    ds_read_b128 v[36:39], v3 offset:14336
    v_mfma_f32_16x16x32_bf16 v[52:55], v[164:167], v[12:15], v[52:55]
    s_waitcnt lgkmcnt(4)
    v_mfma_f32_16x16x32_bf16 v[40:43], v[168:171], v[16:19], v[40:43]
    ds_read_b128 v[8:11], v2 offset:16384
    v_mfma_f32_16x16x32_bf16 v[44:47], v[172:175], v[16:19], v[44:47]
    v_mfma_f32_16x16x32_bf16 v[48:51], v[168:171], v[20:23], v[48:51]
    ds_read_b128 v[12:15], v2 offset:18432
    v_mfma_f32_16x16x32_bf16 v[52:55], v[172:175], v[20:23], v[52:55]
    s_add_u32 m0, s40, 8192
    s_add_u32 s45, s39, 256
    buffer_load_dwordx4 v1, s[12:15], s45 offen lds
    s_waitcnt lgkmcnt(4)
    v_mfma_f32_16x16x32_bf16 v[40:43], v[176:179], v[24:27], v[40:43]
    ds_read_b128 v[16:19], v3 offset:16384
    v_mfma_f32_16x16x32_bf16 v[44:47], v[180:183], v[24:27], v[44:47]
    v_mfma_f32_16x16x32_bf16 v[48:51], v[176:179], v[28:31], v[48:51]
    ds_read_b128 v[20:23], v3 offset:18432
    v_mfma_f32_16x16x32_bf16 v[52:55], v[180:183], v[28:31], v[52:55]
    s_waitcnt lgkmcnt(4)
    v_mfma_f32_16x16x32_bf16 v[40:43], v[184:187], v[32:35], v[40:43]
    ds_read_b128 v[24:27], v2 offset:20480
    v_mfma_f32_16x16x32_bf16 v[44:47], v[188:191], v[32:35], v[44:47]
    v_mfma_f32_16x16x32_bf16 v[48:51], v[184:187], v[36:39], v[48:51]
    ds_read_b128 v[28:31], v2 offset:22528
    v_mfma_f32_16x16x32_bf16 v[52:55], v[188:191], v[36:39], v[52:55]
    s_add_u32 m0, s40, 12288
    s_add_u32 s45, s39, 384
    buffer_load_dwordx4 v1, s[12:15], s45 offen lds
    s_waitcnt lgkmcnt(4)
    v_mfma_f32_16x16x32_bf16 v[40:43], v[192:195], v[8:11], v[40:43]
    ds_read_b128 v[32:35], v3 offset:20480
    v_mfma_f32_16x16x32_bf16 v[44:47], v[196:199], v[8:11], v[44:47]
    v_mfma_f32_16x16x32_bf16 v[48:51], v[192:195], v[12:15], v[48:51]
    ds_read_b128 v[36:39], v3 offset:22528
    v_mfma_f32_16x16x32_bf16 v[52:55], v[196:199], v[12:15], v[52:55]
    s_waitcnt lgkmcnt(4)
    v_mfma_f32_16x16x32_bf16 v[40:43], v[200:203], v[16:19], v[40:43]
    ds_read_b128 v[8:11], v2 offset:24576
    v_mfma_f32_16x16x32_bf16 v[44:47], v[204:207], v[16:19], v[44:47]
    v_mfma_f32_16x16x32_bf16 v[48:51], v[200:203], v[20:23], v[48:51]
    ds_read_b128 v[12:15], v2 offset:26624
    v_mfma_f32_16x16x32_bf16 v[52:55], v[204:207], v[20:23], v[52:55]
    s_add_u32 m0, s40, 16384
    s_add_u32 s45, s39, 512
    buffer_load_dwordx4 v1, s[12:15], s45 offen lds
    s_waitcnt lgkmcnt(4)
    v_mfma_f32_16x16x32_bf16 v[40:43], v[208:211], v[24:27], v[40:43]
    ds_read_b128 v[16:19], v3 offset:24576
    v_mfma_f32_16x16x32_bf16 v[44:47], v[212:215], v[24:27], v[44:47]
    v_mfma_f32_16x16x32_bf16 v[48:51], v[208:211], v[28:31], v[48:51]
    ds_read_b128 v[20:23], v3 offset:26624
    v_mfma_f32_16x16x32_bf16 v[52:55], v[212:215], v[28:31], v[52:55]
    s_waitcnt lgkmcnt(4)
    v_mfma_f32_16x16x32_bf16 v[40:43], v[216:219], v[32:35], v[40:43]
    ds_read_b128 v[24:27], v2 offset:28672
    v_mfma_f32_16x16x32_bf16 v[44:47], v[220:223], v[32:35], v[44:47]
    v_mfma_f32_16x16x32_bf16 v[48:51], v[216:219], v[36:39], v[48:51]
    ds_read_b128 v[28:31], v2 offset:30720
    v_mfma_f32_16x16x32_bf16 v[52:55], v[220:223], v[36:39], v[52:55]
    s_add_u32 m0, s40, 20480
    s_add_u32 s45, s39, 640
    buffer_load_dwordx4 v1, s[12:15], s45 offen lds
    s_waitcnt lgkmcnt(4)
    v_mfma_f32_16x16x32_bf16 v[40:43], v[224:227], v[8:11], v[40:43]
    ds_read_b128 v[32:35], v3 offset:28672
    v_mfma_f32_16x16x32_bf16 v[44:47], v[228:231], v[8:11], v[44:47]
    v_mfma_f32_16x16x32_bf16 v[48:51], v[224:227], v[12:15], v[48:51]
    ds_read_b128 v[36:39], v3 offset:30720
    v_mfma_f32_16x16x32_bf16 v[52:55], v[228:231], v[12:15], v[52:55]
    s_waitcnt lgkmcnt(4)
    v_mfma_f32_16x16x32_bf16 v[40:43], v[232:235], v[16:19], v[40:43]
    v_mfma_f32_16x16x32_bf16 v[44:47], v[236:239], v[16:19], v[44:47]
    v_mfma_f32_16x16x32_bf16 v[48:51], v[232:235], v[20:23], v[48:51]
    v_mfma_f32_16x16x32_bf16 v[52:55], v[236:239], v[20:23], v[52:55]
    s_add_u32 m0, s40, 24576
    s_add_u32 s45, s39, 768
    buffer_load_dwordx4 v1, s[12:15], s45 offen lds
    s_waitcnt lgkmcnt(2)
    v_mfma_f32_16x16x32_bf16 v[40:43], v[240:243], v[24:27], v[40:43]
    v_mfma_f32_16x16x32_bf16 v[44:47], v[244:247], v[24:27], v[44:47]
    v_mfma_f32_16x16x32_bf16 v[48:51], v[240:243], v[28:31], v[48:51]
    v_mfma_f32_16x16x32_bf16 v[52:55], v[244:247], v[28:31], v[52:55]
    s_waitcnt lgkmcnt(0)
    v_mfma_f32_16x16x32_bf16 v[40:43], v[248:251], v[32:35], v[40:43]
    v_mfma_f32_16x16x32_bf16 v[44:47], v[252:255], v[32:35], v[44:47]
    v_mfma_f32_16x16x32_bf16 v[48:51], v[248:251], v[36:39], v[48:51]
    v_mfma_f32_16x16x32_bf16 v[52:55], v[252:255], v[36:39], v[52:55]
    s_add_u32 m0, s40, 28672
    s_add_u32 s45, s39, 896
    buffer_load_dwordx4 v1, s[12:15], s45 offen lds
    s_add_u32 s39, s39, 32768
    s_add_u32 s40, s40, 32768
    s_and_b32 s40, s40, 0x1ffff
    v_add_u32 v2, 0x8000, v2
    v_and_b32 v2, 0x1ffff, v2
    v_add_u32 v3, 0x8000, v3
    v_and_b32 v3, 0x1ffff, v3
    v_cvt_pk_bf16_f32 v56, v40, v44
    v_cvt_pk_bf16_f32 v57, v41, v45
    v_cvt_pk_bf16_f32 v58, v42, v46
    v_cvt_pk_bf16_f32 v59, v43, v47
    v_cvt_pk_bf16_f32 v60, v48, v52
    v_cvt_pk_bf16_f32 v61, v49, v53
    v_cvt_pk_bf16_f32 v62, v50, v54
    v_cvt_pk_bf16_f32 v63, v51, v55
    s_add_u32 s33, s41, 4096
    buffer_store_dwordx4 v[56:59], v4, s[4:7], s41 offen sc1
    buffer_store_dwordx4 v[60:63], v4, s[4:7], s33 offen sc1
    s_add_u32 s41, s41, 8192
    s_add_u32 s38, s38, 1
    s_cmp_lt_u32 s38, 64
    s_cbranch_scc1 L_kvtop_31
    s_waitcnt vmcnt(0)
    s_barrier
    v_mov_b32 v106, 64
    buffer_store_dword v106, off, s[4:7], s42 sc1
    s_endpgm
L_kv_v_30:
    s_lshl_b32 s32, s28, 11
    s_add_u32 s41, s41, s32
    s_waitcnt vmcnt(0)
    s_branch L_kvent_37
    .p2align 6
L_kvtop_36:
    s_waitcnt vmcnt(11)
L_kvent_37:
    s_barrier
    s_max_u32 s32, s38, 1
    s_sub_u32 s32, s32, 1
    v_mov_b32 v106, s32
    buffer_store_dword v106, off, s[4:7], s42 sc1
    ds_read_b128 v[8:11], v2 offset:0
    ds_read_b128 v[12:15], v2 offset:2048
    ds_read_b128 v[16:19], v3 offset:0
    ds_read_b128 v[20:23], v3 offset:2048
    ds_read_b128 v[24:27], v2 offset:4096
    ds_read_b128 v[28:31], v2 offset:6144
    s_waitcnt lgkmcnt(4)
    v_mfma_f32_16x16x32_bf16 v[40:43], v[8:11], v[128:131], 0
    ds_read_b128 v[32:35], v3 offset:4096
    v_mfma_f32_16x16x32_bf16 v[44:47], v[8:11], v[132:135], 0
    v_mfma_f32_16x16x32_bf16 v[48:51], v[12:15], v[128:131], 0
    ds_read_b128 v[36:39], v3 offset:6144
    v_mfma_f32_16x16x32_bf16 v[52:55], v[12:15], v[132:135], 0
    s_waitcnt lgkmcnt(4)
    v_mfma_f32_16x16x32_bf16 v[40:43], v[16:19], v[136:139], v[40:43]
    ds_read_b128 v[8:11], v2 offset:8192
    v_mfma_f32_16x16x32_bf16 v[44:47], v[16:19], v[140:143], v[44:47]
    v_mfma_f32_16x16x32_bf16 v[48:51], v[20:23], v[136:139], v[48:51]
    ds_read_b128 v[12:15], v2 offset:10240
    v_mfma_f32_16x16x32_bf16 v[52:55], v[20:23], v[140:143], v[52:55]
    s_add_u32 m0, s40, 0
    s_add_u32 s45, s39, 0
    buffer_load_dwordx4 v1, s[12:15], s45 offen lds
    s_waitcnt lgkmcnt(4)
    v_mfma_f32_16x16x32_bf16 v[40:43], v[24:27], v[144:147], v[40:43]
    ds_read_b128 v[16:19], v3 offset:8192
    v_mfma_f32_16x16x32_bf16 v[44:47], v[24:27], v[148:151], v[44:47]
    v_mfma_f32_16x16x32_bf16 v[48:51], v[28:31], v[144:147], v[48:51]
    ds_read_b128 v[20:23], v3 offset:10240
    v_mfma_f32_16x16x32_bf16 v[52:55], v[28:31], v[148:151], v[52:55]
    s_waitcnt lgkmcnt(4)
    v_mfma_f32_16x16x32_bf16 v[40:43], v[32:35], v[152:155], v[40:43]
    ds_read_b128 v[24:27], v2 offset:12288
    v_mfma_f32_16x16x32_bf16 v[44:47], v[32:35], v[156:159], v[44:47]
    v_mfma_f32_16x16x32_bf16 v[48:51], v[36:39], v[152:155], v[48:51]
    ds_read_b128 v[28:31], v2 offset:14336
    v_mfma_f32_16x16x32_bf16 v[52:55], v[36:39], v[156:159], v[52:55]
    s_add_u32 m0, s40, 4096
    s_add_u32 s45, s39, 128
    buffer_load_dwordx4 v1, s[12:15], s45 offen lds
    s_waitcnt lgkmcnt(4)
    v_mfma_f32_16x16x32_bf16 v[40:43], v[8:11], v[160:163], v[40:43]
    ds_read_b128 v[32:35], v3 offset:12288
    v_mfma_f32_16x16x32_bf16 v[44:47], v[8:11], v[164:167], v[44:47]
    v_mfma_f32_16x16x32_bf16 v[48:51], v[12:15], v[160:163], v[48:51]
    ds_read_b128 v[36:39], v3 offset:14336
    v_mfma_f32_16x16x32_bf16 v[52:55], v[12:15], v[164:167], v[52:55]
    s_waitcnt lgkmcnt(4)
    v_mfma_f32_16x16x32_bf16 v[40:43], v[16:19], v[168:171], v[40:43]
    ds_read_b128 v[8:11], v2 offset:16384
    v_mfma_f32_16x16x32_bf16 v[44:47], v[16:19], v[172:175], v[44:47]
    v_mfma_f32_16x16x32_bf16 v[48:51], v[20:23], v[168:171], v[48:51]
    ds_read_b128 v[12:15], v2 offset:18432
    v_mfma_f32_16x16x32_bf16 v[52:55], v[20:23], v[172:175], v[52:55]
    s_add_u32 m0, s40, 8192
    s_add_u32 s45, s39, 256
    buffer_load_dwordx4 v1, s[12:15], s45 offen lds
    s_waitcnt lgkmcnt(4)
    v_mfma_f32_16x16x32_bf16 v[40:43], v[24:27], v[176:179], v[40:43]
    ds_read_b128 v[16:19], v3 offset:16384
    v_mfma_f32_16x16x32_bf16 v[44:47], v[24:27], v[180:183], v[44:47]
    v_mfma_f32_16x16x32_bf16 v[48:51], v[28:31], v[176:179], v[48:51]
    ds_read_b128 v[20:23], v3 offset:18432
    v_mfma_f32_16x16x32_bf16 v[52:55], v[28:31], v[180:183], v[52:55]
    s_waitcnt lgkmcnt(4)
    v_mfma_f32_16x16x32_bf16 v[40:43], v[32:35], v[184:187], v[40:43]
    ds_read_b128 v[24:27], v2 offset:20480
    v_mfma_f32_16x16x32_bf16 v[44:47], v[32:35], v[188:191], v[44:47]
    v_mfma_f32_16x16x32_bf16 v[48:51], v[36:39], v[184:187], v[48:51]
    ds_read_b128 v[28:31], v2 offset:22528
    v_mfma_f32_16x16x32_bf16 v[52:55], v[36:39], v[188:191], v[52:55]
    s_add_u32 m0, s40, 12288
    s_add_u32 s45, s39, 384
    buffer_load_dwordx4 v1, s[12:15], s45 offen lds
    s_waitcnt lgkmcnt(4)
    v_mfma_f32_16x16x32_bf16 v[40:43], v[8:11], v[192:195], v[40:43]
    ds_read_b128 v[32:35], v3 offset:20480
    v_mfma_f32_16x16x32_bf16 v[44:47], v[8:11], v[196:199], v[44:47]
    v_mfma_f32_16x16x32_bf16 v[48:51], v[12:15], v[192:195], v[48:51]
    ds_read_b128 v[36:39], v3 offset:22528
    v_mfma_f32_16x16x32_bf16 v[52:55], v[12:15], v[196:199], v[52:55]
    s_waitcnt lgkmcnt(4)
    v_mfma_f32_16x16x32_bf16 v[40:43], v[16:19], v[200:203], v[40:43]
    ds_read_b128 v[8:11], v2 offset:24576
    v_mfma_f32_16x16x32_bf16 v[44:47], v[16:19], v[204:207], v[44:47]
    v_mfma_f32_16x16x32_bf16 v[48:51], v[20:23], v[200:203], v[48:51]
    ds_read_b128 v[12:15], v2 offset:26624
    v_mfma_f32_16x16x32_bf16 v[52:55], v[20:23], v[204:207], v[52:55]
    s_add_u32 m0, s40, 16384
    s_add_u32 s45, s39, 512
    buffer_load_dwordx4 v1, s[12:15], s45 offen lds
    s_waitcnt lgkmcnt(4)
    v_mfma_f32_16x16x32_bf16 v[40:43], v[24:27], v[208:211], v[40:43]
    ds_read_b128 v[16:19], v3 offset:24576
    v_mfma_f32_16x16x32_bf16 v[44:47], v[24:27], v[212:215], v[44:47]
    v_mfma_f32_16x16x32_bf16 v[48:51], v[28:31], v[208:211], v[48:51]
    ds_read_b128 v[20:23], v3 offset:26624
    v_mfma_f32_16x16x32_bf16 v[52:55], v[28:31], v[212:215], v[52:55]
    s_waitcnt lgkmcnt(4)
    v_mfma_f32_16x16x32_bf16 v[40:43], v[32:35], v[216:219], v[40:43]
    ds_read_b128 v[24:27], v2 offset:28672
    v_mfma_f32_16x16x32_bf16 v[44:47], v[32:35], v[220:223], v[44:47]
    v_mfma_f32_16x16x32_bf16 v[48:51], v[36:39], v[216:219], v[48:51]
    ds_read_b128 v[28:31], v2 offset:30720
    v_mfma_f32_16x16x32_bf16 v[52:55], v[36:39], v[220:223], v[52:55]
    s_add_u32 m0, s40, 20480
    s_add_u32 s45, s39, 640
    buffer_load_dwordx4 v1, s[12:15], s45 offen lds
    s_waitcnt lgkmcnt(4)
    v_mfma_f32_16x16x32_bf16 v[40:43], v[8:11], v[224:227], v[40:43]
    ds_read_b128 v[32:35], v3 offset:28672
    v_mfma_f32_16x16x32_bf16 v[44:47], v[8:11], v[228:231], v[44:47]
    v_mfma_f32_16x16x32_bf16 v[48:51], v[12:15], v[224:227], v[48:51]
    ds_read_b128 v[36:39], v3 offset:30720
    v_mfma_f32_16x16x32_bf16 v[52:55], v[12:15], v[228:231], v[52:55]
    s_waitcnt lgkmcnt(4)
    v_mfma_f32_16x16x32_bf16 v[40:43], v[16:19], v[232:235], v[40:43]
    v_mfma_f32_16x16x32_bf16 v[44:47], v[16:19], v[236:239], v[44:47]
    v_mfma_f32_16x16x32_bf16 v[48:51], v[20:23], v[232:235], v[48:51]
    v_mfma_f32_16x16x32_bf16 v[52:55], v[20:23], v[236:239], v[52:55]
    s_add_u32 m0, s40, 24576
    s_add_u32 s45, s39, 768
    buffer_load_dwordx4 v1, s[12:15], s45 offen lds
    s_waitcnt lgkmcnt(2)
    v_mfma_f32_16x16x32_bf16 v[40:43], v[24:27], v[240:243], v[40:43]
    v_mfma_f32_16x16x32_bf16 v[44:47], v[24:27], v[244:247], v[44:47]
    v_mfma_f32_16x16x32_bf16 v[48:51], v[28:31], v[240:243], v[48:51]
    v_mfma_f32_16x16x32_bf16 v[52:55], v[28:31], v[244:247], v[52:55]
    s_waitcnt lgkmcnt(0)
    v_mfma_f32_16x16x32_bf16 v[40:43], v[32:35], v[248:251], v[40:43]
    v_mfma_f32_16x16x32_bf16 v[44:47], v[32:35], v[252:255], v[44:47]
    v_mfma_f32_16x16x32_bf16 v[48:51], v[36:39], v[248:251], v[48:51]
    v_mfma_f32_16x16x32_bf16 v[52:55], v[36:39], v[252:255], v[52:55]
    s_add_u32 m0, s40, 28672
    s_add_u32 s45, s39, 896
    buffer_load_dwordx4 v1, s[12:15], s45 offen lds
    s_add_u32 s39, s39, 32768
    s_add_u32 s40, s40, 32768
    s_and_b32 s40, s40, 0x1ffff
    v_add_u32 v2, 0x8000, v2
    v_and_b32 v2, 0x1ffff, v2
    v_add_u32 v3, 0x8000, v3
    v_and_b32 v3, 0x1ffff, v3
    v_cvt_pk_bf16_f32 v56, v40, v41
    v_cvt_pk_bf16_f32 v57, v42, v43
    v_cvt_pk_bf16_f32 v58, v48, v49
    v_cvt_pk_bf16_f32 v59, v50, v51
    v_cvt_pk_bf16_f32 v60, v44, v45
    v_cvt_pk_bf16_f32 v61, v46, v47
    v_cvt_pk_bf16_f32 v62, v52, v53
    v_cvt_pk_bf16_f32 v63, v54, v55
    s_add_u32 s33, s41, 1024
    buffer_store_dwordx4 v[56:59], v4, s[4:7], s41 offen sc1
    buffer_store_dwordx4 v[60:63], v4, s[4:7], s33 offen sc1
    s_add_u32 s41, s41, 8192
    s_add_u32 s38, s38, 1
    s_cmp_lt_u32 s38, 64
    s_cbranch_scc1 L_kvtop_36
    s_waitcnt vmcnt(0)
    s_barrier
    v_mov_b32 v106, 64
    buffer_store_dword v106, off, s[4:7], s42 sc1
    s_endpgm
L_w2:
    s_mov_b32 s8, s86
    s_and_b32 s9, s87, 0xffff
    s_mov_b32 s10, 0x400000
    s_mov_b32 s11, 0x20000
    s_mov_b32 s12, s82
    s_and_b32 s13, s83, 0xffff
    s_mov_b32 s14, 0x200000
    s_mov_b32 s15, 0x20000
    s_mov_b32 s20, s96
    s_and_b32 s21, s97, 0xffff
    s_mov_b32 s22, 0x800000
    s_mov_b32 s23, 0x20000
    s_mov_b32 s24, s92
    s_and_b32 s25, s93, 0xffff
    s_mov_b32 s26, 0x400000
    s_mov_b32 s27, 0x20000
    s_mov_b32 s55, 0x05040100
    s_mov_b32 s56, 0x07060302
    s_mov_b32 s58, 0x3e0293ee
    s_mov_b32 s59, 0x3e0293ee
    v_and_b32 v240, 63, v0
    v_and_b32 v241, 15, v240
    v_lshrrev_b32 v242, 4, v240
    v_lshrrev_b32 v243, 4, v240
    v_and_b32 v244, 7, v240
    v_xor_b32 v243, v243, v244
    s_and_b32 s32, s28, 1
    s_lshl_b32 s32, s32, 2
    v_xor_b32 v243, s32, v243
    v_lshlrev_b32 v243, 4, v243
    v_lshrrev_b32 v244, 3, v240
    v_lshl_add_u32 v243, v244, 10, v243
    s_lshl_b32 s32, s28, 13
    v_add_u32 v1, s32, v243
    v_lshrrev_b32 v243, 1, v241
    v_xor_b32 v243, v243, v242
    v_lshlrev_b32 v243, 4, v243
    v_lshl_add_u32 v2, v241, 7, v243
    v_xor_b32 v3, 64, v2
    v_lshlrev_b32 v4, 4, v240
    v_mov_b32 v8, 0xff000000
    v_lshlrev_b32 v243, 16, v242
    v_lshl_add_u32 v243, v241, 2, v243
    s_lshl_b32 s32, s29, 8
    s_lshl_b32 s33, s28, 6
    s_add_u32 s32, s32, s33
    v_add_u32 v245, s32, v243
    v_lshlrev_b32 v243, 13, v242
    v_lshl_add_u32 v243, v241, 4, v243
    s_lshl_b32 s32, s29, 17
    s_lshl_b32 s33, s28, 8
    s_add_u32 s32, s32, s33
    v_add_u32 v246, s32, v243
    v_lshrrev_b32 v243, 2, v241
    v_lshlrev_b32 v243, 1, v243
    v_and_b32 v244, 1, v241
    v_add_u32 v243, v243, v244
    v_xor_b32 v243, v243, v242
    v_lshlrev_b32 v243, 5, v243
    v_lshl_add_u32 v5, v242, 8, v243
    v_xor_b32 v178, 128, v5
    v_lshlrev_b32 v243, 16, v242
    v_lshl_add_u32 v243, v241, 4, v243
    s_lshl_b32 s32, s28, 18
    s_lshl_b32 s33, s29, 8
    s_add_u32 s32, s32, s33
    v_add_u32 v6, s32, v243
    v_lshlrev_b32 v243, 12, v241
    v_lshl_add_u32 v7, v242, 6, v243
    v_and_b32 v244, 1, v241
    v_lshlrev_b32 v244, 4, v244
    v_mov_b32 v243, 0x3f80
    v_lshlrev_b32 v244, v244, v243
    v_lshrrev_b32 v243, 1, v241
    v_cmp_eq_u32 vcc, 0, v243
    s_nop 1
    v_cndmask_b32 v12, 0, v244, vcc
    v_cmp_eq_u32 vcc, 1, v243
    s_nop 1
    v_cndmask_b32 v13, 0, v244, vcc
    v_cmp_eq_u32 vcc, 2, v243
    s_nop 1
    v_cndmask_b32 v14, 0, v244, vcc
    v_cmp_eq_u32 vcc, 3, v243
    s_nop 1
    v_cndmask_b32 v15, 0, v244, vcc
    s_sub_u32 s38, s30, 3
    s_lshl_b32 s32, s38, 21
    s_add_u32 s44, s32, 0x3000000
    s_lshl_b32 s32, s29, 15
    s_lshl_b32 s33, s28, 13
    s_add_u32 s32, s32, s33
    s_add_u32 s45, s44, s32
    s_lshl_b32 s32, s29, 19
    s_lshl_b32 s33, s38, 13
    s_add_u32 s32, s32, s33
    s_add_u32 s42, s32, 0x1000000
    s_add_u32 s43, s32, 0x5000000
    s_lshl_b32 s32, s29, 8
    s_add_u32 s50, s32, 0x0
    s_add_u32 s51, s32, 0x4000
    s_lshl_b32 s32, s38, 17
    s_and_b32 s33, s29, 1
    s_lshl_b32 s33, s33, 16
    s_add_u32 s32, s32, s33
    s_lshr_b32 s33, s29, 1
    s_lshl_b32 s33, s33, 7
    s_add_u32 s32, s32, s33
    s_lshl_b32 s33, s28, 3
    s_add_u32 s32, s32, s33
    s_add_u32 s46, s32, 2048
    v_mov_b32 v228, -1
    v_mov_b32 v229, -1
    v_mov_b32 v230, -1
    v_mov_b32 v231, -1
    s_lshl_b32 s32, s28, 10
    s_add_u32 s33, s43, s32
    buffer_store_dwordx4 v[228:231], v4, s[4:7], s33 offen sc1
    s_add_u32 s33, s33, 32768
    buffer_store_dwordx4 v[228:231], v4, s[4:7], s33 offen sc1
    s_add_u32 s33, s33, 32768
    buffer_store_dwordx4 v[228:231], v4, s[4:7], s33 offen sc1
    s_add_u32 s33, s33, 32768
    buffer_store_dwordx4 v[228:231], v4, s[4:7], s33 offen sc1
    s_add_u32 s33, s33, 32768
    s_lshl_b32 s40, s38, 15
    s_lshl_b32 s41, s28, 10
    s_add_u32 m0, s41, 0
    s_add_u32 s54, s40, 0
    buffer_load_dwordx4 v1, s[12:15], s54 offen lds
    s_add_u32 m0, s41, 4096
    s_add_u32 s54, s40, 128
    buffer_load_dwordx4 v1, s[12:15], s54 offen lds
    s_add_u32 m0, s41, 8192
    s_add_u32 s54, s40, 256
    buffer_load_dwordx4 v1, s[12:15], s54 offen lds
    s_add_u32 m0, s41, 12288
    s_add_u32 s54, s40, 384
    buffer_load_dwordx4 v1, s[12:15], s54 offen lds
    s_add_u32 m0, s41, 16384
    s_add_u32 s54, s40, 512
    buffer_load_dwordx4 v1, s[12:15], s54 offen lds
    s_add_u32 m0, s41, 20480
    s_add_u32 s54, s40, 640
    buffer_load_dwordx4 v1, s[12:15], s54 offen lds
    s_add_u32 m0, s41, 24576
    s_add_u32 s54, s40, 768
    buffer_load_dwordx4 v1, s[12:15], s54 offen lds
    s_add_u32 m0, s41, 28672
    s_add_u32 s54, s40, 896
    buffer_load_dwordx4 v1, s[12:15], s54 offen lds
    s_add_u32 s40, s40, 131072
    s_xor_b32 s41, s41, 0x8000
    s_mov_b32 s33, 0
    buffer_load_dword v16, v245, s[8:11], s33 offen
    s_mov_b32 s33, 8192
    buffer_load_dword v17, v245, s[8:11], s33 offen
    s_mov_b32 s33, 16384
    buffer_load_dword v18, v245, s[8:11], s33 offen
    s_mov_b32 s33, 24576
    buffer_load_dword v19, v245, s[8:11], s33 offen
    s_mov_b32 s33, 32768
    buffer_load_dword v20, v245, s[8:11], s33 offen
    s_mov_b32 s33, 40960
    buffer_load_dword v21, v245, s[8:11], s33 offen
    s_mov_b32 s33, 49152
    buffer_load_dword v22, v245, s[8:11], s33 offen
    s_mov_b32 s33, 57344
    buffer_load_dword v23, v245, s[8:11], s33 offen
    s_mov_b32 s33, 262144
    buffer_load_dword v24, v245, s[8:11], s33 offen
    s_mov_b32 s33, 270336
    buffer_load_dword v25, v245, s[8:11], s33 offen
    s_mov_b32 s33, 278528
    buffer_load_dword v26, v245, s[8:11], s33 offen
    s_mov_b32 s33, 286720
    buffer_load_dword v27, v245, s[8:11], s33 offen
    s_mov_b32 s33, 294912
    buffer_load_dword v28, v245, s[8:11], s33 offen
    s_mov_b32 s33, 303104
    buffer_load_dword v29, v245, s[8:11], s33 offen
    s_mov_b32 s33, 311296
    buffer_load_dword v30, v245, s[8:11], s33 offen
    s_mov_b32 s33, 319488
    buffer_load_dword v31, v245, s[8:11], s33 offen
    s_mov_b32 s33, 524288
    buffer_load_dword v32, v245, s[8:11], s33 offen
    s_mov_b32 s33, 532480
    buffer_load_dword v33, v245, s[8:11], s33 offen
    s_mov_b32 s33, 540672
    buffer_load_dword v34, v245, s[8:11], s33 offen
    s_mov_b32 s33, 548864
    buffer_load_dword v35, v245, s[8:11], s33 offen
    s_mov_b32 s33, 557056
    buffer_load_dword v36, v245, s[8:11], s33 offen
    s_mov_b32 s33, 565248
    buffer_load_dword v37, v245, s[8:11], s33 offen
    s_mov_b32 s33, 573440
    buffer_load_dword v38, v245, s[8:11], s33 offen
    s_mov_b32 s33, 581632
    buffer_load_dword v39, v245, s[8:11], s33 offen
    s_mov_b32 s33, 786432
    buffer_load_dword v40, v245, s[8:11], s33 offen
    s_mov_b32 s33, 794624
    buffer_load_dword v41, v245, s[8:11], s33 offen
    s_mov_b32 s33, 802816
    buffer_load_dword v42, v245, s[8:11], s33 offen
    s_mov_b32 s33, 811008
    buffer_load_dword v43, v245, s[8:11], s33 offen
    s_mov_b32 s33, 819200
    buffer_load_dword v44, v245, s[8:11], s33 offen
    s_mov_b32 s33, 827392
    buffer_load_dword v45, v245, s[8:11], s33 offen
    s_mov_b32 s33, 835584
    buffer_load_dword v46, v245, s[8:11], s33 offen
    s_mov_b32 s33, 843776
    buffer_load_dword v47, v245, s[8:11], s33 offen
    s_mov_b32 s33, 1048576
    buffer_load_dword v48, v245, s[8:11], s33 offen
    s_mov_b32 s33, 1056768
    buffer_load_dword v49, v245, s[8:11], s33 offen
    s_mov_b32 s33, 1064960
    buffer_load_dword v50, v245, s[8:11], s33 offen
    s_mov_b32 s33, 1073152
    buffer_load_dword v51, v245, s[8:11], s33 offen
    s_mov_b32 s33, 1081344
    buffer_load_dword v52, v245, s[8:11], s33 offen
    s_mov_b32 s33, 1089536
    buffer_load_dword v53, v245, s[8:11], s33 offen
    s_mov_b32 s33, 1097728
    buffer_load_dword v54, v245, s[8:11], s33 offen
    s_mov_b32 s33, 1105920
    buffer_load_dword v55, v245, s[8:11], s33 offen
    s_waitcnt vmcnt(48)
    s_barrier
    s_cmp_lg_u32 s28, 0
    s_cbranch_scc1 L_arr_38
    s_mul_i32 s32, s31, 6
    s_lshl_b64 s[34:35], 1, s32
    s_or_b32 s35, s35, 0x01000000
    s_lshl_b32 s32, s30, 3
    v_mov_b32 v232, s34
    v_mov_b32 v233, s35
    v_mov_b32 v234, s32
    s_mov_b64 s[36:37], exec
    s_mov_b64 exec, 1
    buffer_atomic_add_x2 v[232:233], v234, s[16:19], 0 offen offset:128
    s_mov_b64 exec, s[36:37]
L_arr_38:
    s_mov_b32 s33, 1310720
    buffer_load_dword v56, v245, s[8:11], s33 offen
    s_mov_b32 s33, 1318912
    buffer_load_dword v57, v245, s[8:11], s33 offen
    s_mov_b32 s33, 1327104
    buffer_load_dword v58, v245, s[8:11], s33 offen
    s_mov_b32 s33, 1335296
    buffer_load_dword v59, v245, s[8:11], s33 offen
    s_mov_b32 s33, 1343488
    buffer_load_dword v60, v245, s[8:11], s33 offen
    s_mov_b32 s33, 1351680
    buffer_load_dword v61, v245, s[8:11], s33 offen
    s_mov_b32 s33, 1359872
    buffer_load_dword v62, v245, s[8:11], s33 offen
    s_mov_b32 s33, 1368064
    buffer_load_dword v63, v245, s[8:11], s33 offen
    s_waitcnt vmcnt(40)
    v_perm_b32 v232, v17, v16, s55
    v_perm_b32 v233, v17, v16, s56
    v_accvgpr_write_b32 a0, v232
    v_accvgpr_write_b32 a4, v233
    v_perm_b32 v232, v19, v18, s55
    v_perm_b32 v233, v19, v18, s56
    v_accvgpr_write_b32 a1, v232
    v_accvgpr_write_b32 a5, v233
    v_perm_b32 v232, v21, v20, s55
    v_perm_b32 v233, v21, v20, s56
    v_accvgpr_write_b32 a2, v232
    v_accvgpr_write_b32 a6, v233
    v_perm_b32 v232, v23, v22, s55
    v_perm_b32 v233, v23, v22, s56
    v_accvgpr_write_b32 a3, v232
    v_accvgpr_write_b32 a7, v233
    s_mov_b32 s33, 1572864
    buffer_load_dword v16, v245, s[8:11], s33 offen
    s_mov_b32 s33, 1581056
    buffer_load_dword v17, v245, s[8:11], s33 offen
    s_mov_b32 s33, 1589248
    buffer_load_dword v18, v245, s[8:11], s33 offen
    s_mov_b32 s33, 1597440
    buffer_load_dword v19, v245, s[8:11], s33 offen
    s_mov_b32 s33, 1605632
    buffer_load_dword v20, v245, s[8:11], s33 offen
    s_mov_b32 s33, 1613824
    buffer_load_dword v21, v245, s[8:11], s33 offen
    s_mov_b32 s33, 1622016
    buffer_load_dword v22, v245, s[8:11], s33 offen
    s_mov_b32 s33, 1630208
    buffer_load_dword v23, v245, s[8:11], s33 offen
    s_waitcnt vmcnt(40)
    v_perm_b32 v232, v25, v24, s55
    v_perm_b32 v233, v25, v24, s56
    v_accvgpr_write_b32 a8, v232
    v_accvgpr_write_b32 a12, v233
    v_perm_b32 v232, v27, v26, s55
    v_perm_b32 v233, v27, v26, s56
    v_accvgpr_write_b32 a9, v232
    v_accvgpr_write_b32 a13, v233
    v_perm_b32 v232, v29, v28, s55
    v_perm_b32 v233, v29, v28, s56
    v_accvgpr_write_b32 a10, v232
    v_accvgpr_write_b32 a14, v233
    v_perm_b32 v232, v31, v30, s55
    v_perm_b32 v233, v31, v30, s56
    v_accvgpr_write_b32 a11, v232
    v_accvgpr_write_b32 a15, v233
    s_mov_b32 s33, 1835008
    buffer_load_dword v24, v245, s[8:11], s33 offen
    s_mov_b32 s33, 1843200
    buffer_load_dword v25, v245, s[8:11], s33 offen
    s_mov_b32 s33, 1851392
    buffer_load_dword v26, v245, s[8:11], s33 offen
    s_mov_b32 s33, 1859584
    buffer_load_dword v27, v245, s[8:11], s33 offen
    s_mov_b32 s33, 1867776
    buffer_load_dword v28, v245, s[8:11], s33 offen
    s_mov_b32 s33, 1875968
    buffer_load_dword v29, v245, s[8:11], s33 offen
    s_mov_b32 s33, 1884160
    buffer_load_dword v30, v245, s[8:11], s33 offen
    s_mov_b32 s33, 1892352
    buffer_load_dword v31, v245, s[8:11], s33 offen
    s_waitcnt vmcnt(40)
    v_perm_b32 v232, v33, v32, s55
    v_perm_b32 v233, v33, v32, s56
    v_accvgpr_write_b32 a16, v232
    v_accvgpr_write_b32 a20, v233
    v_perm_b32 v232, v35, v34, s55
    v_perm_b32 v233, v35, v34, s56
    v_accvgpr_write_b32 a17, v232
    v_accvgpr_write_b32 a21, v233
    v_perm_b32 v232, v37, v36, s55
    v_perm_b32 v233, v37, v36, s56
    v_accvgpr_write_b32 a18, v232
    v_accvgpr_write_b32 a22, v233
    v_perm_b32 v232, v39, v38, s55
    v_perm_b32 v233, v39, v38, s56
    v_accvgpr_write_b32 a19, v232
    v_accvgpr_write_b32 a23, v233
    s_mov_b32 s33, 2097152
    buffer_load_dword v32, v245, s[8:11], s33 offen
    s_mov_b32 s33, 2105344
    buffer_load_dword v33, v245, s[8:11], s33 offen
    s_mov_b32 s33, 2113536
    buffer_load_dword v34, v245, s[8:11], s33 offen
    s_mov_b32 s33, 2121728
    buffer_load_dword v35, v245, s[8:11], s33 offen
    s_mov_b32 s33, 2129920
    buffer_load_dword v36, v245, s[8:11], s33 offen
    s_mov_b32 s33, 2138112
    buffer_load_dword v37, v245, s[8:11], s33 offen
    s_mov_b32 s33, 2146304
    buffer_load_dword v38, v245, s[8:11], s33 offen
    s_mov_b32 s33, 2154496
    buffer_load_dword v39, v245, s[8:11], s33 offen
    s_waitcnt vmcnt(40)
    v_perm_b32 v232, v41, v40, s55
    v_perm_b32 v233, v41, v40, s56
    v_accvgpr_write_b32 a24, v232
    v_accvgpr_write_b32 a28, v233
    v_perm_b32 v232, v43, v42, s55
    v_perm_b32 v233, v43, v42, s56
    v_accvgpr_write_b32 a25, v232
    v_accvgpr_write_b32 a29, v233
    v_perm_b32 v232, v45, v44, s55
    v_perm_b32 v233, v45, v44, s56
    v_accvgpr_write_b32 a26, v232
    v_accvgpr_write_b32 a30, v233
    v_perm_b32 v232, v47, v46, s55
    v_perm_b32 v233, v47, v46, s56
    v_accvgpr_write_b32 a27, v232
    v_accvgpr_write_b32 a31, v233
    s_mov_b32 s33, 2359296
    buffer_load_dword v40, v245, s[8:11], s33 offen
    s_mov_b32 s33, 2367488
    buffer_load_dword v41, v245, s[8:11], s33 offen
    s_mov_b32 s33, 2375680
    buffer_load_dword v42, v245, s[8:11], s33 offen
    s_mov_b32 s33, 2383872
    buffer_load_dword v43, v245, s[8:11], s33 offen
    s_mov_b32 s33, 2392064
    buffer_load_dword v44, v245, s[8:11], s33 offen
    s_mov_b32 s33, 2400256
    buffer_load_dword v45, v245, s[8:11], s33 offen
    s_mov_b32 s33, 2408448
    buffer_load_dword v46, v245, s[8:11], s33 offen
    s_mov_b32 s33, 2416640
    buffer_load_dword v47, v245, s[8:11], s33 offen
    s_waitcnt vmcnt(40)
    v_perm_b32 v232, v49, v48, s55
    v_perm_b32 v233, v49, v48, s56
    v_accvgpr_write_b32 a32, v232
    v_accvgpr_write_b32 a36, v233
    v_perm_b32 v232, v51, v50, s55
    v_perm_b32 v233, v51, v50, s56
    v_accvgpr_write_b32 a33, v232
    v_accvgpr_write_b32 a37, v233
    v_perm_b32 v232, v53, v52, s55
    v_perm_b32 v233, v53, v52, s56
    v_accvgpr_write_b32 a34, v232
    v_accvgpr_write_b32 a38, v233
    v_perm_b32 v232, v55, v54, s55
    v_perm_b32 v233, v55, v54, s56
    v_accvgpr_write_b32 a35, v232
    v_accvgpr_write_b32 a39, v233
    s_mov_b32 s33, 2621440
    buffer_load_dword v48, v245, s[8:11], s33 offen
    s_mov_b32 s33, 2629632
    buffer_load_dword v49, v245, s[8:11], s33 offen
    s_mov_b32 s33, 2637824
    buffer_load_dword v50, v245, s[8:11], s33 offen
    s_mov_b32 s33, 2646016
    buffer_load_dword v51, v245, s[8:11], s33 offen
    s_mov_b32 s33, 2654208
    buffer_load_dword v52, v245, s[8:11], s33 offen
    s_mov_b32 s33, 2662400
    buffer_load_dword v53, v245, s[8:11], s33 offen
    s_mov_b32 s33, 2670592
    buffer_load_dword v54, v245, s[8:11], s33 offen
    s_mov_b32 s33, 2678784
    buffer_load_dword v55, v245, s[8:11], s33 offen
    s_waitcnt vmcnt(40)
    v_perm_b32 v232, v57, v56, s55
    v_perm_b32 v233, v57, v56, s56
    v_accvgpr_write_b32 a40, v232
    v_accvgpr_write_b32 a44, v233
    v_perm_b32 v232, v59, v58, s55
    v_perm_b32 v233, v59, v58, s56
    v_accvgpr_write_b32 a41, v232
    v_accvgpr_write_b32 a45, v233
    v_perm_b32 v232, v61, v60, s55
    v_perm_b32 v233, v61, v60, s56
    v_accvgpr_write_b32 a42, v232
    v_accvgpr_write_b32 a46, v233
    v_perm_b32 v232, v63, v62, s55
    v_perm_b32 v233, v63, v62, s56
    v_accvgpr_write_b32 a43, v232
    v_accvgpr_write_b32 a47, v233
    s_mov_b32 s33, 2883584
    buffer_load_dword v56, v245, s[8:11], s33 offen
    s_mov_b32 s33, 2891776
    buffer_load_dword v57, v245, s[8:11], s33 offen
    s_mov_b32 s33, 2899968
    buffer_load_dword v58, v245, s[8:11], s33 offen
    s_mov_b32 s33, 2908160
    buffer_load_dword v59, v245, s[8:11], s33 offen
    s_mov_b32 s33, 2916352
    buffer_load_dword v60, v245, s[8:11], s33 offen
    s_mov_b32 s33, 2924544
    buffer_load_dword v61, v245, s[8:11], s33 offen
    s_mov_b32 s33, 2932736
    buffer_load_dword v62, v245, s[8:11], s33 offen
    s_mov_b32 s33, 2940928
    buffer_load_dword v63, v245, s[8:11], s33 offen
    s_waitcnt vmcnt(40)
    v_perm_b32 v232, v17, v16, s55
    v_perm_b32 v233, v17, v16, s56
    v_accvgpr_write_b32 a48, v232
    v_accvgpr_write_b32 a52, v233
    v_perm_b32 v232, v19, v18, s55
    v_perm_b32 v233, v19, v18, s56
    v_accvgpr_write_b32 a49, v232
    v_accvgpr_write_b32 a53, v233
    v_perm_b32 v232, v21, v20, s55
    v_perm_b32 v233, v21, v20, s56
    v_accvgpr_write_b32 a50, v232
    v_accvgpr_write_b32 a54, v233
    v_perm_b32 v232, v23, v22, s55
    v_perm_b32 v233, v23, v22, s56
    v_accvgpr_write_b32 a51, v232
    v_accvgpr_write_b32 a55, v233
    s_mov_b32 s33, 3145728
    buffer_load_dword v16, v245, s[8:11], s33 offen
    s_mov_b32 s33, 3153920
    buffer_load_dword v17, v245, s[8:11], s33 offen
    s_mov_b32 s33, 3162112
    buffer_load_dword v18, v245, s[8:11], s33 offen
    s_mov_b32 s33, 3170304
    buffer_load_dword v19, v245, s[8:11], s33 offen
    s_mov_b32 s33, 3178496
    buffer_load_dword v20, v245, s[8:11], s33 offen
    s_mov_b32 s33, 3186688
    buffer_load_dword v21, v245, s[8:11], s33 offen
    s_mov_b32 s33, 3194880
    buffer_load_dword v22, v245, s[8:11], s33 offen
    s_mov_b32 s33, 3203072
    buffer_load_dword v23, v245, s[8:11], s33 offen
    s_waitcnt vmcnt(40)
    v_perm_b32 v232, v25, v24, s55
    v_perm_b32 v233, v25, v24, s56
    v_accvgpr_write_b32 a56, v232
    v_accvgpr_write_b32 a60, v233
    v_perm_b32 v232, v27, v26, s55
    v_perm_b32 v233, v27, v26, s56
    v_accvgpr_write_b32 a57, v232
    v_accvgpr_write_b32 a61, v233
    v_perm_b32 v232, v29, v28, s55
    v_perm_b32 v233, v29, v28, s56
    v_accvgpr_write_b32 a58, v232
    v_accvgpr_write_b32 a62, v233
    v_perm_b32 v232, v31, v30, s55
    v_perm_b32 v233, v31, v30, s56
    v_accvgpr_write_b32 a59, v232
    v_accvgpr_write_b32 a63, v233
    s_mov_b32 s33, 3407872
    buffer_load_dword v24, v245, s[8:11], s33 offen
    s_mov_b32 s33, 3416064
    buffer_load_dword v25, v245, s[8:11], s33 offen
    s_mov_b32 s33, 3424256
    buffer_load_dword v26, v245, s[8:11], s33 offen
    s_mov_b32 s33, 3432448
    buffer_load_dword v27, v245, s[8:11], s33 offen
    s_mov_b32 s33, 3440640
    buffer_load_dword v28, v245, s[8:11], s33 offen
    s_mov_b32 s33, 3448832
    buffer_load_dword v29, v245, s[8:11], s33 offen
    s_mov_b32 s33, 3457024
    buffer_load_dword v30, v245, s[8:11], s33 offen
    s_mov_b32 s33, 3465216
    buffer_load_dword v31, v245, s[8:11], s33 offen
    s_waitcnt vmcnt(40)
    v_perm_b32 v232, v33, v32, s55
    v_perm_b32 v233, v33, v32, s56
    v_accvgpr_write_b32 a64, v232
    v_accvgpr_write_b32 a68, v233
    v_perm_b32 v232, v35, v34, s55
    v_perm_b32 v233, v35, v34, s56
    v_accvgpr_write_b32 a65, v232
    v_accvgpr_write_b32 a69, v233
    v_perm_b32 v232, v37, v36, s55
    v_perm_b32 v233, v37, v36, s56
    v_accvgpr_write_b32 a66, v232
    v_accvgpr_write_b32 a70, v233
    v_perm_b32 v232, v39, v38, s55
    v_perm_b32 v233, v39, v38, s56
    v_accvgpr_write_b32 a67, v232
    v_accvgpr_write_b32 a71, v233
    s_mov_b32 s33, 3670016
    buffer_load_dword v32, v245, s[8:11], s33 offen
    s_mov_b32 s33, 3678208
    buffer_load_dword v33, v245, s[8:11], s33 offen
    s_mov_b32 s33, 3686400
    buffer_load_dword v34, v245, s[8:11], s33 offen
    s_mov_b32 s33, 3694592
    buffer_load_dword v35, v245, s[8:11], s33 offen
    s_mov_b32 s33, 3702784
    buffer_load_dword v36, v245, s[8:11], s33 offen
    s_mov_b32 s33, 3710976
    buffer_load_dword v37, v245, s[8:11], s33 offen
    s_mov_b32 s33, 3719168
    buffer_load_dword v38, v245, s[8:11], s33 offen
    s_mov_b32 s33, 3727360
    buffer_load_dword v39, v245, s[8:11], s33 offen
    s_waitcnt vmcnt(40)
    v_perm_b32 v232, v41, v40, s55
    v_perm_b32 v233, v41, v40, s56
    v_accvgpr_write_b32 a72, v232
    v_accvgpr_write_b32 a76, v233
    v_perm_b32 v232, v43, v42, s55
    v_perm_b32 v233, v43, v42, s56
    v_accvgpr_write_b32 a73, v232
    v_accvgpr_write_b32 a77, v233
    v_perm_b32 v232, v45, v44, s55
    v_perm_b32 v233, v45, v44, s56
    v_accvgpr_write_b32 a74, v232
    v_accvgpr_write_b32 a78, v233
    v_perm_b32 v232, v47, v46, s55
    v_perm_b32 v233, v47, v46, s56
    v_accvgpr_write_b32 a75, v232
    v_accvgpr_write_b32 a79, v233
    s_mov_b32 s33, 3932160
    buffer_load_dword v40, v245, s[8:11], s33 offen
    s_mov_b32 s33, 3940352
    buffer_load_dword v41, v245, s[8:11], s33 offen
    s_mov_b32 s33, 3948544
    buffer_load_dword v42, v245, s[8:11], s33 offen
    s_mov_b32 s33, 3956736
    buffer_load_dword v43, v245, s[8:11], s33 offen
    s_mov_b32 s33, 3964928
    buffer_load_dword v44, v245, s[8:11], s33 offen
    s_mov_b32 s33, 3973120
    buffer_load_dword v45, v245, s[8:11], s33 offen
    s_mov_b32 s33, 3981312
    buffer_load_dword v46, v245, s[8:11], s33 offen
    s_mov_b32 s33, 3989504
    buffer_load_dword v47, v245, s[8:11], s33 offen
    s_waitcnt vmcnt(40)
    v_perm_b32 v232, v49, v48, s55
    v_perm_b32 v233, v49, v48, s56
    v_accvgpr_write_b32 a80, v232
    v_accvgpr_write_b32 a84, v233
    v_perm_b32 v232, v51, v50, s55
    v_perm_b32 v233, v51, v50, s56
    v_accvgpr_write_b32 a81, v232
    v_accvgpr_write_b32 a85, v233
    v_perm_b32 v232, v53, v52, s55
    v_perm_b32 v233, v53, v52, s56
    v_accvgpr_write_b32 a82, v232
    v_accvgpr_write_b32 a86, v233
    v_perm_b32 v232, v55, v54, s55
    v_perm_b32 v233, v55, v54, s56
    v_accvgpr_write_b32 a83, v232
    v_accvgpr_write_b32 a87, v233
    s_waitcnt vmcnt(32)
    v_perm_b32 v232, v57, v56, s55
    v_perm_b32 v233, v57, v56, s56
    v_accvgpr_write_b32 a88, v232
    v_accvgpr_write_b32 a92, v233
    v_perm_b32 v232, v59, v58, s55
    v_perm_b32 v233, v59, v58, s56
    v_accvgpr_write_b32 a89, v232
    v_accvgpr_write_b32 a93, v233
    v_perm_b32 v232, v61, v60, s55
    v_perm_b32 v233, v61, v60, s56
    v_accvgpr_write_b32 a90, v232
    v_accvgpr_write_b32 a94, v233
    v_perm_b32 v232, v63, v62, s55
    v_perm_b32 v233, v63, v62, s56
    v_accvgpr_write_b32 a91, v232
    v_accvgpr_write_b32 a95, v233
    s_waitcnt vmcnt(24)
    v_perm_b32 v232, v17, v16, s55
    v_perm_b32 v233, v17, v16, s56
    v_accvgpr_write_b32 a96, v232
    v_accvgpr_write_b32 a100, v233
    v_perm_b32 v232, v19, v18, s55
    v_perm_b32 v233, v19, v18, s56
    v_accvgpr_write_b32 a97, v232
    v_accvgpr_write_b32 a101, v233
    v_perm_b32 v232, v21, v20, s55
    v_perm_b32 v233, v21, v20, s56
    v_accvgpr_write_b32 a98, v232
    v_accvgpr_write_b32 a102, v233
    v_perm_b32 v232, v23, v22, s55
    v_perm_b32 v233, v23, v22, s56
    v_accvgpr_write_b32 a99, v232
    v_accvgpr_write_b32 a103, v233
    s_waitcnt vmcnt(16)
    v_perm_b32 v232, v25, v24, s55
    v_perm_b32 v233, v25, v24, s56
    v_accvgpr_write_b32 a104, v232
    v_accvgpr_write_b32 a108, v233
    v_perm_b32 v232, v27, v26, s55
    v_perm_b32 v233, v27, v26, s56
    v_accvgpr_write_b32 a105, v232
    v_accvgpr_write_b32 a109, v233
    v_perm_b32 v232, v29, v28, s55
    v_perm_b32 v233, v29, v28, s56
    v_accvgpr_write_b32 a106, v232
    v_accvgpr_write_b32 a110, v233
    v_perm_b32 v232, v31, v30, s55
    v_perm_b32 v233, v31, v30, s56
    v_accvgpr_write_b32 a107, v232
    v_accvgpr_write_b32 a111, v233
    s_waitcnt vmcnt(8)
    v_perm_b32 v232, v33, v32, s55
    v_perm_b32 v233, v33, v32, s56
    v_accvgpr_write_b32 a112, v232
    v_accvgpr_write_b32 a116, v233
    v_perm_b32 v232, v35, v34, s55
    v_perm_b32 v233, v35, v34, s56
    v_accvgpr_write_b32 a113, v232
    v_accvgpr_write_b32 a117, v233
    v_perm_b32 v232, v37, v36, s55
    v_perm_b32 v233, v37, v36, s56
    v_accvgpr_write_b32 a114, v232
    v_accvgpr_write_b32 a118, v233
    v_perm_b32 v232, v39, v38, s55
    v_perm_b32 v233, v39, v38, s56
    v_accvgpr_write_b32 a115, v232
    v_accvgpr_write_b32 a119, v233
    s_waitcnt vmcnt(0)
    v_perm_b32 v232, v41, v40, s55
    v_perm_b32 v233, v41, v40, s56
    v_accvgpr_write_b32 a120, v232
    v_accvgpr_write_b32 a124, v233
    v_perm_b32 v232, v43, v42, s55
    v_perm_b32 v233, v43, v42, s56
    v_accvgpr_write_b32 a121, v232
    v_accvgpr_write_b32 a125, v233
    v_perm_b32 v232, v45, v44, s55
    v_perm_b32 v233, v45, v44, s56
    v_accvgpr_write_b32 a122, v232
    v_accvgpr_write_b32 a126, v233
    v_perm_b32 v232, v47, v46, s55
    v_perm_b32 v233, v47, v46, s56
    v_accvgpr_write_b32 a123, v232
    v_accvgpr_write_b32 a127, v233
    s_mov_b32 s33, 0
    buffer_load_dwordx4 v[16:19], v246, s[24:27], s33 offen
    s_mov_b32 s33, 1024
    buffer_load_dwordx4 v[20:23], v246, s[24:27], s33 offen
    s_mov_b32 s33, 2048
    buffer_load_dwordx4 v[24:27], v246, s[24:27], s33 offen
    s_mov_b32 s33, 3072
    buffer_load_dwordx4 v[28:31], v246, s[24:27], s33 offen
    s_mov_b32 s33, 4096
    buffer_load_dwordx4 v[32:35], v246, s[24:27], s33 offen
    s_mov_b32 s33, 5120
    buffer_load_dwordx4 v[36:39], v246, s[24:27], s33 offen
    s_mov_b32 s33, 6144
    buffer_load_dwordx4 v[40:43], v246, s[24:27], s33 offen
    s_mov_b32 s33, 7168
    buffer_load_dwordx4 v[44:47], v246, s[24:27], s33 offen
    s_mov_b32 s33, 32768
    buffer_load_dwordx4 v[48:51], v246, s[24:27], s33 offen
    s_mov_b32 s33, 33792
    buffer_load_dwordx4 v[52:55], v246, s[24:27], s33 offen
    s_mov_b32 s33, 34816
    buffer_load_dwordx4 v[56:59], v246, s[24:27], s33 offen
    s_mov_b32 s33, 35840
    buffer_load_dwordx4 v[60:63], v246, s[24:27], s33 offen
    s_mov_b32 s33, 36864
    buffer_load_dwordx4 v[64:67], v246, s[24:27], s33 offen
    s_mov_b32 s33, 37888
    buffer_load_dwordx4 v[68:71], v246, s[24:27], s33 offen
    s_mov_b32 s33, 38912
    buffer_load_dwordx4 v[72:75], v246, s[24:27], s33 offen
    s_mov_b32 s33, 39936
    buffer_load_dwordx4 v[76:79], v246, s[24:27], s33 offen
    s_mov_b32 s33, 65536
    buffer_load_dwordx4 v[80:83], v246, s[24:27], s33 offen
    s_mov_b32 s33, 66560
    buffer_load_dwordx4 v[84:87], v246, s[24:27], s33 offen
    s_mov_b32 s33, 67584
    buffer_load_dwordx4 v[88:91], v246, s[24:27], s33 offen
    s_mov_b32 s33, 68608
    buffer_load_dwordx4 v[92:95], v246, s[24:27], s33 offen
    s_mov_b32 s33, 69632
    buffer_load_dwordx4 v[96:99], v246, s[24:27], s33 offen
    s_mov_b32 s33, 70656
    buffer_load_dwordx4 v[100:103], v246, s[24:27], s33 offen
    s_mov_b32 s33, 71680
    buffer_load_dwordx4 v[104:107], v246, s[24:27], s33 offen
    s_mov_b32 s33, 72704
    buffer_load_dwordx4 v[108:111], v246, s[24:27], s33 offen
    s_waitcnt vmcnt(16)
    v_perm_b32 v228, v20, v16, s55
    v_perm_b32 v229, v20, v16, s56
    v_perm_b32 v230, v21, v17, s55
    v_perm_b32 v231, v21, v17, s56
    v_perm_b32 v232, v22, v18, s55
    v_perm_b32 v233, v22, v18, s56
    v_perm_b32 v234, v23, v19, s55
    v_perm_b32 v235, v23, v19, s56
    v_accvgpr_write_b32 a128, v228
    v_accvgpr_write_b32 a144, v229
    v_accvgpr_write_b32 a160, v230
    v_accvgpr_write_b32 a176, v231
    v_accvgpr_write_b32 a192, v232
    v_accvgpr_write_b32 a208, v233
    v_accvgpr_write_b32 a224, v234
    v_accvgpr_write_b32 a240, v235
    v_perm_b32 v228, v28, v24, s55
    v_perm_b32 v229, v28, v24, s56
    v_perm_b32 v230, v29, v25, s55
    v_perm_b32 v231, v29, v25, s56
    v_perm_b32 v232, v30, v26, s55
    v_perm_b32 v233, v30, v26, s56
    v_perm_b32 v234, v31, v27, s55
    v_perm_b32 v235, v31, v27, s56
    v_accvgpr_write_b32 a129, v228
    v_accvgpr_write_b32 a145, v229
    v_accvgpr_write_b32 a161, v230
    v_accvgpr_write_b32 a177, v231
    v_accvgpr_write_b32 a193, v232
    v_accvgpr_write_b32 a209, v233
    v_accvgpr_write_b32 a225, v234
    v_accvgpr_write_b32 a241, v235
    v_perm_b32 v228, v36, v32, s55
    v_perm_b32 v229, v36, v32, s56
    v_perm_b32 v230, v37, v33, s55
    v_perm_b32 v231, v37, v33, s56
    v_perm_b32 v232, v38, v34, s55
    v_perm_b32 v233, v38, v34, s56
    v_perm_b32 v234, v39, v35, s55
    v_perm_b32 v235, v39, v35, s56
    v_accvgpr_write_b32 a130, v228
    v_accvgpr_write_b32 a146, v229
    v_accvgpr_write_b32 a162, v230
    v_accvgpr_write_b32 a178, v231
    v_accvgpr_write_b32 a194, v232
    v_accvgpr_write_b32 a210, v233
    v_accvgpr_write_b32 a226, v234
    v_accvgpr_write_b32 a242, v235
    v_perm_b32 v228, v44, v40, s55
    v_perm_b32 v229, v44, v40, s56
    v_perm_b32 v230, v45, v41, s55
    v_perm_b32 v231, v45, v41, s56
    v_perm_b32 v232, v46, v42, s55
    v_perm_b32 v233, v46, v42, s56
    v_perm_b32 v234, v47, v43, s55
    v_perm_b32 v235, v47, v43, s56
    v_accvgpr_write_b32 a131, v228
    v_accvgpr_write_b32 a147, v229
    v_accvgpr_write_b32 a163, v230
    v_accvgpr_write_b32 a179, v231
    v_accvgpr_write_b32 a195, v232
    v_accvgpr_write_b32 a211, v233
    v_accvgpr_write_b32 a227, v234
    v_accvgpr_write_b32 a243, v235
    s_mov_b32 s33, 98304
    buffer_load_dwordx4 v[16:19], v246, s[24:27], s33 offen
    s_mov_b32 s33, 99328
    buffer_load_dwordx4 v[20:23], v246, s[24:27], s33 offen
    s_mov_b32 s33, 100352
    buffer_load_dwordx4 v[24:27], v246, s[24:27], s33 offen
    s_mov_b32 s33, 101376
    buffer_load_dwordx4 v[28:31], v246, s[24:27], s33 offen
    s_mov_b32 s33, 102400
    buffer_load_dwordx4 v[32:35], v246, s[24:27], s33 offen
    s_mov_b32 s33, 103424
    buffer_load_dwordx4 v[36:39], v246, s[24:27], s33 offen
    s_mov_b32 s33, 104448
    buffer_load_dwordx4 v[40:43], v246, s[24:27], s33 offen
    s_mov_b32 s33, 105472
    buffer_load_dwordx4 v[44:47], v246, s[24:27], s33 offen
    s_waitcnt vmcnt(16)
    v_perm_b32 v228, v52, v48, s55
    v_perm_b32 v229, v52, v48, s56
    v_perm_b32 v230, v53, v49, s55
    v_perm_b32 v231, v53, v49, s56
    v_perm_b32 v232, v54, v50, s55
    v_perm_b32 v233, v54, v50, s56
    v_perm_b32 v234, v55, v51, s55
    v_perm_b32 v235, v55, v51, s56
    v_accvgpr_write_b32 a132, v228
    v_accvgpr_write_b32 a148, v229
    v_accvgpr_write_b32 a164, v230
    v_accvgpr_write_b32 a180, v231
    v_accvgpr_write_b32 a196, v232
    v_accvgpr_write_b32 a212, v233
    v_accvgpr_write_b32 a228, v234
    v_accvgpr_write_b32 a244, v235
    v_perm_b32 v228, v60, v56, s55
    v_perm_b32 v229, v60, v56, s56
    v_perm_b32 v230, v61, v57, s55
    v_perm_b32 v231, v61, v57, s56
    v_perm_b32 v232, v62, v58, s55
    v_perm_b32 v233, v62, v58, s56
    v_perm_b32 v234, v63, v59, s55
    v_perm_b32 v235, v63, v59, s56
    v_accvgpr_write_b32 a133, v228
    v_accvgpr_write_b32 a149, v229
    v_accvgpr_write_b32 a165, v230
    v_accvgpr_write_b32 a181, v231
    v_accvgpr_write_b32 a197, v232
    v_accvgpr_write_b32 a213, v233
    v_accvgpr_write_b32 a229, v234
    v_accvgpr_write_b32 a245, v235
    v_perm_b32 v228, v68, v64, s55
    v_perm_b32 v229, v68, v64, s56
    v_perm_b32 v230, v69, v65, s55
    v_perm_b32 v231, v69, v65, s56
    v_perm_b32 v232, v70, v66, s55
    v_perm_b32 v233, v70, v66, s56
    v_perm_b32 v234, v71, v67, s55
    v_perm_b32 v235, v71, v67, s56
    v_accvgpr_write_b32 a134, v228
    v_accvgpr_write_b32 a150, v229
    v_accvgpr_write_b32 a166, v230
    v_accvgpr_write_b32 a182, v231
    v_accvgpr_write_b32 a198, v232
    v_accvgpr_write_b32 a214, v233
    v_accvgpr_write_b32 a230, v234
    v_accvgpr_write_b32 a246, v235
    v_perm_b32 v228, v76, v72, s55
    v_perm_b32 v229, v76, v72, s56
    v_perm_b32 v230, v77, v73, s55
    v_perm_b32 v231, v77, v73, s56
    v_perm_b32 v232, v78, v74, s55
    v_perm_b32 v233, v78, v74, s56
    v_perm_b32 v234, v79, v75, s55
    v_perm_b32 v235, v79, v75, s56
    v_accvgpr_write_b32 a135, v228
    v_accvgpr_write_b32 a151, v229
    v_accvgpr_write_b32 a167, v230
    v_accvgpr_write_b32 a183, v231
    v_accvgpr_write_b32 a199, v232
    v_accvgpr_write_b32 a215, v233
    v_accvgpr_write_b32 a231, v234
    v_accvgpr_write_b32 a247, v235
    s_waitcnt vmcnt(8)
    v_perm_b32 v228, v84, v80, s55
    v_perm_b32 v229, v84, v80, s56
    v_perm_b32 v230, v85, v81, s55
    v_perm_b32 v231, v85, v81, s56
    v_perm_b32 v232, v86, v82, s55
    v_perm_b32 v233, v86, v82, s56
    v_perm_b32 v234, v87, v83, s55
    v_perm_b32 v235, v87, v83, s56
    v_accvgpr_write_b32 a136, v228
    v_accvgpr_write_b32 a152, v229
    v_accvgpr_write_b32 a168, v230
    v_accvgpr_write_b32 a184, v231
    v_accvgpr_write_b32 a200, v232
    v_accvgpr_write_b32 a216, v233
    v_accvgpr_write_b32 a232, v234
    v_accvgpr_write_b32 a248, v235
    v_perm_b32 v228, v92, v88, s55
    v_perm_b32 v229, v92, v88, s56
    v_perm_b32 v230, v93, v89, s55
    v_perm_b32 v231, v93, v89, s56
    v_perm_b32 v232, v94, v90, s55
    v_perm_b32 v233, v94, v90, s56
    v_perm_b32 v234, v95, v91, s55
    v_perm_b32 v235, v95, v91, s56
    v_accvgpr_write_b32 a137, v228
    v_accvgpr_write_b32 a153, v229
    v_accvgpr_write_b32 a169, v230
    v_accvgpr_write_b32 a185, v231
    v_accvgpr_write_b32 a201, v232
    v_accvgpr_write_b32 a217, v233
    v_accvgpr_write_b32 a233, v234
    v_accvgpr_write_b32 a249, v235
    v_perm_b32 v228, v100, v96, s55
    v_perm_b32 v229, v100, v96, s56
    v_perm_b32 v230, v101, v97, s55
    v_perm_b32 v231, v101, v97, s56
    v_perm_b32 v232, v102, v98, s55
    v_perm_b32 v233, v102, v98, s56
    v_perm_b32 v234, v103, v99, s55
    v_perm_b32 v235, v103, v99, s56
    v_accvgpr_write_b32 a138, v228
    v_accvgpr_write_b32 a154, v229
    v_accvgpr_write_b32 a170, v230
    v_accvgpr_write_b32 a186, v231
    v_accvgpr_write_b32 a202, v232
    v_accvgpr_write_b32 a218, v233
    v_accvgpr_write_b32 a234, v234
    v_accvgpr_write_b32 a250, v235
    v_perm_b32 v228, v108, v104, s55
    v_perm_b32 v229, v108, v104, s56
    v_perm_b32 v230, v109, v105, s55
    v_perm_b32 v231, v109, v105, s56
    v_perm_b32 v232, v110, v106, s55
    v_perm_b32 v233, v110, v106, s56
    v_perm_b32 v234, v111, v107, s55
    v_perm_b32 v235, v111, v107, s56
    v_accvgpr_write_b32 a139, v228
    v_accvgpr_write_b32 a155, v229
    v_accvgpr_write_b32 a171, v230
    v_accvgpr_write_b32 a187, v231
    v_accvgpr_write_b32 a203, v232
    v_accvgpr_write_b32 a219, v233
    v_accvgpr_write_b32 a235, v234
    v_accvgpr_write_b32 a251, v235
    s_waitcnt vmcnt(0)
    v_perm_b32 v228, v20, v16, s55
    v_perm_b32 v229, v20, v16, s56
    v_perm_b32 v230, v21, v17, s55
    v_perm_b32 v231, v21, v17, s56
    v_perm_b32 v232, v22, v18, s55
    v_perm_b32 v233, v22, v18, s56
    v_perm_b32 v234, v23, v19, s55
    v_perm_b32 v235, v23, v19, s56
    v_accvgpr_write_b32 a140, v228
    v_accvgpr_write_b32 a156, v229
    v_accvgpr_write_b32 a172, v230
    v_accvgpr_write_b32 a188, v231
    v_accvgpr_write_b32 a204, v232
    v_accvgpr_write_b32 a220, v233
    v_accvgpr_write_b32 a236, v234
    v_accvgpr_write_b32 a252, v235
    v_perm_b32 v228, v28, v24, s55
    v_perm_b32 v229, v28, v24, s56
    v_perm_b32 v230, v29, v25, s55
    v_perm_b32 v231, v29, v25, s56
    v_perm_b32 v232, v30, v26, s55
    v_perm_b32 v233, v30, v26, s56
    v_perm_b32 v234, v31, v27, s55
    v_perm_b32 v235, v31, v27, s56
    v_accvgpr_write_b32 a141, v228
    v_accvgpr_write_b32 a157, v229
    v_accvgpr_write_b32 a173, v230
    v_accvgpr_write_b32 a189, v231
    v_accvgpr_write_b32 a205, v232
    v_accvgpr_write_b32 a221, v233
    v_accvgpr_write_b32 a237, v234
    v_accvgpr_write_b32 a253, v235
    v_perm_b32 v228, v36, v32, s55
    v_perm_b32 v229, v36, v32, s56
    v_perm_b32 v230, v37, v33, s55
    v_perm_b32 v231, v37, v33, s56
    v_perm_b32 v232, v38, v34, s55
    v_perm_b32 v233, v38, v34, s56
    v_perm_b32 v234, v39, v35, s55
    v_perm_b32 v235, v39, v35, s56
    v_accvgpr_write_b32 a142, v228
    v_accvgpr_write_b32 a158, v229
    v_accvgpr_write_b32 a174, v230
    v_accvgpr_write_b32 a190, v231
    v_accvgpr_write_b32 a206, v232
    v_accvgpr_write_b32 a222, v233
    v_accvgpr_write_b32 a238, v234
    v_accvgpr_write_b32 a254, v235
    v_perm_b32 v228, v44, v40, s55
    v_perm_b32 v229, v44, v40, s56
    v_perm_b32 v230, v45, v41, s55
    v_perm_b32 v231, v45, v41, s56
    v_perm_b32 v232, v46, v42, s55
    v_perm_b32 v233, v46, v42, s56
    v_perm_b32 v234, v47, v43, s55
    v_perm_b32 v235, v47, v43, s56
    v_accvgpr_write_b32 a143, v228
    v_accvgpr_write_b32 a159, v229
    v_accvgpr_write_b32 a175, v230
    v_accvgpr_write_b32 a191, v231
    v_accvgpr_write_b32 a207, v232
    v_accvgpr_write_b32 a223, v233
    v_accvgpr_write_b32 a239, v234
    v_accvgpr_write_b32 a255, v235
    v_mov_b32 v228, -1
    v_mov_b32 v229, -1
    v_mov_b32 v230, -1
    v_mov_b32 v231, -1
    s_add_u32 s33, s45, 0
    buffer_store_dwordx4 v[228:231], v4, s[4:7], s33 offen offset:0 sc1
    buffer_store_dwordx4 v[228:231], v4, s[4:7], s33 offen offset:1024 sc1
    buffer_store_dwordx4 v[228:231], v4, s[4:7], s33 offen offset:2048 sc1
    buffer_store_dwordx4 v[228:231], v4, s[4:7], s33 offen offset:3072 sc1
    s_add_u32 s33, s45, 4096
    buffer_store_dwordx4 v[228:231], v4, s[4:7], s33 offen offset:0 sc1
    buffer_store_dwordx4 v[228:231], v4, s[4:7], s33 offen offset:1024 sc1
    buffer_store_dwordx4 v[228:231], v4, s[4:7], s33 offen offset:2048 sc1
    buffer_store_dwordx4 v[228:231], v4, s[4:7], s33 offen offset:3072 sc1
    s_add_u32 s33, s45, 1048576
    buffer_store_dwordx4 v[228:231], v4, s[4:7], s33 offen offset:0 sc1
    buffer_store_dwordx4 v[228:231], v4, s[4:7], s33 offen offset:1024 sc1
    buffer_store_dwordx4 v[228:231], v4, s[4:7], s33 offen offset:2048 sc1
    buffer_store_dwordx4 v[228:231], v4, s[4:7], s33 offen offset:3072 sc1
    s_add_u32 s33, s45, 1052672
    buffer_store_dwordx4 v[228:231], v4, s[4:7], s33 offen offset:0 sc1
    buffer_store_dwordx4 v[228:231], v4, s[4:7], s33 offen offset:1024 sc1
    buffer_store_dwordx4 v[228:231], v4, s[4:7], s33 offen offset:2048 sc1
    buffer_store_dwordx4 v[228:231], v4, s[4:7], s33 offen offset:3072 sc1
    s_lshl_b32 s32, s28, 10
    s_add_u32 s33, s43, s32
    s_add_u32 s32, s33, 131072
    buffer_store_dwordx4 v[228:231], v4, s[4:7], s32 offen sc1
    s_add_u32 s32, s33, 163840
    buffer_store_dwordx4 v[228:231], v4, s[4:7], s32 offen sc1
    s_add_u32 s32, s33, 196608
    buffer_store_dwordx4 v[228:231], v4, s[4:7], s32 offen sc1
    s_add_u32 s32, s33, 229376
    buffer_store_dwordx4 v[228:231], v4, s[4:7], s32 offen sc1
    s_add_u32 s32, s33, 262144
    buffer_store_dwordx4 v[228:231], v4, s[4:7], s32 offen sc1
    s_add_u32 s32, s33, 294912
    buffer_store_dwordx4 v[228:231], v4, s[4:7], s32 offen sc1
    s_add_u32 s32, s33, 327680
    buffer_store_dwordx4 v[228:231], v4, s[4:7], s32 offen sc1
    s_add_u32 s32, s33, 360448
    buffer_store_dwordx4 v[228:231], v4, s[4:7], s32 offen sc1
    s_add_u32 s32, s33, 393216
    buffer_store_dwordx4 v[228:231], v4, s[4:7], s32 offen sc1
    s_add_u32 s32, s33, 425984
    buffer_store_dwordx4 v[228:231], v4, s[4:7], s32 offen sc1
    s_add_u32 s32, s33, 458752
    buffer_store_dwordx4 v[228:231], v4, s[4:7], s32 offen sc1
    s_add_u32 s32, s33, 491520
    buffer_store_dwordx4 v[228:231], v4, s[4:7], s32 offen sc1
    s_waitcnt vmcnt(0)
    s_add_u32 s49, s30, 5
    s_barrier
    s_cmp_lg_u32 s28, 0
    s_cbranch_scc1 L_arr_39
    s_mul_i32 s32, s31, 6
    s_lshl_b64 s[34:35], 1, s32
    s_or_b32 s35, s35, 0x01000000
    s_lshl_b32 s32, s49, 3
    v_mov_b32 v232, s34
    v_mov_b32 v233, s35
    v_mov_b32 v234, s32
    s_mov_b64 s[36:37], exec
    s_mov_b64 exec, 1
    buffer_atomic_add_x2 v[232:233], v234, s[16:19], 0 offen offset:128
    s_mov_b64 exec, s[36:37]
L_arr_39:
    s_and_b32 s32, s28, 1
    s_lshl_b32 s32, s32, 4
    v_add_u32 v243, s32, v241
    v_lshlrev_b32 v244, 2, v242
    v_sub_u32 v243, v243, v244
    s_lshl_b32 s48, 1, s49
    s_or_b32 s48, s48, 0x06
    s_mov_b32 s32, 0
L_wa_40:
    v_mbcnt_lo_u32_b32 v230, -1, 0
    v_mbcnt_hi_u32_b32 v230, -1, v230
    v_and_b32 v230, 15, v230
    v_lshlrev_b32 v230, 3, v230
    buffer_load_dwordx2 v[228:229], v230, s[16:19], 0 offen offset:128 sc1
    s_add_u32 s32, s32, 1
    s_cmp_gt_u32 s32, 262144
    s_cbranch_scc1 L_fail
    s_waitcnt vmcnt(0)
L_wac_41:
    v_lshrrev_b32 v231, 24, v229
    v_cmp_ne_u32 vcc, 32, v231
    s_and_b32 s33, vcc_lo, s48
    s_cmp_lg_u32 s33, 0
    s_cbranch_scc0 L_wac_41_ok
    s_sleep 8
    s_branch L_wa_40
L_wac_41_ok:
    s_nop 3
    v_readlane_b32 s34, v228, s49
    v_readlane_b32 s35, v229, s49
    s_mul_i32 s32, s31, 6
    s_lshl_b64 s[36:37], 32, s32
    s_or_b32 s37, s37, 0x20000000
    s_cmp_eq_u64 s[34:35], s[36:37]
    s_cselect_b32 s52, 1, 0
    v_cmp_le_i32 s[64:65], 0, v243
    v_cmp_le_i32 s[66:67], 1, v243
    v_cmp_le_i32 s[68:69], 2, v243
    v_cmp_le_i32 s[70:71], 3, v243
    v_cmp_le_i32 s[72:73], 16, v243
    v_cmp_le_i32 s[74:75], 17, v243
    v_cmp_le_i32 s[76:77], 18, v243
    v_cmp_le_i32 s[78:79], 19, v243
    s_and_b32 s32, s28, 1
    s_lshl_b32 s32, s32, 12
    v_add_u32 v9, s32, v4
    s_lshr_b32 s33, s28, 1
    s_lshl_b32 s34, s33, 12
    v_add_u32 v10, s34, v4
    s_lshl_b32 s34, s33, 11
    v_add_u32 v11, s34, v9
    s_lshl_b32 s32, s28, 10
    v_add_u32 v243, s32, v4
    v_add_u32 v242, s34, v4
    v_add_u32 v9, 0x10000, v9
    v_add_u32 v11, 0x10000, v11
    v_add_u32 v243, 0x10000, v243
    v_add_u32 v241, 0x10000, v4
    s_mov_b32 s39, 0
    s_mov_b32 s47, 0
    s_mov_b32 s48, 0
    s_mov_b32 s49, 0
    .p2align 6
L_w2top_42:
    s_waitcnt vmcnt(0)
    s_barrier
    s_add_u32 m0, s41, 0
    s_add_u32 s54, s40, 0
    buffer_load_dwordx4 v1, s[12:15], s54 offen lds
    s_add_u32 m0, s41, 4096
    s_add_u32 s54, s40, 128
    buffer_load_dwordx4 v1, s[12:15], s54 offen lds
    s_add_u32 m0, s41, 8192
    s_add_u32 s54, s40, 256
    buffer_load_dwordx4 v1, s[12:15], s54 offen lds
    s_add_u32 m0, s41, 12288
    s_add_u32 s54, s40, 384
    buffer_load_dwordx4 v1, s[12:15], s54 offen lds
    s_add_u32 m0, s41, 16384
    s_add_u32 s54, s40, 512
    buffer_load_dwordx4 v1, s[12:15], s54 offen lds
    s_add_u32 m0, s41, 20480
    s_add_u32 s54, s40, 640
    buffer_load_dwordx4 v1, s[12:15], s54 offen lds
    s_add_u32 m0, s41, 24576
    s_add_u32 s54, s40, 768
    buffer_load_dwordx4 v1, s[12:15], s54 offen lds
    s_add_u32 m0, s41, 28672
    s_add_u32 s54, s40, 896
    buffer_load_dwordx4 v1, s[12:15], s54 offen lds
    s_add_u32 s40, s40, 131072
    s_xor_b32 s41, s41, 0x8000
    s_add_u32 s54, s38, 1
    s_mov_b32 s34, s54
    s_cmp_ge_u32 s48, s34
    s_cbranch_scc1 L_fok_43
    s_mov_b32 s53, 262144
    .p2align 6
L_fp_44:
    buffer_load_dwordx2 v[228:229], off, s[4:7], s50 sc1
    s_sub_u32 s53, s53, 1
    s_cbranch_scc1 L_fail
    s_waitcnt vmcnt(0)
    v_min_u32 v228, v228, v229
    v_cmp_gt_u32 vcc, s34, v228
    s_cbranch_vccnz L_fp_44
    v_readfirstlane_b32 s48, v228
L_fok_43:
    s_add_u32 s32, s42, 4096
    s_add_u32 s33, s42, 0x1000000
    buffer_load_dwordx4 v[88:91], v4, s[4:7], s42 offen offset:0 sc1
    buffer_load_dwordx4 v[92:95], v4, s[4:7], s42 offen offset:1024 sc1
    buffer_load_dwordx4 v[96:99], v4, s[4:7], s42 offen offset:2048 sc1
    buffer_load_dwordx4 v[100:103], v4, s[4:7], s42 offen offset:3072 sc1
    buffer_load_dwordx4 v[104:107], v4, s[4:7], s32 offen offset:0 sc1
    buffer_load_dwordx4 v[108:111], v4, s[4:7], s32 offen offset:1024 sc1
    buffer_load_dwordx4 v[112:115], v4, s[4:7], s32 offen offset:2048 sc1
    buffer_load_dwordx4 v[116:119], v4, s[4:7], s32 offen offset:3072 sc1
    buffer_load_dwordx4 v[120:123], v10, s[4:7], s33 offen offset:0 sc1
    buffer_load_dwordx4 v[124:127], v10, s[4:7], s33 offen offset:1024 sc1
    buffer_load_dwordx4 v[128:131], v10, s[4:7], s33 offen offset:2048 sc1
    buffer_load_dwordx4 v[132:135], v10, s[4:7], s33 offen offset:3072 sc1
    ds_read_b128 v[16:19], v2 offset:0
    ds_read_b128 v[20:23], v2 offset:2048
    ds_read_b128 v[24:27], v3 offset:0
    ds_read_b128 v[28:31], v3 offset:2048
    ds_read_b128 v[32:35], v2 offset:4096
    ds_read_b128 v[36:39], v2 offset:6144
    s_waitcnt lgkmcnt(4)
    v_mfma_f32_16x16x32_bf16 v[48:51], a[0:3], v[16:19], 0
    ds_read_b128 v[40:43], v3 offset:4096
    v_mfma_f32_16x16x32_bf16 v[52:55], a[4:7], v[16:19], 0
    v_mfma_f32_16x16x32_bf16 v[56:59], a[0:3], v[20:23], 0
    ds_read_b128 v[44:47], v3 offset:6144
    v_mfma_f32_16x16x32_bf16 v[60:63], a[4:7], v[20:23], 0
    s_waitcnt lgkmcnt(4)
    v_mfma_f32_16x16x32_bf16 v[48:51], a[8:11], v[24:27], v[48:51]
    ds_read_b128 v[16:19], v2 offset:8192
    v_mfma_f32_16x16x32_bf16 v[52:55], a[12:15], v[24:27], v[52:55]
    v_mfma_f32_16x16x32_bf16 v[56:59], a[8:11], v[28:31], v[56:59]
    ds_read_b128 v[20:23], v2 offset:10240
    v_mfma_f32_16x16x32_bf16 v[60:63], a[12:15], v[28:31], v[60:63]
    s_waitcnt lgkmcnt(4)
    v_mfma_f32_16x16x32_bf16 v[48:51], a[16:19], v[32:35], v[48:51]
    ds_read_b128 v[24:27], v3 offset:8192
    v_mfma_f32_16x16x32_bf16 v[52:55], a[20:23], v[32:35], v[52:55]
    v_mfma_f32_16x16x32_bf16 v[56:59], a[16:19], v[36:39], v[56:59]
    ds_read_b128 v[28:31], v3 offset:10240
    v_mfma_f32_16x16x32_bf16 v[60:63], a[20:23], v[36:39], v[60:63]
    s_waitcnt lgkmcnt(4)
    v_mfma_f32_16x16x32_bf16 v[48:51], a[24:27], v[40:43], v[48:51]
    ds_read_b128 v[32:35], v2 offset:12288
    v_mfma_f32_16x16x32_bf16 v[52:55], a[28:31], v[40:43], v[52:55]
    v_mfma_f32_16x16x32_bf16 v[56:59], a[24:27], v[44:47], v[56:59]
    ds_read_b128 v[36:39], v2 offset:14336
    v_mfma_f32_16x16x32_bf16 v[60:63], a[28:31], v[44:47], v[60:63]
    s_waitcnt lgkmcnt(4)
    v_mfma_f32_16x16x32_bf16 v[48:51], a[32:35], v[16:19], v[48:51]
    ds_read_b128 v[40:43], v3 offset:12288
    v_mfma_f32_16x16x32_bf16 v[52:55], a[36:39], v[16:19], v[52:55]
    v_mfma_f32_16x16x32_bf16 v[56:59], a[32:35], v[20:23], v[56:59]
    ds_read_b128 v[44:47], v3 offset:14336
    v_mfma_f32_16x16x32_bf16 v[60:63], a[36:39], v[20:23], v[60:63]
    s_waitcnt lgkmcnt(4)
    v_mfma_f32_16x16x32_bf16 v[48:51], a[40:43], v[24:27], v[48:51]
    ds_read_b128 v[16:19], v2 offset:16384
    v_mfma_f32_16x16x32_bf16 v[52:55], a[44:47], v[24:27], v[52:55]
    v_mfma_f32_16x16x32_bf16 v[56:59], a[40:43], v[28:31], v[56:59]
    ds_read_b128 v[20:23], v2 offset:18432
    v_mfma_f32_16x16x32_bf16 v[60:63], a[44:47], v[28:31], v[60:63]
    s_waitcnt lgkmcnt(4)
    v_mfma_f32_16x16x32_bf16 v[48:51], a[48:51], v[32:35], v[48:51]
    ds_read_b128 v[24:27], v3 offset:16384
    v_mfma_f32_16x16x32_bf16 v[52:55], a[52:55], v[32:35], v[52:55]
    v_mfma_f32_16x16x32_bf16 v[56:59], a[48:51], v[36:39], v[56:59]
    ds_read_b128 v[28:31], v3 offset:18432
    v_mfma_f32_16x16x32_bf16 v[60:63], a[52:55], v[36:39], v[60:63]
    s_waitcnt lgkmcnt(4)
    v_mfma_f32_16x16x32_bf16 v[48:51], a[56:59], v[40:43], v[48:51]
    ds_read_b128 v[32:35], v2 offset:20480
    v_mfma_f32_16x16x32_bf16 v[52:55], a[60:63], v[40:43], v[52:55]
    v_mfma_f32_16x16x32_bf16 v[56:59], a[56:59], v[44:47], v[56:59]
    ds_read_b128 v[36:39], v2 offset:22528
    v_mfma_f32_16x16x32_bf16 v[60:63], a[60:63], v[44:47], v[60:63]
    s_waitcnt lgkmcnt(4)
    v_mfma_f32_16x16x32_bf16 v[48:51], a[64:67], v[16:19], v[48:51]
    ds_read_b128 v[40:43], v3 offset:20480
    v_mfma_f32_16x16x32_bf16 v[52:55], a[68:71], v[16:19], v[52:55]
    v_mfma_f32_16x16x32_bf16 v[56:59], a[64:67], v[20:23], v[56:59]
    ds_read_b128 v[44:47], v3 offset:22528
    v_mfma_f32_16x16x32_bf16 v[60:63], a[68:71], v[20:23], v[60:63]
    s_waitcnt lgkmcnt(4)
    v_mfma_f32_16x16x32_bf16 v[48:51], a[72:75], v[24:27], v[48:51]
    ds_read_b128 v[16:19], v2 offset:24576
    v_mfma_f32_16x16x32_bf16 v[52:55], a[76:79], v[24:27], v[52:55]
    v_mfma_f32_16x16x32_bf16 v[56:59], a[72:75], v[28:31], v[56:59]
    ds_read_b128 v[20:23], v2 offset:26624
    v_mfma_f32_16x16x32_bf16 v[60:63], a[76:79], v[28:31], v[60:63]
    s_waitcnt lgkmcnt(4)
    v_mfma_f32_16x16x32_bf16 v[48:51], a[80:83], v[32:35], v[48:51]
    ds_read_b128 v[24:27], v3 offset:24576
    v_mfma_f32_16x16x32_bf16 v[52:55], a[84:87], v[32:35], v[52:55]
    v_mfma_f32_16x16x32_bf16 v[56:59], a[80:83], v[36:39], v[56:59]
    ds_read_b128 v[28:31], v3 offset:26624
    v_mfma_f32_16x16x32_bf16 v[60:63], a[84:87], v[36:39], v[60:63]
    s_waitcnt lgkmcnt(4)
    v_mfma_f32_16x16x32_bf16 v[48:51], a[88:91], v[40:43], v[48:51]
    ds_read_b128 v[32:35], v2 offset:28672
    v_mfma_f32_16x16x32_bf16 v[52:55], a[92:95], v[40:43], v[52:55]
    v_mfma_f32_16x16x32_bf16 v[56:59], a[88:91], v[44:47], v[56:59]
    ds_read_b128 v[36:39], v2 offset:30720
    v_mfma_f32_16x16x32_bf16 v[60:63], a[92:95], v[44:47], v[60:63]
    s_waitcnt lgkmcnt(4)
    v_mfma_f32_16x16x32_bf16 v[48:51], a[96:99], v[16:19], v[48:51]
    ds_read_b128 v[40:43], v3 offset:28672
    v_mfma_f32_16x16x32_bf16 v[52:55], a[100:103], v[16:19], v[52:55]
    v_mfma_f32_16x16x32_bf16 v[56:59], a[96:99], v[20:23], v[56:59]
    ds_read_b128 v[44:47], v3 offset:30720
    v_mfma_f32_16x16x32_bf16 v[60:63], a[100:103], v[20:23], v[60:63]
    s_waitcnt lgkmcnt(4)
    v_mfma_f32_16x16x32_bf16 v[48:51], a[104:107], v[24:27], v[48:51]
    v_mfma_f32_16x16x32_bf16 v[52:55], a[108:111], v[24:27], v[52:55]
    v_mfma_f32_16x16x32_bf16 v[56:59], a[104:107], v[28:31], v[56:59]
    v_mfma_f32_16x16x32_bf16 v[60:63], a[108:111], v[28:31], v[60:63]
    s_waitcnt lgkmcnt(2)
    v_mfma_f32_16x16x32_bf16 v[48:51], a[112:115], v[32:35], v[48:51]
    v_mfma_f32_16x16x32_bf16 v[52:55], a[116:119], v[32:35], v[52:55]
    v_mfma_f32_16x16x32_bf16 v[56:59], a[112:115], v[36:39], v[56:59]
    v_mfma_f32_16x16x32_bf16 v[60:63], a[116:119], v[36:39], v[60:63]
    s_waitcnt lgkmcnt(0)
    v_mfma_f32_16x16x32_bf16 v[48:51], a[120:123], v[40:43], v[48:51]
    v_mfma_f32_16x16x32_bf16 v[52:55], a[124:127], v[40:43], v[52:55]
    v_mfma_f32_16x16x32_bf16 v[56:59], a[120:123], v[44:47], v[56:59]
    v_mfma_f32_16x16x32_bf16 v[60:63], a[124:127], v[44:47], v[60:63]
    v_xor_b32 v2, 0x8000, v2
    v_xor_b32 v3, 0x8000, v3
    s_nop 5
    v_cvt_pk_bf16_f32 v64, v48, v52
    v_cvt_pk_bf16_f32 v65, v49, v53
    v_cvt_pk_bf16_f32 v66, v50, v54
    v_cvt_pk_bf16_f32 v67, v51, v55
    ds_write_b128 v243, v[64:67] offset:0
    v_cvt_pk_bf16_f32 v68, v56, v60
    v_cvt_pk_bf16_f32 v69, v57, v61
    v_cvt_pk_bf16_f32 v70, v58, v62
    v_cvt_pk_bf16_f32 v71, v59, v63
    ds_write_b128 v243, v[68:71] offset:4096
    s_waitcnt lgkmcnt(0)
    s_barrier
    ds_read_b128 v[72:75], v9 offset:0
    ds_read_b128 v[76:79], v9 offset:1024
    ds_read_b128 v[80:83], v9 offset:2048
    ds_read_b128 v[84:87], v9 offset:3072
    s_waitcnt lgkmcnt(0) vmcnt(0)
    v_mfma_f32_16x16x32_bf16 v[160:163], v[88:91], v[72:75], 0
    v_mfma_f32_16x16x32_bf16 v[160:163], v[92:95], v[76:79], v[160:163]
    v_mfma_f32_16x16x32_bf16 v[160:163], v[96:99], v[80:83], v[160:163]
    v_mfma_f32_16x16x32_bf16 v[160:163], v[100:103], v[84:87], v[160:163]
    v_mfma_f32_16x16x32_bf16 v[164:167], v[104:107], v[72:75], 0
    v_mfma_f32_16x16x32_bf16 v[164:167], v[108:111], v[76:79], v[164:167]
    v_mfma_f32_16x16x32_bf16 v[164:167], v[112:115], v[80:83], v[164:167]
    v_mfma_f32_16x16x32_bf16 v[164:167], v[116:119], v[84:87], v[164:167]
    s_nop 5
    v_cndmask_b32 v160, v8, v160, s[64:65]
    v_cndmask_b32 v161, v8, v161, s[66:67]
    v_cndmask_b32 v162, v8, v162, s[68:69]
    v_cndmask_b32 v163, v8, v163, s[70:71]
    v_cndmask_b32 v164, v8, v164, s[72:73]
    v_cndmask_b32 v165, v8, v165, s[74:75]
    v_cndmask_b32 v166, v8, v166, s[76:77]
    v_cndmask_b32 v167, v8, v167, s[78:79]
    v_max3_f32 v228, v160, v161, v162
    v_max3_f32 v228, v228, v163, v164
    v_max3_f32 v228, v228, v165, v166
    v_max_f32 v228, v228, v167
    v_mov_b32 v177, 0
    s_mov_b32 s53, 262144
L_km_45:
    buffer_load_dwordx2 v[136:137], v5, s[4:7], s43 offen offset:0 sc1
    buffer_load_dwordx2 v[138:139], v5, s[4:7], s43 offen offset:16 sc1
    buffer_load_dwordx2 v[140:141], v178, s[4:7], s43 offen offset:1024 sc1
    buffer_load_dwordx2 v[142:143], v178, s[4:7], s43 offen offset:1040 sc1
    buffer_load_dwordx2 v[144:145], v5, s[4:7], s43 offen offset:2048 sc1
    buffer_load_dwordx2 v[146:147], v5, s[4:7], s43 offen offset:2064 sc1
    buffer_load_dwordx2 v[148:149], v178, s[4:7], s43 offen offset:3072 sc1
    buffer_load_dwordx2 v[150:151], v178, s[4:7], s43 offen offset:3088 sc1
    buffer_load_dwordx2 v[152:153], v242, s[4:7], s43 offen offset:8 sc1
    buffer_load_dwordx2 v[156:157], v242, s[4:7], s43 offen offset:1032 sc1
    s_sub_u32 s53, s53, 1
    s_cbranch_scc1 L_fail
    s_waitcnt vmcnt(0)
    v_max3_u32 v232, v136, v138, v140
    v_max3_u32 v233, v142, v144, v146
    v_max3_u32 v232, v232, v148, v150
    v_max3_u32 v233, v233, v152, v156
    v_max_u32 v232, v232, v233
    v_cmp_eq_u32 vcc, -1, v232
    s_cbranch_vccz L_kmok_46
    s_sleep 1
    s_branch L_km_45
L_kmok_46:
    v_mfma_f32_16x16x32_bf16 v[168:171], v[136:139], v[72:75], 0
    v_mfma_f32_16x16x32_bf16 v[168:171], v[140:143], v[76:79], v[168:171]
    v_mfma_f32_16x16x32_bf16 v[168:171], v[144:147], v[80:83], v[168:171]
    v_mfma_f32_16x16x32_bf16 v[168:171], v[148:151], v[84:87], v[168:171]
    s_nop 7
    v_max3_f32 v229, v228, v168, v169
    v_max3_f32 v228, v228, v168, v169
    s_nop 1
    v_permlane16_swap_b32 v228, v229
    v_max_f32 v230, v228, v229
    v_max_f32 v228, v228, v229
    s_nop 1
    v_permlane32_swap_b32 v228, v230
    v_max_f32 v228, v228, v230
    v_mul_f32 v230, s58, v228
    v_pk_fma_f32 v[160:161], v[160:161], s[58:59], v[230:231] op_sel_hi:[1,1,0] neg_lo:[0,0,1] neg_hi:[0,0,1]
    v_pk_fma_f32 v[162:163], v[162:163], s[58:59], v[230:231] op_sel_hi:[1,1,0] neg_lo:[0,0,1] neg_hi:[0,0,1]
    v_pk_fma_f32 v[164:165], v[164:165], s[58:59], v[230:231] op_sel_hi:[1,1,0] neg_lo:[0,0,1] neg_hi:[0,0,1]
    v_pk_fma_f32 v[166:167], v[166:167], s[58:59], v[230:231] op_sel_hi:[1,1,0] neg_lo:[0,0,1] neg_hi:[0,0,1]
    v_pk_fma_f32 v[168:169], v[168:169], s[58:59], v[230:231] op_sel_hi:[1,1,0] neg_lo:[0,0,1] neg_hi:[0,0,1]
    v_exp_f32 v160, v160
    v_exp_f32 v161, v161
    v_exp_f32 v162, v162
    v_exp_f32 v163, v163
    v_exp_f32 v164, v164
    v_exp_f32 v165, v165
    v_exp_f32 v166, v166
    v_exp_f32 v167, v167
    v_exp_f32 v168, v168
    v_exp_f32 v169, v169
    s_nop 0
    v_cvt_pk_bf16_f32 v172, v160, v161
    v_cvt_pk_bf16_f32 v173, v162, v163
    v_cvt_pk_bf16_f32 v174, v164, v165
    v_cvt_pk_bf16_f32 v175, v166, v167
    v_cvt_pk_bf16_f32 v176, v168, v169
    v_pk_add_f32 v[160:161], v[160:161], v[162:163]
    v_pk_add_f32 v[164:165], v[164:165], v[166:167]
    v_pk_add_f32 v[160:161], v[160:161], v[168:169]
    v_pk_add_f32 v[160:161], v[160:161], v[164:165]
    s_waitcnt vmcnt(0)
    v_mov_b32 v154, v153
    v_mov_b32 v155, v152
    v_mov_b32 v158, v157
    v_mov_b32 v159, v156
    v_mfma_f32_16x16x32_bf16 v[180:183], v[120:123], v[172:175], 0
    v_mfma_f32_16x16x32_bf16 v[184:187], v[124:127], v[172:175], 0
    v_mfma_f32_16x16x32_bf16 v[188:191], v[128:131], v[172:175], 0
    v_mfma_f32_16x16x32_bf16 v[192:195], v[132:135], v[172:175], 0
    v_add_f32 v232, v160, v161
    v_add_f32 v233, v160, v161
    v_mfma_f32_16x16x16_bf16 v[180:183], v[152:153], v[176:177], v[180:183]
    v_mfma_f32_16x16x16_bf16 v[184:187], v[154:155], v[176:177], v[184:187]
    v_mfma_f32_16x16x16_bf16 v[188:191], v[156:157], v[176:177], v[188:191]
    v_mfma_f32_16x16x16_bf16 v[192:195], v[158:159], v[176:177], v[192:195]
    v_permlane16_swap_b32 v232, v233
    v_add_f32 v229, v232, v233
    v_add_f32 v233, v232, v233
    s_nop 1
    v_permlane32_swap_b32 v229, v233
    v_add_f32 v232, v229, v233
    v_rcp_f32 v230, v232
    s_nop 1
    v_pk_mul_f32 v[180:181], v[180:181], v[230:231] op_sel_hi:[1,0]
    v_pk_mul_f32 v[182:183], v[182:183], v[230:231] op_sel_hi:[1,0]
    v_pk_mul_f32 v[184:185], v[184:185], v[230:231] op_sel_hi:[1,0]
    v_pk_mul_f32 v[186:187], v[186:187], v[230:231] op_sel_hi:[1,0]
    v_pk_mul_f32 v[188:189], v[188:189], v[230:231] op_sel_hi:[1,0]
    v_pk_mul_f32 v[190:191], v[190:191], v[230:231] op_sel_hi:[1,0]
    v_pk_mul_f32 v[192:193], v[192:193], v[230:231] op_sel_hi:[1,0]
    v_pk_mul_f32 v[194:195], v[194:195], v[230:231] op_sel_hi:[1,0]
    v_cvt_pk_bf16_f32 v64, v180, v184
    v_cvt_pk_bf16_f32 v65, v181, v185
    v_cvt_pk_bf16_f32 v66, v182, v186
    v_cvt_pk_bf16_f32 v67, v183, v187
    ds_write_b128 v11, v[64:67] offset:8192
    v_cvt_pk_bf16_f32 v68, v188, v192
    v_cvt_pk_bf16_f32 v69, v189, v193
    v_cvt_pk_bf16_f32 v70, v190, v194
    v_cvt_pk_bf16_f32 v71, v191, v195
    ds_write_b128 v11, v[68:71] offset:9216
    s_waitcnt lgkmcnt(0)
    s_barrier
    ds_read_b128 v[196:199], v241 offset:8192
    ds_read_b128 v[200:203], v241 offset:9216
    ds_read_b128 v[204:207], v241 offset:10240
    ds_read_b128 v[208:211], v241 offset:11264
    ds_read_b128 v[212:215], v241 offset:12288
    ds_read_b128 v[216:219], v241 offset:13312
    ds_read_b128 v[220:223], v241 offset:14336
    ds_read_b128 v[224:227], v241 offset:15360
    s_cmp_eq_u32 s52, 0
    s_cbranch_scc1 L_ps_47
    s_waitcnt lgkmcnt(4)
    v_mfma_f32_16x16x32_bf16 v[16:19], a[128:131], v[196:199], 0
    v_mfma_f32_16x16x32_bf16 v[16:19], a[132:135], v[200:203], v[16:19]
    v_mfma_f32_16x16x32_bf16 v[16:19], a[136:139], v[204:207], v[16:19]
    v_mfma_f32_16x16x32_bf16 v[16:19], a[140:143], v[208:211], v[16:19]
    v_mfma_f32_16x16x32_bf16 v[20:23], a[144:147], v[196:199], 0
    v_mfma_f32_16x16x32_bf16 v[20:23], a[148:151], v[200:203], v[20:23]
    v_mfma_f32_16x16x32_bf16 v[20:23], a[152:155], v[204:207], v[20:23]
    v_mfma_f32_16x16x32_bf16 v[20:23], a[156:159], v[208:211], v[20:23]
    v_mfma_f32_16x16x32_bf16 v[24:27], a[160:163], v[196:199], 0
    s_nop 0
    s_nop 0
    v_mfma_f32_16x16x32_bf16 v[24:27], a[164:167], v[200:203], v[24:27]
    s_nop 0
    s_nop 0
    v_mfma_f32_16x16x32_bf16 v[24:27], a[168:171], v[204:207], v[24:27]
    s_nop 0
    s_nop 0
    v_mfma_f32_16x16x32_bf16 v[24:27], a[172:175], v[208:211], v[24:27]
    v_cvt_pk_bf16_f32 v172, v16, v20
    v_cvt_pk_bf16_f32 v173, v17, v21
    v_mfma_f32_16x16x32_bf16 v[28:31], a[176:179], v[196:199], 0
    v_cvt_pk_bf16_f32 v174, v18, v22
    v_cvt_pk_bf16_f32 v175, v19, v23
    v_mfma_f32_16x16x32_bf16 v[28:31], a[180:183], v[200:203], v[28:31]
    v_bfi_b32 v172, 1, s47, v172
    s_add_u32 s32, s44, 0
    v_mfma_f32_16x16x32_bf16 v[28:31], a[184:187], v[204:207], v[28:31]
    buffer_store_dwordx4 v[172:175], v6, s[4:7], s32 offen
    v_mfma_f32_16x16x32_bf16 v[28:31], a[188:191], v[208:211], v[28:31]
    v_mfma_f32_16x16x32_bf16 v[32:35], a[192:195], v[196:199], 0
    s_nop 0
    s_nop 0
    v_mfma_f32_16x16x32_bf16 v[32:35], a[196:199], v[200:203], v[32:35]
    s_nop 0
    s_nop 0
    v_mfma_f32_16x16x32_bf16 v[32:35], a[200:203], v[204:207], v[32:35]
    s_nop 0
    s_nop 0
    v_mfma_f32_16x16x32_bf16 v[32:35], a[204:207], v[208:211], v[32:35]
    v_cvt_pk_bf16_f32 v160, v24, v28
    v_cvt_pk_bf16_f32 v161, v25, v29
    v_mfma_f32_16x16x32_bf16 v[36:39], a[208:211], v[196:199], 0
    v_cvt_pk_bf16_f32 v162, v26, v30
    v_cvt_pk_bf16_f32 v163, v27, v31
    v_mfma_f32_16x16x32_bf16 v[36:39], a[212:215], v[200:203], v[36:39]
    v_bfi_b32 v160, 1, s47, v160
    s_add_u32 s32, s44, 8192
    v_mfma_f32_16x16x32_bf16 v[36:39], a[216:219], v[204:207], v[36:39]
    buffer_store_dwordx4 v[160:163], v6, s[4:7], s32 offen
    v_mfma_f32_16x16x32_bf16 v[36:39], a[220:223], v[208:211], v[36:39]
    v_mfma_f32_16x16x32_bf16 v[40:43], a[224:227], v[196:199], 0
    s_nop 0
    s_nop 0
    v_mfma_f32_16x16x32_bf16 v[40:43], a[228:231], v[200:203], v[40:43]
    s_nop 0
    s_nop 0
    v_mfma_f32_16x16x32_bf16 v[40:43], a[232:235], v[204:207], v[40:43]
    s_nop 0
    s_nop 0
    v_mfma_f32_16x16x32_bf16 v[40:43], a[236:239], v[208:211], v[40:43]
    v_cvt_pk_bf16_f32 v172, v32, v36
    v_cvt_pk_bf16_f32 v173, v33, v37
    v_mfma_f32_16x16x32_bf16 v[44:47], a[240:243], v[196:199], 0
    v_cvt_pk_bf16_f32 v174, v34, v38
    v_cvt_pk_bf16_f32 v175, v35, v39
    v_mfma_f32_16x16x32_bf16 v[44:47], a[244:247], v[200:203], v[44:47]
    v_bfi_b32 v172, 1, s47, v172
    s_add_u32 s32, s44, 16384
    v_mfma_f32_16x16x32_bf16 v[44:47], a[248:251], v[204:207], v[44:47]
    buffer_store_dwordx4 v[172:175], v6, s[4:7], s32 offen
    v_mfma_f32_16x16x32_bf16 v[44:47], a[252:255], v[208:211], v[44:47]
    s_waitcnt lgkmcnt(0)
    v_mfma_f32_16x16x32_bf16 v[48:51], a[128:131], v[212:215], 0
    s_nop 0
    s_nop 0
    v_mfma_f32_16x16x32_bf16 v[48:51], a[132:135], v[216:219], v[48:51]
    s_nop 0
    s_nop 0
    v_mfma_f32_16x16x32_bf16 v[48:51], a[136:139], v[220:223], v[48:51]
    s_nop 0
    s_nop 0
    v_mfma_f32_16x16x32_bf16 v[48:51], a[140:143], v[224:227], v[48:51]
    v_cvt_pk_bf16_f32 v160, v40, v44
    v_cvt_pk_bf16_f32 v161, v41, v45
    v_mfma_f32_16x16x32_bf16 v[52:55], a[144:147], v[212:215], 0
    v_cvt_pk_bf16_f32 v162, v42, v46
    v_cvt_pk_bf16_f32 v163, v43, v47
    v_mfma_f32_16x16x32_bf16 v[52:55], a[148:151], v[216:219], v[52:55]
    v_bfi_b32 v160, 1, s47, v160
    s_add_u32 s32, s44, 24576
    v_mfma_f32_16x16x32_bf16 v[52:55], a[152:155], v[220:223], v[52:55]
    buffer_store_dwordx4 v[160:163], v6, s[4:7], s32 offen
    v_mfma_f32_16x16x32_bf16 v[52:55], a[156:159], v[224:227], v[52:55]
    v_mfma_f32_16x16x32_bf16 v[56:59], a[160:163], v[212:215], 0
    s_nop 0
    s_nop 0
    v_mfma_f32_16x16x32_bf16 v[56:59], a[164:167], v[216:219], v[56:59]
    s_nop 0
    s_nop 0
    v_mfma_f32_16x16x32_bf16 v[56:59], a[168:171], v[220:223], v[56:59]
    s_nop 0
    s_nop 0
    v_mfma_f32_16x16x32_bf16 v[56:59], a[172:175], v[224:227], v[56:59]
    v_cvt_pk_bf16_f32 v172, v48, v52
    v_cvt_pk_bf16_f32 v173, v49, v53
    v_mfma_f32_16x16x32_bf16 v[60:63], a[176:179], v[212:215], 0
    v_cvt_pk_bf16_f32 v174, v50, v54
    v_cvt_pk_bf16_f32 v175, v51, v55
    v_mfma_f32_16x16x32_bf16 v[60:63], a[180:183], v[216:219], v[60:63]
    v_bfi_b32 v172, 1, s47, v172
    s_add_u32 s32, s44, 32768
    v_mfma_f32_16x16x32_bf16 v[60:63], a[184:187], v[220:223], v[60:63]
    buffer_store_dwordx4 v[172:175], v6, s[4:7], s32 offen
    v_mfma_f32_16x16x32_bf16 v[60:63], a[188:191], v[224:227], v[60:63]
    v_mfma_f32_16x16x32_bf16 v[64:67], a[192:195], v[212:215], 0
    s_nop 0
    s_nop 0
    v_mfma_f32_16x16x32_bf16 v[64:67], a[196:199], v[216:219], v[64:67]
    s_nop 0
    s_nop 0
    v_mfma_f32_16x16x32_bf16 v[64:67], a[200:203], v[220:223], v[64:67]
    s_nop 0
    s_nop 0
    v_mfma_f32_16x16x32_bf16 v[64:67], a[204:207], v[224:227], v[64:67]
    v_cvt_pk_bf16_f32 v160, v56, v60
    v_cvt_pk_bf16_f32 v161, v57, v61
    v_mfma_f32_16x16x32_bf16 v[68:71], a[208:211], v[212:215], 0
    v_cvt_pk_bf16_f32 v162, v58, v62
    v_cvt_pk_bf16_f32 v163, v59, v63
    v_mfma_f32_16x16x32_bf16 v[68:71], a[212:215], v[216:219], v[68:71]
    v_bfi_b32 v160, 1, s47, v160
    s_add_u32 s32, s44, 40960
    v_mfma_f32_16x16x32_bf16 v[68:71], a[216:219], v[220:223], v[68:71]
    buffer_store_dwordx4 v[160:163], v6, s[4:7], s32 offen
    v_mfma_f32_16x16x32_bf16 v[68:71], a[220:223], v[224:227], v[68:71]
    v_mfma_f32_16x16x32_bf16 v[72:75], a[224:227], v[212:215], 0
    s_nop 0
    s_nop 0
    v_mfma_f32_16x16x32_bf16 v[72:75], a[228:231], v[216:219], v[72:75]
    s_nop 0
    s_nop 0
    v_mfma_f32_16x16x32_bf16 v[72:75], a[232:235], v[220:223], v[72:75]
    s_nop 0
    s_nop 0
    v_mfma_f32_16x16x32_bf16 v[72:75], a[236:239], v[224:227], v[72:75]
    v_cvt_pk_bf16_f32 v172, v64, v68
    v_cvt_pk_bf16_f32 v173, v65, v69
    v_mfma_f32_16x16x32_bf16 v[76:79], a[240:243], v[212:215], 0
    v_cvt_pk_bf16_f32 v174, v66, v70
    v_cvt_pk_bf16_f32 v175, v67, v71
    v_mfma_f32_16x16x32_bf16 v[76:79], a[244:247], v[216:219], v[76:79]
    v_bfi_b32 v172, 1, s47, v172
    s_add_u32 s32, s44, 49152
    v_mfma_f32_16x16x32_bf16 v[76:79], a[248:251], v[220:223], v[76:79]
    buffer_store_dwordx4 v[172:175], v6, s[4:7], s32 offen
    v_mfma_f32_16x16x32_bf16 v[76:79], a[252:255], v[224:227], v[76:79]
    s_nop 7
    v_cvt_pk_bf16_f32 v160, v72, v76
    v_cvt_pk_bf16_f32 v161, v73, v77
    v_cvt_pk_bf16_f32 v162, v74, v78
    v_cvt_pk_bf16_f32 v163, v75, v79
    v_bfi_b32 v160, 1, s47, v160
    s_add_u32 s32, s44, 57344
    buffer_store_dwordx4 v[160:163], v6, s[4:7], s32 offen
    s_branch L_pj_48
L_ps_47:
    s_waitcnt lgkmcnt(4)
    v_mfma_f32_16x16x32_bf16 v[16:19], a[128:131], v[196:199], 0
    v_mfma_f32_16x16x32_bf16 v[16:19], a[132:135], v[200:203], v[16:19]
    v_mfma_f32_16x16x32_bf16 v[16:19], a[136:139], v[204:207], v[16:19]
    v_mfma_f32_16x16x32_bf16 v[16:19], a[140:143], v[208:211], v[16:19]
    v_mfma_f32_16x16x32_bf16 v[20:23], a[144:147], v[196:199], 0
    v_mfma_f32_16x16x32_bf16 v[20:23], a[148:151], v[200:203], v[20:23]
    v_mfma_f32_16x16x32_bf16 v[20:23], a[152:155], v[204:207], v[20:23]
    v_mfma_f32_16x16x32_bf16 v[20:23], a[156:159], v[208:211], v[20:23]
    v_mfma_f32_16x16x32_bf16 v[24:27], a[160:163], v[196:199], 0
    s_nop 0
    s_nop 0
    v_mfma_f32_16x16x32_bf16 v[24:27], a[164:167], v[200:203], v[24:27]
    s_nop 0
    s_nop 0
    v_mfma_f32_16x16x32_bf16 v[24:27], a[168:171], v[204:207], v[24:27]
    s_nop 0
    s_nop 0
    v_mfma_f32_16x16x32_bf16 v[24:27], a[172:175], v[208:211], v[24:27]
    v_cvt_pk_bf16_f32 v172, v16, v20
    v_cvt_pk_bf16_f32 v173, v17, v21
    v_mfma_f32_16x16x32_bf16 v[28:31], a[176:179], v[196:199], 0
    v_cvt_pk_bf16_f32 v174, v18, v22
    v_cvt_pk_bf16_f32 v175, v19, v23
    v_mfma_f32_16x16x32_bf16 v[28:31], a[180:183], v[200:203], v[28:31]
    v_bfi_b32 v172, 1, s47, v172
    s_add_u32 s32, s44, 0
    v_mfma_f32_16x16x32_bf16 v[28:31], a[184:187], v[204:207], v[28:31]
    buffer_store_dwordx4 v[172:175], v6, s[4:7], s32 offen sc1
    v_mfma_f32_16x16x32_bf16 v[28:31], a[188:191], v[208:211], v[28:31]
    v_mfma_f32_16x16x32_bf16 v[32:35], a[192:195], v[196:199], 0
    s_nop 0
    s_nop 0
    v_mfma_f32_16x16x32_bf16 v[32:35], a[196:199], v[200:203], v[32:35]
    s_nop 0
    s_nop 0
    v_mfma_f32_16x16x32_bf16 v[32:35], a[200:203], v[204:207], v[32:35]
    s_nop 0
    s_nop 0
    v_mfma_f32_16x16x32_bf16 v[32:35], a[204:207], v[208:211], v[32:35]
    v_cvt_pk_bf16_f32 v160, v24, v28
    v_cvt_pk_bf16_f32 v161, v25, v29
    v_mfma_f32_16x16x32_bf16 v[36:39], a[208:211], v[196:199], 0
    v_cvt_pk_bf16_f32 v162, v26, v30
    v_cvt_pk_bf16_f32 v163, v27, v31
    v_mfma_f32_16x16x32_bf16 v[36:39], a[212:215], v[200:203], v[36:39]
    v_bfi_b32 v160, 1, s47, v160
    s_add_u32 s32, s44, 8192
    v_mfma_f32_16x16x32_bf16 v[36:39], a[216:219], v[204:207], v[36:39]
    buffer_store_dwordx4 v[160:163], v6, s[4:7], s32 offen sc1
    v_mfma_f32_16x16x32_bf16 v[36:39], a[220:223], v[208:211], v[36:39]
    v_mfma_f32_16x16x32_bf16 v[40:43], a[224:227], v[196:199], 0
    s_nop 0
    s_nop 0
    v_mfma_f32_16x16x32_bf16 v[40:43], a[228:231], v[200:203], v[40:43]
    s_nop 0
    s_nop 0
    v_mfma_f32_16x16x32_bf16 v[40:43], a[232:235], v[204:207], v[40:43]
    s_nop 0
    s_nop 0
    v_mfma_f32_16x16x32_bf16 v[40:43], a[236:239], v[208:211], v[40:43]
    v_cvt_pk_bf16_f32 v172, v32, v36
    v_cvt_pk_bf16_f32 v173, v33, v37
    v_mfma_f32_16x16x32_bf16 v[44:47], a[240:243], v[196:199], 0
    v_cvt_pk_bf16_f32 v174, v34, v38
    v_cvt_pk_bf16_f32 v175, v35, v39
    v_mfma_f32_16x16x32_bf16 v[44:47], a[244:247], v[200:203], v[44:47]
    v_bfi_b32 v172, 1, s47, v172
    s_add_u32 s32, s44, 16384
    v_mfma_f32_16x16x32_bf16 v[44:47], a[248:251], v[204:207], v[44:47]
    buffer_store_dwordx4 v[172:175], v6, s[4:7], s32 offen sc1
    v_mfma_f32_16x16x32_bf16 v[44:47], a[252:255], v[208:211], v[44:47]
    s_waitcnt lgkmcnt(0)
    v_mfma_f32_16x16x32_bf16 v[48:51], a[128:131], v[212:215], 0
    s_nop 0
    s_nop 0
    v_mfma_f32_16x16x32_bf16 v[48:51], a[132:135], v[216:219], v[48:51]
    s_nop 0
    s_nop 0
    v_mfma_f32_16x16x32_bf16 v[48:51], a[136:139], v[220:223], v[48:51]
    s_nop 0
    s_nop 0
    v_mfma_f32_16x16x32_bf16 v[48:51], a[140:143], v[224:227], v[48:51]
    v_cvt_pk_bf16_f32 v160, v40, v44
    v_cvt_pk_bf16_f32 v161, v41, v45
    v_mfma_f32_16x16x32_bf16 v[52:55], a[144:147], v[212:215], 0
    v_cvt_pk_bf16_f32 v162, v42, v46
    v_cvt_pk_bf16_f32 v163, v43, v47
    v_mfma_f32_16x16x32_bf16 v[52:55], a[148:151], v[216:219], v[52:55]
    v_bfi_b32 v160, 1, s47, v160
    s_add_u32 s32, s44, 24576
    v_mfma_f32_16x16x32_bf16 v[52:55], a[152:155], v[220:223], v[52:55]
    buffer_store_dwordx4 v[160:163], v6, s[4:7], s32 offen sc1
    v_mfma_f32_16x16x32_bf16 v[52:55], a[156:159], v[224:227], v[52:55]
    v_mfma_f32_16x16x32_bf16 v[56:59], a[160:163], v[212:215], 0
    s_nop 0
    s_nop 0
    v_mfma_f32_16x16x32_bf16 v[56:59], a[164:167], v[216:219], v[56:59]
    s_nop 0
    s_nop 0
    v_mfma_f32_16x16x32_bf16 v[56:59], a[168:171], v[220:223], v[56:59]
    s_nop 0
    s_nop 0
    v_mfma_f32_16x16x32_bf16 v[56:59], a[172:175], v[224:227], v[56:59]
    v_cvt_pk_bf16_f32 v172, v48, v52
    v_cvt_pk_bf16_f32 v173, v49, v53
    v_mfma_f32_16x16x32_bf16 v[60:63], a[176:179], v[212:215], 0
    v_cvt_pk_bf16_f32 v174, v50, v54
    v_cvt_pk_bf16_f32 v175, v51, v55
    v_mfma_f32_16x16x32_bf16 v[60:63], a[180:183], v[216:219], v[60:63]
    v_bfi_b32 v172, 1, s47, v172
    s_add_u32 s32, s44, 32768
    v_mfma_f32_16x16x32_bf16 v[60:63], a[184:187], v[220:223], v[60:63]
    buffer_store_dwordx4 v[172:175], v6, s[4:7], s32 offen sc1
    v_mfma_f32_16x16x32_bf16 v[60:63], a[188:191], v[224:227], v[60:63]
    v_mfma_f32_16x16x32_bf16 v[64:67], a[192:195], v[212:215], 0
    s_nop 0
    s_nop 0
    v_mfma_f32_16x16x32_bf16 v[64:67], a[196:199], v[216:219], v[64:67]
    s_nop 0
    s_nop 0
    v_mfma_f32_16x16x32_bf16 v[64:67], a[200:203], v[220:223], v[64:67]
    s_nop 0
    s_nop 0
    v_mfma_f32_16x16x32_bf16 v[64:67], a[204:207], v[224:227], v[64:67]
    v_cvt_pk_bf16_f32 v160, v56, v60
    v_cvt_pk_bf16_f32 v161, v57, v61
    v_mfma_f32_16x16x32_bf16 v[68:71], a[208:211], v[212:215], 0
    v_cvt_pk_bf16_f32 v162, v58, v62
    v_cvt_pk_bf16_f32 v163, v59, v63
    v_mfma_f32_16x16x32_bf16 v[68:71], a[212:215], v[216:219], v[68:71]
    v_bfi_b32 v160, 1, s47, v160
    s_add_u32 s32, s44, 40960
    v_mfma_f32_16x16x32_bf16 v[68:71], a[216:219], v[220:223], v[68:71]
    buffer_store_dwordx4 v[160:163], v6, s[4:7], s32 offen sc1
    v_mfma_f32_16x16x32_bf16 v[68:71], a[220:223], v[224:227], v[68:71]
    v_mfma_f32_16x16x32_bf16 v[72:75], a[224:227], v[212:215], 0
    s_nop 0
    s_nop 0
    v_mfma_f32_16x16x32_bf16 v[72:75], a[228:231], v[216:219], v[72:75]
    s_nop 0
    s_nop 0
    v_mfma_f32_16x16x32_bf16 v[72:75], a[232:235], v[220:223], v[72:75]
    s_nop 0
    s_nop 0
    v_mfma_f32_16x16x32_bf16 v[72:75], a[236:239], v[224:227], v[72:75]
    v_cvt_pk_bf16_f32 v172, v64, v68
    v_cvt_pk_bf16_f32 v173, v65, v69
    v_mfma_f32_16x16x32_bf16 v[76:79], a[240:243], v[212:215], 0
    v_cvt_pk_bf16_f32 v174, v66, v70
    v_cvt_pk_bf16_f32 v175, v67, v71
    v_mfma_f32_16x16x32_bf16 v[76:79], a[244:247], v[216:219], v[76:79]
    v_bfi_b32 v172, 1, s47, v172
    s_add_u32 s32, s44, 49152
    v_mfma_f32_16x16x32_bf16 v[76:79], a[248:251], v[220:223], v[76:79]
    buffer_store_dwordx4 v[172:175], v6, s[4:7], s32 offen sc1
    v_mfma_f32_16x16x32_bf16 v[76:79], a[252:255], v[224:227], v[76:79]
    s_nop 7
    v_cvt_pk_bf16_f32 v160, v72, v76
    v_cvt_pk_bf16_f32 v161, v73, v77
    v_cvt_pk_bf16_f32 v162, v74, v78
    v_cvt_pk_bf16_f32 v163, v75, v79
    v_bfi_b32 v160, 1, s47, v160
    s_add_u32 s32, s44, 57344
    buffer_store_dwordx4 v[160:163], v6, s[4:7], s32 offen sc1
L_pj_48:
    s_add_u32 s33, s45, 4096
    s_mov_b32 s53, 262144
L_w2red_49:
    buffer_load_dwordx4 v[88:91], v4, s[4:7], s45 offen offset:0 sc1
    buffer_load_dwordx4 v[92:95], v4, s[4:7], s45 offen offset:1024 sc1
    buffer_load_dwordx4 v[96:99], v4, s[4:7], s45 offen offset:2048 sc1
    buffer_load_dwordx4 v[100:103], v4, s[4:7], s45 offen offset:3072 sc1
    buffer_load_dwordx4 v[104:107], v4, s[4:7], s33 offen offset:0 sc1
    buffer_load_dwordx4 v[108:111], v4, s[4:7], s33 offen offset:1024 sc1
    buffer_load_dwordx4 v[112:115], v4, s[4:7], s33 offen offset:2048 sc1
    buffer_load_dwordx4 v[116:119], v4, s[4:7], s33 offen offset:3072 sc1
    s_mov_b64 exec, -1
    s_sub_u32 s53, s53, 1
    s_cbranch_scc1 L_fail
    s_waitcnt vmcnt(0)
    v_bitop3_b32 v228, v88, v92, s47 bitop3:0x7e
    v_bitop3_b32 v229, v96, v100, s47 bitop3:0x7e
    v_bitop3_b32 v230, v104, v108, s47 bitop3:0x7e
    v_bitop3_b32 v231, v112, v116, s47 bitop3:0x7e
    v_or3_b32 v228, v228, v229, v230
    v_or_b32 v228, v228, v231
    v_and_b32 v228, 1, v228
    v_cmp_ne_u32 vcc, 0, v228
    s_cbranch_vccz L_w2rok_50
    s_mov_b64 exec, vcc
    s_branch L_w2red_49
L_w2rok_50:
    v_mfma_f32_16x16x32_bf16 v[180:183], v[12:15], v[88:91], 0
    v_mfma_f32_16x16x32_bf16 v[180:183], v[12:15], v[92:95], v[180:183]
    v_mfma_f32_16x16x32_bf16 v[180:183], v[12:15], v[96:99], v[180:183]
    v_mfma_f32_16x16x32_bf16 v[180:183], v[12:15], v[100:103], v[180:183]
    v_mfma_f32_16x16x32_bf16 v[180:183], v[12:15], v[104:107], v[180:183]
    v_mfma_f32_16x16x32_bf16 v[180:183], v[12:15], v[108:111], v[180:183]
    v_mfma_f32_16x16x32_bf16 v[180:183], v[12:15], v[112:115], v[180:183]
    v_mfma_f32_16x16x32_bf16 v[180:183], v[12:15], v[116:119], v[180:183]
    s_xor_b32 s44, s44, 0x100000
    s_xor_b32 s45, s45, 0x100000
    s_add_u32 s39, s39, 1
    s_lshr_b32 s47, s39, 1
    s_and_b32 s47, s47, 1
    s_add_u32 s38, s38, 4
    s_add_u32 s42, s42, 32768
    s_add_u32 s43, s43, 32768
    s_mov_b32 exec_hi, 0
    buffer_store_dwordx2 v[180:181], v7, s[20:23], s46 offen
    buffer_store_dwordx2 v[182:183], v7, s[20:23], s46 offen offset:32
    s_mov_b64 exec, -1
    s_add_u32 s46, s46, 524288
    s_cmp_lt_u32 s38, 64
    s_cbranch_scc1 L_w2top_42
    s_endpgm
L_parta:
    s_mov_b32 s8, s70
    s_and_b32 s9, s71, 0xffff
    s_mov_b32 s10, 0x80000
    s_mov_b32 s11, 0x20000
    s_mov_b32 s12, s72
    s_and_b32 s13, s73, 0xffff
    s_mov_b32 s14, 0x80000
    s_mov_b32 s15, 0x20000
    s_mov_b32 s20, s74
    s_and_b32 s21, s75, 0xffff
    s_mov_b32 s22, 0x80000
    s_mov_b32 s23, 0x20000
    s_mov_b32 s24, s76
    s_and_b32 s25, s77, 0xffff
    s_mov_b32 s26, 0x80000
    s_mov_b32 s27, 0x20000
    s_mov_b32 s46, 0x05040100
    s_mov_b32 s47, 0x07060302
    v_and_b32 v240, 63, v0
    v_and_b32 v241, 15, v240
    v_lshrrev_b32 v242, 4, v240
    s_lshl_b32 s42, s29, 2
    s_add_u32 s42, s42, 0x7000
    v_mov_b32 v104, 0
    buffer_store_dword v104, off, s[4:7], s42 sc1
    v_lshlrev_b32 v243, 10, v241
    v_lshl_add_u32 v243, v242, 4, v243
    s_lshl_b32 s32, s29, 14
    v_add_u32 v245, s32, v243
    buffer_load_dwordx4 a[0:3], v245, s[8:11], 0 offen offset:0
    buffer_load_dwordx4 a[4:7], v245, s[12:15], 0 offen offset:0
    buffer_load_dwordx4 a[8:11], v245, s[8:11], 0 offen offset:64
    buffer_load_dwordx4 a[12:15], v245, s[12:15], 0 offen offset:64
    buffer_load_dwordx4 a[16:19], v245, s[8:11], 0 offen offset:128
    buffer_load_dwordx4 a[20:23], v245, s[12:15], 0 offen offset:128
    buffer_load_dwordx4 a[24:27], v245, s[8:11], 0 offen offset:192
    buffer_load_dwordx4 a[28:31], v245, s[12:15], 0 offen offset:192
    buffer_load_dwordx4 a[32:35], v245, s[8:11], 0 offen offset:256
    buffer_load_dwordx4 a[36:39], v245, s[12:15], 0 offen offset:256
    buffer_load_dwordx4 a[40:43], v245, s[8:11], 0 offen offset:320
    buffer_load_dwordx4 a[44:47], v245, s[12:15], 0 offen offset:320
    buffer_load_dwordx4 a[48:51], v245, s[8:11], 0 offen offset:384
    buffer_load_dwordx4 a[52:55], v245, s[12:15], 0 offen offset:384
    buffer_load_dwordx4 a[56:59], v245, s[8:11], 0 offen offset:448
    buffer_load_dwordx4 a[60:63], v245, s[12:15], 0 offen offset:448
    buffer_load_dwordx4 a[64:67], v245, s[8:11], 0 offen offset:512
    buffer_load_dwordx4 a[68:71], v245, s[12:15], 0 offen offset:512
    buffer_load_dwordx4 a[72:75], v245, s[8:11], 0 offen offset:576
    buffer_load_dwordx4 a[76:79], v245, s[12:15], 0 offen offset:576
    buffer_load_dwordx4 a[80:83], v245, s[8:11], 0 offen offset:640
    buffer_load_dwordx4 a[84:87], v245, s[12:15], 0 offen offset:640
    buffer_load_dwordx4 a[88:91], v245, s[8:11], 0 offen offset:704
    buffer_load_dwordx4 a[92:95], v245, s[12:15], 0 offen offset:704
    buffer_load_dwordx4 a[96:99], v245, s[8:11], 0 offen offset:768
    buffer_load_dwordx4 a[100:103], v245, s[12:15], 0 offen offset:768
    buffer_load_dwordx4 a[104:107], v245, s[8:11], 0 offen offset:832
    buffer_load_dwordx4 a[108:111], v245, s[12:15], 0 offen offset:832
    buffer_load_dwordx4 a[112:115], v245, s[8:11], 0 offen offset:896
    buffer_load_dwordx4 a[116:119], v245, s[12:15], 0 offen offset:896
    buffer_load_dwordx4 a[120:123], v245, s[8:11], 0 offen offset:960
    buffer_load_dwordx4 a[124:127], v245, s[12:15], 0 offen offset:960
    s_waitcnt vmcnt(32)
    s_barrier
    s_cmp_lg_u32 s28, 0
    s_cbranch_scc1 L_arr_51
    s_mul_i32 s32, s31, 6
    s_lshl_b64 s[34:35], 1, s32
    s_or_b32 s35, s35, 0x01000000
    s_lshl_b32 s32, s30, 3
    v_mov_b32 v104, s34
    v_mov_b32 v105, s35
    v_mov_b32 v106, s32
    s_mov_b64 s[36:37], exec
    s_mov_b64 exec, 1
    buffer_atomic_add_x2 v[104:105], v106, s[16:19], 0 offen offset:128
    s_mov_b64 exec, s[36:37]
L_arr_51:
    s_lshl_b32 s32, s29, 5
    v_lshl_add_u32 v243, v241, 1, s32
    global_load_ushort v104, v243, s[66:67]
    global_load_ushort v105, v243, s[68:69]
    global_load_ushort v106, v243, s[78:79]
    s_lshr_b32 s32, s29, 2
    s_lshl_b32 s32, s32, 7
    s_lshl_b32 s33, s28, 5
    s_add_u32 s52, s32, s33
    v_lshl_add_u32 v244, v242, 3, s52
    global_load_dwordx2 v[120:121], v244, s[80:81]
    v_lshlrev_b32 v243, 10, v241
    v_lshl_add_u32 v243, v242, 3, v243
    s_lshl_b32 s32, s52, 9
    v_add_u32 v246, s32, v243
    buffer_load_dwordx2 v[128:129], v246, s[20:23], 0 offen offset:0
    buffer_load_dwordx2 v[130:131], v246, s[24:27], 0 offen offset:0
    buffer_load_dwordx2 v[132:133], v246, s[20:23], 0 offen offset:32
    buffer_load_dwordx2 v[134:135], v246, s[24:27], 0 offen offset:32
    buffer_load_dwordx2 v[136:137], v246, s[20:23], 0 offen offset:64
    buffer_load_dwordx2 v[138:139], v246, s[24:27], 0 offen offset:64
    buffer_load_dwordx2 v[140:141], v246, s[20:23], 0 offen offset:96
    buffer_load_dwordx2 v[142:143], v246, s[24:27], 0 offen offset:96
    buffer_load_dwordx2 v[144:145], v246, s[20:23], 0 offen offset:128
    buffer_load_dwordx2 v[146:147], v246, s[24:27], 0 offen offset:128
    buffer_load_dwordx2 v[148:149], v246, s[20:23], 0 offen offset:160
    buffer_load_dwordx2 v[150:151], v246, s[24:27], 0 offen offset:160
    buffer_load_dwordx2 v[152:153], v246, s[20:23], 0 offen offset:192
    buffer_load_dwordx2 v[154:155], v246, s[24:27], 0 offen offset:192
    buffer_load_dwordx2 v[156:157], v246, s[20:23], 0 offen offset:224
    buffer_load_dwordx2 v[158:159], v246, s[24:27], 0 offen offset:224
    buffer_load_dwordx2 v[160:161], v246, s[20:23], 0 offen offset:256
    buffer_load_dwordx2 v[162:163], v246, s[24:27], 0 offen offset:256
    buffer_load_dwordx2 v[164:165], v246, s[20:23], 0 offen offset:288
    buffer_load_dwordx2 v[166:167], v246, s[24:27], 0 offen offset:288
    buffer_load_dwordx2 v[168:169], v246, s[20:23], 0 offen offset:320
    buffer_load_dwordx2 v[170:171], v246, s[24:27], 0 offen offset:320
    buffer_load_dwordx2 v[172:173], v246, s[20:23], 0 offen offset:352
    buffer_load_dwordx2 v[174:175], v246, s[24:27], 0 offen offset:352
    buffer_load_dwordx2 v[176:177], v246, s[20:23], 0 offen offset:384
    buffer_load_dwordx2 v[178:179], v246, s[24:27], 0 offen offset:384
    buffer_load_dwordx2 v[180:181], v246, s[20:23], 0 offen offset:416
    buffer_load_dwordx2 v[182:183], v246, s[24:27], 0 offen offset:416
    buffer_load_dwordx2 v[184:185], v246, s[20:23], 0 offen offset:448
    buffer_load_dwordx2 v[186:187], v246, s[24:27], 0 offen offset:448
    buffer_load_dwordx2 v[188:189], v246, s[20:23], 0 offen offset:480
    buffer_load_dwordx2 v[190:191], v246, s[24:27], 0 offen offset:480
    buffer_load_dwordx2 v[192:193], v246, s[20:23], 0 offen offset:512
    buffer_load_dwordx2 v[194:195], v246, s[24:27], 0 offen offset:512
    buffer_load_dwordx2 v[196:197], v246, s[20:23], 0 offen offset:544
    buffer_load_dwordx2 v[198:199], v246, s[24:27], 0 offen offset:544
    buffer_load_dwordx2 v[200:201], v246, s[20:23], 0 offen offset:576
    buffer_load_dwordx2 v[202:203], v246, s[24:27], 0 offen offset:576
    buffer_load_dwordx2 v[204:205], v246, s[20:23], 0 offen offset:608
    buffer_load_dwordx2 v[206:207], v246, s[24:27], 0 offen offset:608
    buffer_load_dwordx2 v[208:209], v246, s[20:23], 0 offen offset:640
    buffer_load_dwordx2 v[210:211], v246, s[24:27], 0 offen offset:640
    buffer_load_dwordx2 v[212:213], v246, s[20:23], 0 offen offset:672
    buffer_load_dwordx2 v[214:215], v246, s[24:27], 0 offen offset:672
    buffer_load_dwordx2 v[216:217], v246, s[20:23], 0 offen offset:704
    buffer_load_dwordx2 v[218:219], v246, s[24:27], 0 offen offset:704
    buffer_load_dwordx2 v[220:221], v246, s[20:23], 0 offen offset:736
    buffer_load_dwordx2 v[222:223], v246, s[24:27], 0 offen offset:736
    s_waitcnt vmcnt(40)
    v_perm_b32 v108, v130, v128, s46
    v_perm_b32 v109, v130, v128, s47
    v_perm_b32 v110, v131, v129, s46
    v_perm_b32 v111, v131, v129, s47
    v_accvgpr_write_b32 a128, v108
    v_accvgpr_write_b32 a129, v109
    v_accvgpr_write_b32 a130, v110
    v_accvgpr_write_b32 a131, v111
    v_perm_b32 v108, v134, v132, s46
    v_perm_b32 v109, v134, v132, s47
    v_perm_b32 v110, v135, v133, s46
    v_perm_b32 v111, v135, v133, s47
    v_accvgpr_write_b32 a132, v108
    v_accvgpr_write_b32 a133, v109
    v_accvgpr_write_b32 a134, v110
    v_accvgpr_write_b32 a135, v111
    v_perm_b32 v108, v138, v136, s46
    v_perm_b32 v109, v138, v136, s47
    v_perm_b32 v110, v139, v137, s46
    v_perm_b32 v111, v139, v137, s47
    v_accvgpr_write_b32 a136, v108
    v_accvgpr_write_b32 a137, v109
    v_accvgpr_write_b32 a138, v110
    v_accvgpr_write_b32 a139, v111
    v_perm_b32 v108, v142, v140, s46
    v_perm_b32 v109, v142, v140, s47
    v_perm_b32 v110, v143, v141, s46
    v_perm_b32 v111, v143, v141, s47
    v_accvgpr_write_b32 a140, v108
    v_accvgpr_write_b32 a141, v109
    v_accvgpr_write_b32 a142, v110
    v_accvgpr_write_b32 a143, v111
    buffer_load_dwordx2 v[128:129], v246, s[20:23], 0 offen offset:768
    buffer_load_dwordx2 v[130:131], v246, s[24:27], 0 offen offset:768
    buffer_load_dwordx2 v[132:133], v246, s[20:23], 0 offen offset:800
    buffer_load_dwordx2 v[134:135], v246, s[24:27], 0 offen offset:800
    buffer_load_dwordx2 v[136:137], v246, s[20:23], 0 offen offset:832
    buffer_load_dwordx2 v[138:139], v246, s[24:27], 0 offen offset:832
    buffer_load_dwordx2 v[140:141], v246, s[20:23], 0 offen offset:864
    buffer_load_dwordx2 v[142:143], v246, s[24:27], 0 offen offset:864
    s_waitcnt vmcnt(40)
    v_perm_b32 v108, v146, v144, s46
    v_perm_b32 v109, v146, v144, s47
    v_perm_b32 v110, v147, v145, s46
    v_perm_b32 v111, v147, v145, s47
    v_accvgpr_write_b32 a144, v108
    v_accvgpr_write_b32 a145, v109
    v_accvgpr_write_b32 a146, v110
    v_accvgpr_write_b32 a147, v111
    v_perm_b32 v108, v150, v148, s46
    v_perm_b32 v109, v150, v148, s47
    v_perm_b32 v110, v151, v149, s46
    v_perm_b32 v111, v151, v149, s47
    v_accvgpr_write_b32 a148, v108
    v_accvgpr_write_b32 a149, v109
    v_accvgpr_write_b32 a150, v110
    v_accvgpr_write_b32 a151, v111
    v_perm_b32 v108, v154, v152, s46
    v_perm_b32 v109, v154, v152, s47
    v_perm_b32 v110, v155, v153, s46
    v_perm_b32 v111, v155, v153, s47
    v_accvgpr_write_b32 a152, v108
    v_accvgpr_write_b32 a153, v109
    v_accvgpr_write_b32 a154, v110
    v_accvgpr_write_b32 a155, v111
    v_perm_b32 v108, v158, v156, s46
    v_perm_b32 v109, v158, v156, s47
    v_perm_b32 v110, v159, v157, s46
    v_perm_b32 v111, v159, v157, s47
    v_accvgpr_write_b32 a156, v108
    v_accvgpr_write_b32 a157, v109
    v_accvgpr_write_b32 a158, v110
    v_accvgpr_write_b32 a159, v111
    buffer_load_dwordx2 v[144:145], v246, s[20:23], 0 offen offset:896
    buffer_load_dwordx2 v[146:147], v246, s[24:27], 0 offen offset:896
    buffer_load_dwordx2 v[148:149], v246, s[20:23], 0 offen offset:928
    buffer_load_dwordx2 v[150:151], v246, s[24:27], 0 offen offset:928
    buffer_load_dwordx2 v[152:153], v246, s[20:23], 0 offen offset:960
    buffer_load_dwordx2 v[154:155], v246, s[24:27], 0 offen offset:960
    buffer_load_dwordx2 v[156:157], v246, s[20:23], 0 offen offset:992
    buffer_load_dwordx2 v[158:159], v246, s[24:27], 0 offen offset:992
    s_waitcnt vmcnt(40)
    v_perm_b32 v108, v162, v160, s46
    v_perm_b32 v109, v162, v160, s47
    v_perm_b32 v110, v163, v161, s46
    v_perm_b32 v111, v163, v161, s47
    v_accvgpr_write_b32 a160, v108
    v_accvgpr_write_b32 a161, v109
    v_accvgpr_write_b32 a162, v110
    v_accvgpr_write_b32 a163, v111
    v_perm_b32 v108, v166, v164, s46
    v_perm_b32 v109, v166, v164, s47
    v_perm_b32 v110, v167, v165, s46
    v_perm_b32 v111, v167, v165, s47
    v_accvgpr_write_b32 a164, v108
    v_accvgpr_write_b32 a165, v109
    v_accvgpr_write_b32 a166, v110
    v_accvgpr_write_b32 a167, v111
    v_perm_b32 v108, v170, v168, s46
    v_perm_b32 v109, v170, v168, s47
    v_perm_b32 v110, v171, v169, s46
    v_perm_b32 v111, v171, v169, s47
    v_accvgpr_write_b32 a168, v108
    v_accvgpr_write_b32 a169, v109
    v_accvgpr_write_b32 a170, v110
    v_accvgpr_write_b32 a171, v111
    v_perm_b32 v108, v174, v172, s46
    v_perm_b32 v109, v174, v172, s47
    v_perm_b32 v110, v175, v173, s46
    v_perm_b32 v111, v175, v173, s47
    v_accvgpr_write_b32 a172, v108
    v_accvgpr_write_b32 a173, v109
    v_accvgpr_write_b32 a174, v110
    v_accvgpr_write_b32 a175, v111
    s_waitcnt vmcnt(32)
    v_perm_b32 v108, v178, v176, s46
    v_perm_b32 v109, v178, v176, s47
    v_perm_b32 v110, v179, v177, s46
    v_perm_b32 v111, v179, v177, s47
    v_accvgpr_write_b32 a176, v108
    v_accvgpr_write_b32 a177, v109
    v_accvgpr_write_b32 a178, v110
    v_accvgpr_write_b32 a179, v111
    v_perm_b32 v108, v182, v180, s46
    v_perm_b32 v109, v182, v180, s47
    v_perm_b32 v110, v183, v181, s46
    v_perm_b32 v111, v183, v181, s47
    v_accvgpr_write_b32 a180, v108
    v_accvgpr_write_b32 a181, v109
    v_accvgpr_write_b32 a182, v110
    v_accvgpr_write_b32 a183, v111
    v_perm_b32 v108, v186, v184, s46
    v_perm_b32 v109, v186, v184, s47
    v_perm_b32 v110, v187, v185, s46
    v_perm_b32 v111, v187, v185, s47
    v_accvgpr_write_b32 a184, v108
    v_accvgpr_write_b32 a185, v109
    v_accvgpr_write_b32 a186, v110
    v_accvgpr_write_b32 a187, v111
    v_perm_b32 v108, v190, v188, s46
    v_perm_b32 v109, v190, v188, s47
    v_perm_b32 v110, v191, v189, s46
    v_perm_b32 v111, v191, v189, s47
    v_accvgpr_write_b32 a188, v108
    v_accvgpr_write_b32 a189, v109
    v_accvgpr_write_b32 a190, v110
    v_accvgpr_write_b32 a191, v111
    s_waitcnt vmcnt(24)
    v_perm_b32 v108, v194, v192, s46
    v_perm_b32 v109, v194, v192, s47
    v_perm_b32 v110, v195, v193, s46
    v_perm_b32 v111, v195, v193, s47
    v_accvgpr_write_b32 a192, v108
    v_accvgpr_write_b32 a193, v109
    v_accvgpr_write_b32 a194, v110
    v_accvgpr_write_b32 a195, v111
    v_perm_b32 v108, v198, v196, s46
    v_perm_b32 v109, v198, v196, s47
    v_perm_b32 v110, v199, v197, s46
    v_perm_b32 v111, v199, v197, s47
    v_accvgpr_write_b32 a196, v108
    v_accvgpr_write_b32 a197, v109
    v_accvgpr_write_b32 a198, v110
    v_accvgpr_write_b32 a199, v111
    v_perm_b32 v108, v202, v200, s46
    v_perm_b32 v109, v202, v200, s47
    v_perm_b32 v110, v203, v201, s46
    v_perm_b32 v111, v203, v201, s47
    v_accvgpr_write_b32 a200, v108
    v_accvgpr_write_b32 a201, v109
    v_accvgpr_write_b32 a202, v110
    v_accvgpr_write_b32 a203, v111
    v_perm_b32 v108, v206, v204, s46
    v_perm_b32 v109, v206, v204, s47
    v_perm_b32 v110, v207, v205, s46
    v_perm_b32 v111, v207, v205, s47
    v_accvgpr_write_b32 a204, v108
    v_accvgpr_write_b32 a205, v109
    v_accvgpr_write_b32 a206, v110
    v_accvgpr_write_b32 a207, v111
    s_waitcnt vmcnt(16)
    v_perm_b32 v108, v210, v208, s46
    v_perm_b32 v109, v210, v208, s47
    v_perm_b32 v110, v211, v209, s46
    v_perm_b32 v111, v211, v209, s47
    v_accvgpr_write_b32 a208, v108
    v_accvgpr_write_b32 a209, v109
    v_accvgpr_write_b32 a210, v110
    v_accvgpr_write_b32 a211, v111
    v_perm_b32 v108, v214, v212, s46
    v_perm_b32 v109, v214, v212, s47
    v_perm_b32 v110, v215, v213, s46
    v_perm_b32 v111, v215, v213, s47
    v_accvgpr_write_b32 a212, v108
    v_accvgpr_write_b32 a213, v109
    v_accvgpr_write_b32 a214, v110
    v_accvgpr_write_b32 a215, v111
    v_perm_b32 v108, v218, v216, s46
    v_perm_b32 v109, v218, v216, s47
    v_perm_b32 v110, v219, v217, s46
    v_perm_b32 v111, v219, v217, s47
    v_accvgpr_write_b32 a216, v108
    v_accvgpr_write_b32 a217, v109
    v_accvgpr_write_b32 a218, v110
    v_accvgpr_write_b32 a219, v111
    v_perm_b32 v108, v222, v220, s46
    v_perm_b32 v109, v222, v220, s47
    v_perm_b32 v110, v223, v221, s46
    v_perm_b32 v111, v223, v221, s47
    v_accvgpr_write_b32 a220, v108
    v_accvgpr_write_b32 a221, v109
    v_accvgpr_write_b32 a222, v110
    v_accvgpr_write_b32 a223, v111
    s_waitcnt vmcnt(8)
    v_perm_b32 v108, v130, v128, s46
    v_perm_b32 v109, v130, v128, s47
    v_perm_b32 v110, v131, v129, s46
    v_perm_b32 v111, v131, v129, s47
    v_accvgpr_write_b32 a224, v108
    v_accvgpr_write_b32 a225, v109
    v_accvgpr_write_b32 a226, v110
    v_accvgpr_write_b32 a227, v111
    v_perm_b32 v108, v134, v132, s46
    v_perm_b32 v109, v134, v132, s47
    v_perm_b32 v110, v135, v133, s46
    v_perm_b32 v111, v135, v133, s47
    v_accvgpr_write_b32 a228, v108
    v_accvgpr_write_b32 a229, v109
    v_accvgpr_write_b32 a230, v110
    v_accvgpr_write_b32 a231, v111
    v_perm_b32 v108, v138, v136, s46
    v_perm_b32 v109, v138, v136, s47
    v_perm_b32 v110, v139, v137, s46
    v_perm_b32 v111, v139, v137, s47
    v_accvgpr_write_b32 a232, v108
    v_accvgpr_write_b32 a233, v109
    v_accvgpr_write_b32 a234, v110
    v_accvgpr_write_b32 a235, v111
    v_perm_b32 v108, v142, v140, s46
    v_perm_b32 v109, v142, v140, s47
    v_perm_b32 v110, v143, v141, s46
    v_perm_b32 v111, v143, v141, s47
    v_accvgpr_write_b32 a236, v108
    v_accvgpr_write_b32 a237, v109
    v_accvgpr_write_b32 a238, v110
    v_accvgpr_write_b32 a239, v111
    s_waitcnt vmcnt(0)
    v_perm_b32 v108, v146, v144, s46
    v_perm_b32 v109, v146, v144, s47
    v_perm_b32 v110, v147, v145, s46
    v_perm_b32 v111, v147, v145, s47
    v_accvgpr_write_b32 a240, v108
    v_accvgpr_write_b32 a241, v109
    v_accvgpr_write_b32 a242, v110
    v_accvgpr_write_b32 a243, v111
    v_perm_b32 v108, v150, v148, s46
    v_perm_b32 v109, v150, v148, s47
    v_perm_b32 v110, v151, v149, s46
    v_perm_b32 v111, v151, v149, s47
    v_accvgpr_write_b32 a244, v108
    v_accvgpr_write_b32 a245, v109
    v_accvgpr_write_b32 a246, v110
    v_accvgpr_write_b32 a247, v111
    v_perm_b32 v108, v154, v152, s46
    v_perm_b32 v109, v154, v152, s47
    v_perm_b32 v110, v155, v153, s46
    v_perm_b32 v111, v155, v153, s47
    v_accvgpr_write_b32 a248, v108
    v_accvgpr_write_b32 a249, v109
    v_accvgpr_write_b32 a250, v110
    v_accvgpr_write_b32 a251, v111
    v_perm_b32 v108, v158, v156, s46
    v_perm_b32 v109, v158, v156, s47
    v_perm_b32 v110, v159, v157, s46
    v_perm_b32 v111, v159, v157, s47
    v_accvgpr_write_b32 a252, v108
    v_accvgpr_write_b32 a253, v109
    v_accvgpr_write_b32 a254, v110
    v_accvgpr_write_b32 a255, v111
    v_lshlrev_b32 v104, 16, v104
    v_lshlrev_b32 v105, 16, v105
    v_lshlrev_b32 v106, 16, v106
    v_mul_f32 v106, 0x3fb8aa3b, v106
    v_exp_f32 v106, v106
    s_nop 0
    v_cvt_pk_bf16_f32 v106, v106, v106
    v_lshlrev_b32 v106, 16, v106
    v_mul_f32 v108, v106, v104
    v_mul_f32 v109, v106, v105
    v_mul_f32 v108, 0x3fb8aa3b, v108
    v_exp_f32 v108, v108
    v_mul_f32 v109, 0x3e22f983, v109
    v_rndne_f32 v110, v109
    v_sub_f32 v109, v109, v110
    v_cos_f32 v110, v109
    v_sin_f32 v111, v109
    s_nop 0
    v_mul_f32 v12, v108, v110
    v_mul_f32 v13, v108, v111
    v_mul_f32 v108, v104, v104
    v_fma_f32 v108, v105, v105, v108
    v_rcp_f32 v108, v108
    v_add_f32 v109, -1.0, v12
    v_mul_f32 v110, v109, v104
    v_fma_f32 v110, v13, v105, v110
    v_mul_f32 v111, v13, v104
    v_fma_f32 v111, -v109, v105, v111
    v_mul_f32 v16, v110, v108
    v_mul_f32 v17, v111, v108
    v_mov_b32 v14, v12
    v_mov_b32 v15, v13
    v_mul_f32 v108, v15, v15
    v_mul_f32 v109, v14, v15
    v_fma_f32 v14, v14, v14, -v108
    v_add_f32 v15, v109, v109
    v_mul_f32 v108, v15, v15
    v_mul_f32 v109, v14, v15
    v_fma_f32 v14, v14, v14, -v108
    v_add_f32 v15, v109, v109
    v_mul_f32 v108, v15, v15
    v_mul_f32 v109, v14, v15
    v_fma_f32 v14, v14, v14, -v108
    v_add_f32 v15, v109, v109
    v_mov_b32 v18, 0
    v_mov_b32 v19, 0
    v_lshlrev_b32 v116, 16, v120
    v_and_b32 v117, 0xffff0000, v120
    v_lshlrev_b32 v118, 16, v121
    v_and_b32 v119, 0xffff0000, v121
    s_mov_b32 s8, s64
    s_and_b32 s9, s65, 0xffff
    s_mov_b32 s10, 0x200000
    s_mov_b32 s11, 0x20000
    s_mov_b32 s20, s96
    s_and_b32 s21, s97, 0xffff
    s_mov_b32 s22, 0x800000
    s_mov_b32 s23, 0x20000
    v_lshrrev_b32 v243, 4, v240
    v_and_b32 v244, 7, v240
    v_xor_b32 v243, v243, v244
    v_lshlrev_b32 v243, 4, v243
    v_lshrrev_b32 v244, 3, v240
    v_lshl_add_u32 v126, v244, 11, v243
    v_and_b32 v244, 3, v244
    v_lshl_add_u32 v243, v244, 10, v243
    v_lshrrev_b32 v244, 5, v240
    v_lshl_add_u32 v243, v244, 13, v243
    s_lshl_b32 s32, s28, 15
    v_add_u32 v1, s32, v243
    v_xor_b32 v2, 64, v1
    v_lshrrev_b32 v243, 1, v241
    v_xor_b32 v243, v243, v242
    v_lshlrev_b32 v243, 4, v243
    v_lshl_add_u32 v3, v241, 7, v243
    v_xor_b32 v4, 64, v3
    v_add_u32 v3, s32, v3
    v_add_u32 v4, s32, v4
    s_lshl_b32 s33, s28, 2
    v_add_u32 v10, s33, v242
    v_mul_u32_u24 v243, 144, v241
    v_add_u32 v6, 0x20000, v243
    v_lshl_add_u32 v5, v10, 3, v6
    s_lshl_b32 s33, s28, 11
    s_add_u32 s33, s33, 0x21000
    v_lshlrev_b32 v243, 9, v242
    v_lshl_add_u32 v243, v241, 2, v243
    v_add_u32 v7, s33, v243
    v_lshl_add_u32 v8, v240, 4, s33
    v_lshrrev_b32 v243, 2, v240
    v_lshlrev_b32 v243, 11, v243
    v_and_b32 v244, 3, v240
    v_lshl_add_u32 v9, v244, 4, v243
    s_lshl_b32 s32, s28, 16
    s_lshl_b32 s33, s29, 6
    s_add_u32 s32, s32, s33
    s_add_u32 s41, s32, 0x4000000
    v_lshlrev_b32 v243, 12, v241
    v_lshl_add_u32 v124, v242, 4, v243
    v_lshlrev_b32 v243, 10, v241
    v_lshl_add_u32 v125, v242, 3, v243
    s_mov_b32 s32, 0
L_wa_52:
    v_mbcnt_lo_u32_b32 v106, -1, 0
    v_mbcnt_hi_u32_b32 v106, -1, v106
    v_and_b32 v106, 15, v106
    v_lshlrev_b32 v106, 3, v106
    buffer_load_dwordx2 v[104:105], v106, s[16:19], 0 offen offset:128 sc1
    s_add_u32 s32, s32, 1
    s_cmp_gt_u32 s32, 262144
    s_cbranch_scc1 L_fail
    s_waitcnt vmcnt(0)
L_wac_53:
    v_lshrrev_b32 v107, 24, v105
    v_cmp_ne_u32 vcc, 32, v107
    s_and_b32 s33, vcc_lo, 128
    s_cmp_lg_u32 s33, 0
    s_cbranch_scc0 L_wac_53_ok
    s_sleep 8
    s_branch L_wa_52
L_wac_53_ok:
    s_nop 3
    v_readlane_b32 s34, v104, s30
    v_readlane_b32 s35, v105, s30
    s_mul_i32 s32, s31, 6
    s_lshl_b64 s[36:37], 32, s32
    s_or_b32 s37, s37, 0x20000000
    s_cmp_eq_u64 s[34:35], s[36:37]
    s_cselect_b32 s43, 1, 0
    s_lshl_b32 s40, s28, 15
    s_mov_b32 s39, 0
    s_add_u32 m0, s40, 0
    s_add_u32 s45, s39, 0
    buffer_load_dwordx4 v1, s[8:11], s45 offen  lds
    s_add_u32 m0, s40, 1024
    s_add_u32 s45, s39, 16384
    buffer_load_dwordx4 v2, s[8:11], s45 offen  lds
    s_add_u32 m0, s40, 2048
    s_add_u32 s45, s39, 4096
    buffer_load_dwordx4 v1, s[8:11], s45 offen  lds
    s_add_u32 m0, s40, 3072
    s_add_u32 s45, s39, 20480
    buffer_load_dwordx4 v2, s[8:11], s45 offen  lds
    s_add_u32 m0, s40, 4096
    s_add_u32 s45, s39, 128
    buffer_load_dwordx4 v1, s[8:11], s45 offen  lds
    s_add_u32 m0, s40, 5120
    s_add_u32 s45, s39, 16512
    buffer_load_dwordx4 v2, s[8:11], s45 offen  lds
    s_add_u32 m0, s40, 6144
    s_add_u32 s45, s39, 4224
    buffer_load_dwordx4 v1, s[8:11], s45 offen  lds
    s_add_u32 m0, s40, 7168
    s_add_u32 s45, s39, 20608
    buffer_load_dwordx4 v2, s[8:11], s45 offen  lds
    s_add_u32 m0, s40, 8192
    s_add_u32 s45, s39, 256
    buffer_load_dwordx4 v1, s[8:11], s45 offen  lds
    s_add_u32 m0, s40, 9216
    s_add_u32 s45, s39, 16640
    buffer_load_dwordx4 v2, s[8:11], s45 offen  lds
    s_add_u32 m0, s40, 10240
    s_add_u32 s45, s39, 4352
    buffer_load_dwordx4 v1, s[8:11], s45 offen  lds
    s_add_u32 m0, s40, 11264
    s_add_u32 s45, s39, 20736
    buffer_load_dwordx4 v2, s[8:11], s45 offen  lds
    s_add_u32 m0, s40, 12288
    s_add_u32 s45, s39, 384
    buffer_load_dwordx4 v1, s[8:11], s45 offen  lds
    s_add_u32 m0, s40, 13312
    s_add_u32 s45, s39, 16768
    buffer_load_dwordx4 v2, s[8:11], s45 offen  lds
    s_add_u32 m0, s40, 14336
    s_add_u32 s45, s39, 4480
    buffer_load_dwordx4 v1, s[8:11], s45 offen  lds
    s_add_u32 m0, s40, 15360
    s_add_u32 s45, s39, 20864
    buffer_load_dwordx4 v2, s[8:11], s45 offen  lds
    s_add_u32 m0, s40, 16384
    s_add_u32 s45, s39, 512
    buffer_load_dwordx4 v1, s[8:11], s45 offen  lds
    s_add_u32 m0, s40, 17408
    s_add_u32 s45, s39, 16896
    buffer_load_dwordx4 v2, s[8:11], s45 offen  lds
    s_add_u32 m0, s40, 18432
    s_add_u32 s45, s39, 4608
    buffer_load_dwordx4 v1, s[8:11], s45 offen  lds
    s_add_u32 m0, s40, 19456
    s_add_u32 s45, s39, 20992
    buffer_load_dwordx4 v2, s[8:11], s45 offen  lds
    s_add_u32 m0, s40, 20480
    s_add_u32 s45, s39, 640
    buffer_load_dwordx4 v1, s[8:11], s45 offen  lds
    s_add_u32 m0, s40, 21504
    s_add_u32 s45, s39, 17024
    buffer_load_dwordx4 v2, s[8:11], s45 offen  lds
    s_add_u32 m0, s40, 22528
    s_add_u32 s45, s39, 4736
    buffer_load_dwordx4 v1, s[8:11], s45 offen  lds
    s_add_u32 m0, s40, 23552
    s_add_u32 s45, s39, 21120
    buffer_load_dwordx4 v2, s[8:11], s45 offen  lds
    v_mov_b32 v108, 0
    buffer_store_dword v108, off, s[4:7], s42 sc1
    buffer_store_dword v108, off, s[4:7], s42 sc1
    buffer_store_dword v108, off, s[4:7], s42 sc1
    s_mov_b32 s38, 0
    .p2align 6
L_a1_54:
    s_waitcnt vmcnt(19)
    ds_read_b128 v[20:23], v3 offset:0
    ds_read_b128 v[24:27], v3 offset:2048
    ds_read_b128 v[28:31], v4 offset:0
    ds_read_b128 v[32:35], v4 offset:2048
    ds_read_b128 v[36:39], v3 offset:4096
    ds_read_b128 v[40:43], v3 offset:6144
    ds_read_b128 v[44:47], v4 offset:4096
    ds_read_b128 v[48:51], v4 offset:6144
    s_waitcnt lgkmcnt(6)
    v_mfma_f32_16x16x32_bf16 v[52:55], v[20:23], a[0:3], 0
    v_mfma_f32_16x16x32_bf16 v[56:59], v[20:23], a[4:7], 0
    v_mfma_f32_16x16x32_bf16 v[60:63], v[24:27], a[0:3], 0
    v_mfma_f32_16x16x32_bf16 v[64:67], v[24:27], a[4:7], 0
    s_add_u32 m0, s40, 24576
    s_add_u32 s45, s39, 768
    buffer_load_dwordx4 v1, s[8:11], s45 offen  lds
    s_add_u32 m0, s40, 25600
    s_add_u32 s45, s39, 17152
    buffer_load_dwordx4 v2, s[8:11], s45 offen  lds
    s_waitcnt lgkmcnt(4)
    v_mfma_f32_16x16x32_bf16 v[52:55], v[28:31], a[8:11], v[52:55]
    v_mfma_f32_16x16x32_bf16 v[56:59], v[28:31], a[12:15], v[56:59]
    v_mfma_f32_16x16x32_bf16 v[60:63], v[32:35], a[8:11], v[60:63]
    v_mfma_f32_16x16x32_bf16 v[64:67], v[32:35], a[12:15], v[64:67]
    s_add_u32 m0, s40, 26624
    s_add_u32 s45, s39, 4864
    buffer_load_dwordx4 v1, s[8:11], s45 offen  lds
    s_add_u32 m0, s40, 27648
    s_add_u32 s45, s39, 21248
    buffer_load_dwordx4 v2, s[8:11], s45 offen  lds
    s_waitcnt lgkmcnt(2)
    v_mfma_f32_16x16x32_bf16 v[52:55], v[36:39], a[16:19], v[52:55]
    v_mfma_f32_16x16x32_bf16 v[56:59], v[36:39], a[20:23], v[56:59]
    v_mfma_f32_16x16x32_bf16 v[60:63], v[40:43], a[16:19], v[60:63]
    v_mfma_f32_16x16x32_bf16 v[64:67], v[40:43], a[20:23], v[64:67]
    s_add_u32 m0, s40, 28672
    s_add_u32 s45, s39, 896
    buffer_load_dwordx4 v1, s[8:11], s45 offen  lds
    s_add_u32 m0, s40, 29696
    s_add_u32 s45, s39, 17280
    buffer_load_dwordx4 v2, s[8:11], s45 offen  lds
    s_waitcnt lgkmcnt(0)
    v_mfma_f32_16x16x32_bf16 v[52:55], v[44:47], a[24:27], v[52:55]
    v_mfma_f32_16x16x32_bf16 v[56:59], v[44:47], a[28:31], v[56:59]
    v_mfma_f32_16x16x32_bf16 v[60:63], v[48:51], a[24:27], v[60:63]
    v_mfma_f32_16x16x32_bf16 v[64:67], v[48:51], a[28:31], v[64:67]
    s_add_u32 m0, s40, 30720
    s_add_u32 s45, s39, 4992
    buffer_load_dwordx4 v1, s[8:11], s45 offen  lds
    s_add_u32 m0, s40, 31744
    s_add_u32 s45, s39, 21376
    buffer_load_dwordx4 v2, s[8:11], s45 offen  lds
    s_waitcnt vmcnt(19)
    ds_read_b128 v[20:23], v3 offset:8192
    ds_read_b128 v[24:27], v3 offset:10240
    ds_read_b128 v[28:31], v4 offset:8192
    ds_read_b128 v[32:35], v4 offset:10240
    ds_read_b128 v[36:39], v3 offset:12288
    ds_read_b128 v[40:43], v3 offset:14336
    ds_read_b128 v[44:47], v4 offset:12288
    ds_read_b128 v[48:51], v4 offset:14336
    s_waitcnt lgkmcnt(6)
    v_mfma_f32_16x16x32_bf16 v[52:55], v[20:23], a[32:35], v[52:55]
    v_mfma_f32_16x16x32_bf16 v[56:59], v[20:23], a[36:39], v[56:59]
    v_mfma_f32_16x16x32_bf16 v[60:63], v[24:27], a[32:35], v[60:63]
    v_mfma_f32_16x16x32_bf16 v[64:67], v[24:27], a[36:39], v[64:67]
    s_add_u32 m0, s40, 0
    s_add_u32 s45, s39, 131072
    buffer_load_dwordx4 v1, s[8:11], s45 offen  lds
    s_add_u32 m0, s40, 1024
    s_add_u32 s45, s39, 147456
    buffer_load_dwordx4 v2, s[8:11], s45 offen  lds
    s_waitcnt lgkmcnt(4)
    v_mfma_f32_16x16x32_bf16 v[52:55], v[28:31], a[40:43], v[52:55]
    v_mfma_f32_16x16x32_bf16 v[56:59], v[28:31], a[44:47], v[56:59]
    v_mfma_f32_16x16x32_bf16 v[60:63], v[32:35], a[40:43], v[60:63]
    v_mfma_f32_16x16x32_bf16 v[64:67], v[32:35], a[44:47], v[64:67]
    s_add_u32 m0, s40, 2048
    s_add_u32 s45, s39, 135168
    buffer_load_dwordx4 v1, s[8:11], s45 offen  lds
    s_add_u32 m0, s40, 3072
    s_add_u32 s45, s39, 151552
    buffer_load_dwordx4 v2, s[8:11], s45 offen  lds
    s_waitcnt lgkmcnt(2)
    v_mfma_f32_16x16x32_bf16 v[52:55], v[36:39], a[48:51], v[52:55]
    v_mfma_f32_16x16x32_bf16 v[56:59], v[36:39], a[52:55], v[56:59]
    v_mfma_f32_16x16x32_bf16 v[60:63], v[40:43], a[48:51], v[60:63]
    v_mfma_f32_16x16x32_bf16 v[64:67], v[40:43], a[52:55], v[64:67]
    s_add_u32 m0, s40, 4096
    s_add_u32 s45, s39, 131200
    buffer_load_dwordx4 v1, s[8:11], s45 offen  lds
    s_add_u32 m0, s40, 5120
    s_add_u32 s45, s39, 147584
    buffer_load_dwordx4 v2, s[8:11], s45 offen  lds
    s_waitcnt lgkmcnt(0)
    v_mfma_f32_16x16x32_bf16 v[52:55], v[44:47], a[56:59], v[52:55]
    v_mfma_f32_16x16x32_bf16 v[56:59], v[44:47], a[60:63], v[56:59]
    v_mfma_f32_16x16x32_bf16 v[60:63], v[48:51], a[56:59], v[60:63]
    v_mfma_f32_16x16x32_bf16 v[64:67], v[48:51], a[60:63], v[64:67]
    s_add_u32 m0, s40, 6144
    s_add_u32 s45, s39, 135296
    buffer_load_dwordx4 v1, s[8:11], s45 offen  lds
    s_add_u32 m0, s40, 7168
    s_add_u32 s45, s39, 151680
    buffer_load_dwordx4 v2, s[8:11], s45 offen  lds
    s_waitcnt vmcnt(19)
    ds_read_b128 v[20:23], v3 offset:16384
    ds_read_b128 v[24:27], v3 offset:18432
    ds_read_b128 v[28:31], v4 offset:16384
    ds_read_b128 v[32:35], v4 offset:18432
    ds_read_b128 v[36:39], v3 offset:20480
    ds_read_b128 v[40:43], v3 offset:22528
    ds_read_b128 v[44:47], v4 offset:20480
    ds_read_b128 v[48:51], v4 offset:22528
    s_waitcnt lgkmcnt(6)
    v_mfma_f32_16x16x32_bf16 v[52:55], v[20:23], a[64:67], v[52:55]
    v_mfma_f32_16x16x32_bf16 v[56:59], v[20:23], a[68:71], v[56:59]
    v_mfma_f32_16x16x32_bf16 v[60:63], v[24:27], a[64:67], v[60:63]
    v_mfma_f32_16x16x32_bf16 v[64:67], v[24:27], a[68:71], v[64:67]
    s_add_u32 m0, s40, 8192
    s_add_u32 s45, s39, 131328
    buffer_load_dwordx4 v1, s[8:11], s45 offen  lds
    s_add_u32 m0, s40, 9216
    s_add_u32 s45, s39, 147712
    buffer_load_dwordx4 v2, s[8:11], s45 offen  lds
    s_waitcnt lgkmcnt(4)
    v_mfma_f32_16x16x32_bf16 v[52:55], v[28:31], a[72:75], v[52:55]
    v_mfma_f32_16x16x32_bf16 v[56:59], v[28:31], a[76:79], v[56:59]
    v_mfma_f32_16x16x32_bf16 v[60:63], v[32:35], a[72:75], v[60:63]
    v_mfma_f32_16x16x32_bf16 v[64:67], v[32:35], a[76:79], v[64:67]
    s_add_u32 m0, s40, 10240
    s_add_u32 s45, s39, 135424
    buffer_load_dwordx4 v1, s[8:11], s45 offen  lds
    s_add_u32 m0, s40, 11264
    s_add_u32 s45, s39, 151808
    buffer_load_dwordx4 v2, s[8:11], s45 offen  lds
    s_waitcnt lgkmcnt(2)
    v_mfma_f32_16x16x32_bf16 v[52:55], v[36:39], a[80:83], v[52:55]
    v_mfma_f32_16x16x32_bf16 v[56:59], v[36:39], a[84:87], v[56:59]
    v_mfma_f32_16x16x32_bf16 v[60:63], v[40:43], a[80:83], v[60:63]
    v_mfma_f32_16x16x32_bf16 v[64:67], v[40:43], a[84:87], v[64:67]
    s_add_u32 m0, s40, 12288
    s_add_u32 s45, s39, 131456
    buffer_load_dwordx4 v1, s[8:11], s45 offen  lds
    s_add_u32 m0, s40, 13312
    s_add_u32 s45, s39, 147840
    buffer_load_dwordx4 v2, s[8:11], s45 offen  lds
    s_waitcnt lgkmcnt(0)
    v_mfma_f32_16x16x32_bf16 v[52:55], v[44:47], a[88:91], v[52:55]
    v_mfma_f32_16x16x32_bf16 v[56:59], v[44:47], a[92:95], v[56:59]
    v_mfma_f32_16x16x32_bf16 v[60:63], v[48:51], a[88:91], v[60:63]
    v_mfma_f32_16x16x32_bf16 v[64:67], v[48:51], a[92:95], v[64:67]
    s_add_u32 m0, s40, 14336
    s_add_u32 s45, s39, 135552
    buffer_load_dwordx4 v1, s[8:11], s45 offen  lds
    s_add_u32 m0, s40, 15360
    s_add_u32 s45, s39, 151936
    buffer_load_dwordx4 v2, s[8:11], s45 offen  lds
    s_waitcnt vmcnt(16)
    ds_read_b128 v[20:23], v3 offset:24576
    ds_read_b128 v[24:27], v3 offset:26624
    ds_read_b128 v[28:31], v4 offset:24576
    ds_read_b128 v[32:35], v4 offset:26624
    ds_read_b128 v[36:39], v3 offset:28672
    ds_read_b128 v[40:43], v3 offset:30720
    ds_read_b128 v[44:47], v4 offset:28672
    ds_read_b128 v[48:51], v4 offset:30720
    s_waitcnt lgkmcnt(6)
    v_mfma_f32_16x16x32_bf16 v[52:55], v[20:23], a[96:99], v[52:55]
    v_mfma_f32_16x16x32_bf16 v[56:59], v[20:23], a[100:103], v[56:59]
    v_mfma_f32_16x16x32_bf16 v[60:63], v[24:27], a[96:99], v[60:63]
    v_mfma_f32_16x16x32_bf16 v[64:67], v[24:27], a[100:103], v[64:67]
    s_add_u32 m0, s40, 16384
    s_add_u32 s45, s39, 131584
    buffer_load_dwordx4 v1, s[8:11], s45 offen  lds
    s_add_u32 m0, s40, 17408
    s_add_u32 s45, s39, 147968
    buffer_load_dwordx4 v2, s[8:11], s45 offen  lds
    s_waitcnt lgkmcnt(4)
    v_mfma_f32_16x16x32_bf16 v[52:55], v[28:31], a[104:107], v[52:55]
    v_mfma_f32_16x16x32_bf16 v[56:59], v[28:31], a[108:111], v[56:59]
    v_mfma_f32_16x16x32_bf16 v[60:63], v[32:35], a[104:107], v[60:63]
    v_mfma_f32_16x16x32_bf16 v[64:67], v[32:35], a[108:111], v[64:67]
    s_add_u32 m0, s40, 18432
    s_add_u32 s45, s39, 135680
    buffer_load_dwordx4 v1, s[8:11], s45 offen  lds
    s_add_u32 m0, s40, 19456
    s_add_u32 s45, s39, 152064
    buffer_load_dwordx4 v2, s[8:11], s45 offen  lds
    s_waitcnt lgkmcnt(2)
    v_mfma_f32_16x16x32_bf16 v[52:55], v[36:39], a[112:115], v[52:55]
    v_mfma_f32_16x16x32_bf16 v[56:59], v[36:39], a[116:119], v[56:59]
    v_mfma_f32_16x16x32_bf16 v[60:63], v[40:43], a[112:115], v[60:63]
    v_mfma_f32_16x16x32_bf16 v[64:67], v[40:43], a[116:119], v[64:67]
    s_add_u32 m0, s40, 20480
    s_add_u32 s45, s39, 131712
    buffer_load_dwordx4 v1, s[8:11], s45 offen  lds
    s_add_u32 m0, s40, 21504
    s_add_u32 s45, s39, 148096
    buffer_load_dwordx4 v2, s[8:11], s45 offen  lds
    s_waitcnt lgkmcnt(0)
    v_mfma_f32_16x16x32_bf16 v[52:55], v[44:47], a[120:123], v[52:55]
    v_mfma_f32_16x16x32_bf16 v[56:59], v[44:47], a[124:127], v[56:59]
    v_mfma_f32_16x16x32_bf16 v[60:63], v[48:51], a[120:123], v[60:63]
    v_mfma_f32_16x16x32_bf16 v[64:67], v[48:51], a[124:127], v[64:67]
    s_add_u32 m0, s40, 22528
    s_add_u32 s45, s39, 135808
    buffer_load_dwordx4 v1, s[8:11], s45 offen  lds
    s_add_u32 m0, s40, 23552
    s_add_u32 s45, s39, 152192
    buffer_load_dwordx4 v2, s[8:11], s45 offen  lds
    s_add_u32 s39, s39, 131072
    s_nop 1
    v_fma_f32 v104, v12, v52, v53
    v_fma_f32 v105, v12, v56, v57
    v_fma_f32 v100, -v13, v56, v104
    v_fma_f32 v101, v13, v52, v105
    v_fma_f32 v104, v12, v100, v54
    v_fma_f32 v105, v12, v101, v58
    v_fma_f32 v102, -v13, v101, v104
    v_fma_f32 v103, v13, v100, v105
    v_fma_f32 v104, v12, v102, v55
    v_fma_f32 v105, v12, v103, v59
    v_fma_f32 v100, -v13, v103, v104
    v_fma_f32 v101, v13, v102, v105
    v_fma_f32 v104, v12, v100, v60
    v_fma_f32 v105, v12, v101, v64
    v_fma_f32 v102, -v13, v101, v104
    v_fma_f32 v103, v13, v100, v105
    v_fma_f32 v104, v12, v102, v61
    v_fma_f32 v105, v12, v103, v65
    v_fma_f32 v100, -v13, v103, v104
    v_fma_f32 v101, v13, v102, v105
    v_fma_f32 v104, v12, v100, v62
    v_fma_f32 v105, v12, v101, v66
    v_fma_f32 v102, -v13, v101, v104
    v_fma_f32 v103, v13, v100, v105
    v_fma_f32 v104, v12, v102, v63
    v_fma_f32 v105, v12, v103, v67
    v_fma_f32 v100, -v13, v103, v104
    v_fma_f32 v101, v13, v102, v105
    ds_write_b64 v5, v[100:101]
    s_waitcnt lgkmcnt(0) vmcnt(24)
    s_barrier
    ds_read_b128 v[68:71], v6 offset:0
    ds_read_b128 v[72:75], v6 offset:16
    ds_read_b128 v[76:79], v6 offset:32
    ds_read_b128 v[80:83], v6 offset:48
    ds_read_b128 v[84:87], v6 offset:64
    ds_read_b128 v[88:91], v6 offset:80
    ds_read_b128 v[92:95], v6 offset:96
    ds_read_b128 v[96:99], v6 offset:112
    v_mov_b32 v108, s38
    v_mov_b32 v100, v18
    v_mov_b32 v101, v19
    s_waitcnt lgkmcnt(0)
    s_barrier
    v_fma_f32 v104, v14, v18, v68
    v_fma_f32 v105, v14, v19, v69
    v_fma_f32 v102, -v15, v19, v104
    v_fma_f32 v103, v15, v18, v105
    v_cmp_eq_u32 vcc, 1, v10
    v_fma_f32 v104, v14, v102, v70
    v_fma_f32 v105, v14, v103, v71
    v_cndmask_b32 v100, v100, v102, vcc
    v_cndmask_b32 v101, v101, v103, vcc
    v_fma_f32 v18, -v15, v103, v104
    v_fma_f32 v19, v15, v102, v105
    v_cmp_eq_u32 vcc, 2, v10
    v_fma_f32 v104, v14, v18, v72
    v_fma_f32 v105, v14, v19, v73
    v_cndmask_b32 v100, v100, v18, vcc
    v_cndmask_b32 v101, v101, v19, vcc
    v_fma_f32 v102, -v15, v19, v104
    v_fma_f32 v103, v15, v18, v105
    v_cmp_eq_u32 vcc, 3, v10
    v_fma_f32 v104, v14, v102, v74
    v_fma_f32 v105, v14, v103, v75
    v_cndmask_b32 v100, v100, v102, vcc
    v_cndmask_b32 v101, v101, v103, vcc
    v_fma_f32 v18, -v15, v103, v104
    v_fma_f32 v19, v15, v102, v105
    v_cmp_eq_u32 vcc, 4, v10
    v_fma_f32 v104, v14, v18, v76
    v_fma_f32 v105, v14, v19, v77
    v_cndmask_b32 v100, v100, v18, vcc
    v_cndmask_b32 v101, v101, v19, vcc
    v_fma_f32 v102, -v15, v19, v104
    v_fma_f32 v103, v15, v18, v105
    v_cmp_eq_u32 vcc, 5, v10
    v_fma_f32 v104, v14, v102, v78
    v_fma_f32 v105, v14, v103, v79
    v_cndmask_b32 v100, v100, v102, vcc
    v_cndmask_b32 v101, v101, v103, vcc
    v_fma_f32 v18, -v15, v103, v104
    v_fma_f32 v19, v15, v102, v105
    v_cmp_eq_u32 vcc, 6, v10
    v_fma_f32 v104, v14, v18, v80
    v_fma_f32 v105, v14, v19, v81
    v_cndmask_b32 v100, v100, v18, vcc
    v_cndmask_b32 v101, v101, v19, vcc
    v_fma_f32 v102, -v15, v19, v104
    v_fma_f32 v103, v15, v18, v105
    v_cmp_eq_u32 vcc, 7, v10
    v_fma_f32 v104, v14, v102, v82
    v_fma_f32 v105, v14, v103, v83
    v_cndmask_b32 v100, v100, v102, vcc
    v_cndmask_b32 v101, v101, v103, vcc
    v_fma_f32 v18, -v15, v103, v104
    v_fma_f32 v19, v15, v102, v105
    v_cmp_eq_u32 vcc, 8, v10
    v_fma_f32 v104, v14, v18, v84
    v_fma_f32 v105, v14, v19, v85
    v_cndmask_b32 v100, v100, v18, vcc
    v_cndmask_b32 v101, v101, v19, vcc
    v_fma_f32 v102, -v15, v19, v104
    v_fma_f32 v103, v15, v18, v105
    v_cmp_eq_u32 vcc, 9, v10
    v_fma_f32 v104, v14, v102, v86
    v_fma_f32 v105, v14, v103, v87
    v_cndmask_b32 v100, v100, v102, vcc
    v_cndmask_b32 v101, v101, v103, vcc
    v_fma_f32 v18, -v15, v103, v104
    v_fma_f32 v19, v15, v102, v105
    v_cmp_eq_u32 vcc, 10, v10
    v_fma_f32 v104, v14, v18, v88
    v_fma_f32 v105, v14, v19, v89
    v_cndmask_b32 v100, v100, v18, vcc
    v_cndmask_b32 v101, v101, v19, vcc
    v_fma_f32 v102, -v15, v19, v104
    v_fma_f32 v103, v15, v18, v105
    v_cmp_eq_u32 vcc, 11, v10
    v_fma_f32 v104, v14, v102, v90
    v_fma_f32 v105, v14, v103, v91
    v_cndmask_b32 v100, v100, v102, vcc
    v_cndmask_b32 v101, v101, v103, vcc
    v_fma_f32 v18, -v15, v103, v104
    v_fma_f32 v19, v15, v102, v105
    v_cmp_eq_u32 vcc, 12, v10
    v_fma_f32 v104, v14, v18, v92
    v_fma_f32 v105, v14, v19, v93
    v_cndmask_b32 v100, v100, v18, vcc
    v_cndmask_b32 v101, v101, v19, vcc
    v_fma_f32 v102, -v15, v19, v104
    v_fma_f32 v103, v15, v18, v105
    v_cmp_eq_u32 vcc, 13, v10
    v_fma_f32 v104, v14, v102, v94
    v_fma_f32 v105, v14, v103, v95
    v_cndmask_b32 v100, v100, v102, vcc
    v_cndmask_b32 v101, v101, v103, vcc
    v_fma_f32 v18, -v15, v103, v104
    v_fma_f32 v19, v15, v102, v105
    v_cmp_eq_u32 vcc, 14, v10
    v_fma_f32 v104, v14, v18, v96
    v_fma_f32 v105, v14, v19, v97
    v_cndmask_b32 v100, v100, v18, vcc
    v_cndmask_b32 v101, v101, v19, vcc
    v_fma_f32 v102, -v15, v19, v104
    v_fma_f32 v103, v15, v18, v105
    v_cmp_eq_u32 vcc, 15, v10
    v_fma_f32 v104, v14, v102, v98
    v_fma_f32 v105, v14, v103, v99
    v_cndmask_b32 v100, v100, v102, vcc
    v_cndmask_b32 v101, v101, v103, vcc
    v_fma_f32 v18, -v15, v103, v104
    v_fma_f32 v19, v15, v102, v105
    v_fma_f32 v104, v12, v100, v52
    v_fma_f32 v105, v12, v101, v56
    v_fma_f32 v52, -v13, v101, v104
    v_fma_f32 v56, v13, v100, v105
    v_fma_f32 v104, v12, v52, v53
    v_fma_f32 v105, v12, v56, v57
    v_fma_f32 v53, -v13, v56, v104
    v_fma_f32 v57, v13, v52, v105
    v_fma_f32 v104, v12, v53, v54
    v_fma_f32 v105, v12, v57, v58
    v_fma_f32 v54, -v13, v57, v104
    v_fma_f32 v58, v13, v53, v105
    v_fma_f32 v104, v12, v54, v55
    v_fma_f32 v105, v12, v58, v59
    v_fma_f32 v55, -v13, v58, v104
    v_fma_f32 v59, v13, v54, v105
    v_fma_f32 v104, v12, v55, v60
    v_fma_f32 v105, v12, v59, v64
    v_fma_f32 v60, -v13, v59, v104
    v_fma_f32 v64, v13, v55, v105
    v_fma_f32 v104, v12, v60, v61
    v_fma_f32 v105, v12, v64, v65
    v_fma_f32 v61, -v13, v64, v104
    v_fma_f32 v65, v13, v60, v105
    v_fma_f32 v104, v12, v61, v62
    v_fma_f32 v105, v12, v65, v66
    v_fma_f32 v62, -v13, v65, v104
    v_fma_f32 v66, v13, v61, v105
    v_fma_f32 v104, v12, v62, v63
    v_fma_f32 v105, v12, v66, v67
    v_fma_f32 v63, -v13, v66, v104
    v_fma_f32 v67, v13, v62, v105
    v_mul_f32 v104, v16, v52
    v_mul_f32 v105, v16, v56
    v_fma_f32 v104, -v17, v56, v104
    v_fma_f32 v105, v17, v52, v105
    v_cvt_pk_bf16_f32 v68, v104, -v105
    ds_write_b32 v7, v68 offset:0
    v_mul_f32 v104, v16, v53
    v_mul_f32 v105, v16, v57
    v_fma_f32 v104, -v17, v57, v104
    v_fma_f32 v105, v17, v53, v105
    v_cvt_pk_bf16_f32 v69, v104, -v105
    ds_write_b32 v7, v69 offset:64
    v_mul_f32 v104, v16, v54
    v_mul_f32 v105, v16, v58
    v_fma_f32 v104, -v17, v58, v104
    v_fma_f32 v105, v17, v54, v105
    v_cvt_pk_bf16_f32 v70, v104, -v105
    ds_write_b32 v7, v70 offset:128
    v_mul_f32 v104, v16, v55
    v_mul_f32 v105, v16, v59
    v_fma_f32 v104, -v17, v59, v104
    v_fma_f32 v105, v17, v55, v105
    v_cvt_pk_bf16_f32 v71, v104, -v105
    ds_write_b32 v7, v71 offset:192
    v_mul_f32 v104, v16, v60
    v_mul_f32 v105, v16, v64
    v_fma_f32 v104, -v17, v64, v104
    v_fma_f32 v105, v17, v60, v105
    v_cvt_pk_bf16_f32 v72, v104, -v105
    ds_write_b32 v7, v72 offset:256
    v_mul_f32 v104, v16, v61
    v_mul_f32 v105, v16, v65
    v_fma_f32 v104, -v17, v65, v104
    v_fma_f32 v105, v17, v61, v105
    v_cvt_pk_bf16_f32 v73, v104, -v105
    ds_write_b32 v7, v73 offset:320
    v_mul_f32 v104, v16, v62
    v_mul_f32 v105, v16, v66
    v_fma_f32 v104, -v17, v66, v104
    v_fma_f32 v105, v17, v62, v105
    v_cvt_pk_bf16_f32 v74, v104, -v105
    ds_write_b32 v7, v74 offset:384
    v_mul_f32 v104, v16, v63
    v_mul_f32 v105, v16, v67
    v_fma_f32 v104, -v17, v67, v104
    v_fma_f32 v105, v17, v63, v105
    v_cvt_pk_bf16_f32 v75, v104, -v105
    ds_write_b32 v7, v75 offset:448
    s_waitcnt lgkmcnt(0)
    ds_read_b128 v[76:79], v8
    ds_read_b128 v[80:83], v8 offset:1024
    buffer_store_dword v108, off, s[4:7], s42 sc1
    s_add_u32 s32, s41, 32768
    s_waitcnt lgkmcnt(0)
    s_cmp_eq_u32 s43, 0
    s_cbranch_scc1 L_hs_55
    buffer_store_dwordx4 v[76:79], v9, s[4:7], s41 offen
    buffer_store_dwordx4 v[80:83], v9, s[4:7], s32 offen
    s_branch L_hj_56
L_hs_55:
    buffer_store_dwordx4 v[76:79], v9, s[4:7], s41 offen sc1
    buffer_store_dwordx4 v[80:83], v9, s[4:7], s32 offen sc1
L_hj_56:
    s_add_u32 s41, s41, 262144
    s_add_u32 s38, s38, 1
    s_cmp_lt_u32 s38, 16
    s_cbranch_scc1 L_a1_54
    s_waitcnt vmcnt(0)
    s_barrier
    v_mov_b32 v108, 16
    buffer_store_dword v108, off, s[4:7], s42 sc1
    s_lshl_b32 s32, s28, 15
    v_subrev_u32 v3, s32, v3
    v_subrev_u32 v4, s32, v4
    s_and_b32 s32, s28, 1
    s_lshl_b32 s33, s32, 6
    v_xor_b32 v126, s33, v126
    s_lshl_b32 s33, s32, 14
    s_lshr_b32 s34, s28, 1
    s_lshl_b32 s35, s34, 10
    s_add_u32 s33, s33, s35
    s_and_b32 s35, s29, 3
    s_lshl_b32 s36, s35, 20
    s_add_u32 s33, s33, s36
    s_add_u32 s39, s33, 0x4000000
    s_lshl_b32 s33, s34, 14
    s_lshl_b32 s32, s32, 10
    s_add_u32 s40, s33, s32
    s_lshl_b32 s50, s35, 21
    s_lshl_b32 s32, s52, 1
    s_add_u32 s50, s50, s32
    s_lshl_b32 s51, s35, 19
    s_add_u32 s51, s51, s52
    s_lshl_b32 s49, s35, 5
    s_mov_b32 s48, 0
    v_mbcnt_lo_u32_b32 v1, -1, 0
    v_mbcnt_hi_u32_b32 v1, -1, v1
    v_and_b32 v1, 31, v1
    v_lshlrev_b32 v1, 2, v1
    v_add_u32 v1, 0x7000, v1
    s_lshr_b32 s32, s49, 3
    s_min_u32 s32, s32, 15
    s_cmp_gt_u32 s48, s32
    s_cbranch_scc1 L_aok_57
    s_mov_b32 s44, 262144
L_ap_58:
    buffer_load_dword v104, v1, s[4:7], 0 offen sc1
    s_sub_u32 s44, s44, 1
    s_cbranch_scc1 L_fail
    s_waitcnt vmcnt(0)
    v_cmp_ge_u32 vcc, s32, v104
    s_cbranch_vccz L_gotL_aok_57
    s_sleep 2
    s_branch L_ap_58
L_gotL_aok_57:
    s_add_u32 s48, s32, 1
L_aok_57:
    s_add_u32 m0, s40, 0
    s_add_u32 s45, s39, 0
    buffer_load_dwordx4 v126, s[4:7], s45 offen sc1 lds
    s_add_u32 m0, s40, 2048
    s_add_u32 s45, s39, 128
    buffer_load_dwordx4 v126, s[4:7], s45 offen sc1 lds
    s_add_u32 m0, s40, 4096
    s_add_u32 s45, s39, 256
    buffer_load_dwordx4 v126, s[4:7], s45 offen sc1 lds
    s_add_u32 m0, s40, 6144
    s_add_u32 s45, s39, 384
    buffer_load_dwordx4 v126, s[4:7], s45 offen sc1 lds
    s_add_u32 m0, s40, 8192
    s_add_u32 s45, s39, 512
    buffer_load_dwordx4 v126, s[4:7], s45 offen sc1 lds
    s_add_u32 m0, s40, 10240
    s_add_u32 s45, s39, 640
    buffer_load_dwordx4 v126, s[4:7], s45 offen sc1 lds
    s_add_u32 m0, s40, 12288
    s_add_u32 s45, s39, 768
    buffer_load_dwordx4 v126, s[4:7], s45 offen sc1 lds
    s_add_u32 m0, s40, 14336
    s_add_u32 s45, s39, 896
    buffer_load_dwordx4 v126, s[4:7], s45 offen sc1 lds
    s_add_u32 s39, s39, 32768
    s_add_u32 s40, s40, 32768
    s_and_b32 s40, s40, 0x1ffff
    s_add_u32 s49, s49, 1
    s_lshr_b32 s32, s49, 3
    s_min_u32 s32, s32, 15
    s_cmp_gt_u32 s48, s32
    s_cbranch_scc1 L_aok_59
    s_mov_b32 s44, 262144
L_ap_60:
    buffer_load_dword v104, v1, s[4:7], 0 offen sc1
    s_sub_u32 s44, s44, 1
    s_cbranch_scc1 L_fail
    s_waitcnt vmcnt(0)
    v_cmp_ge_u32 vcc, s32, v104
    s_cbranch_vccz L_gotL_aok_59
    s_sleep 2
    s_branch L_ap_60
L_gotL_aok_59:
    s_add_u32 s48, s32, 1
L_aok_59:
    s_add_u32 m0, s40, 0
    s_add_u32 s45, s39, 0
    buffer_load_dwordx4 v126, s[4:7], s45 offen sc1 lds
    s_add_u32 m0, s40, 2048
    s_add_u32 s45, s39, 128
    buffer_load_dwordx4 v126, s[4:7], s45 offen sc1 lds
    s_add_u32 m0, s40, 4096
    s_add_u32 s45, s39, 256
    buffer_load_dwordx4 v126, s[4:7], s45 offen sc1 lds
    s_add_u32 m0, s40, 6144
    s_add_u32 s45, s39, 384
    buffer_load_dwordx4 v126, s[4:7], s45 offen sc1 lds
    s_add_u32 m0, s40, 8192
    s_add_u32 s45, s39, 512
    buffer_load_dwordx4 v126, s[4:7], s45 offen sc1 lds
    s_add_u32 m0, s40, 10240
    s_add_u32 s45, s39, 640
    buffer_load_dwordx4 v126, s[4:7], s45 offen sc1 lds
    s_add_u32 m0, s40, 12288
    s_add_u32 s45, s39, 768
    buffer_load_dwordx4 v126, s[4:7], s45 offen sc1 lds
    s_add_u32 m0, s40, 14336
    s_add_u32 s45, s39, 896
    buffer_load_dwordx4 v126, s[4:7], s45 offen sc1 lds
    s_add_u32 s39, s39, 32768
    s_add_u32 s40, s40, 32768
    s_and_b32 s40, s40, 0x1ffff
    s_add_u32 s49, s49, 1
    s_lshr_b32 s32, s49, 3
    s_min_u32 s32, s32, 15
    s_cmp_gt_u32 s48, s32
    s_cbranch_scc1 L_aok_61
    s_mov_b32 s44, 262144
L_ap_62:
    buffer_load_dword v104, v1, s[4:7], 0 offen sc1
    s_sub_u32 s44, s44, 1
    s_cbranch_scc1 L_fail
    s_waitcnt vmcnt(0)
    v_cmp_ge_u32 vcc, s32, v104
    s_cbranch_vccz L_gotL_aok_61
    s_sleep 2
    s_branch L_ap_62
L_gotL_aok_61:
    s_add_u32 s48, s32, 1
L_aok_61:
    s_add_u32 m0, s40, 0
    s_add_u32 s45, s39, 0
    buffer_load_dwordx4 v126, s[4:7], s45 offen sc1 lds
    s_add_u32 m0, s40, 2048
    s_add_u32 s45, s39, 128
    buffer_load_dwordx4 v126, s[4:7], s45 offen sc1 lds
    s_add_u32 m0, s40, 4096
    s_add_u32 s45, s39, 256
    buffer_load_dwordx4 v126, s[4:7], s45 offen sc1 lds
    s_add_u32 m0, s40, 6144
    s_add_u32 s45, s39, 384
    buffer_load_dwordx4 v126, s[4:7], s45 offen sc1 lds
    s_add_u32 m0, s40, 8192
    s_add_u32 s45, s39, 512
    buffer_load_dwordx4 v126, s[4:7], s45 offen sc1 lds
    s_add_u32 m0, s40, 10240
    s_add_u32 s45, s39, 640
    buffer_load_dwordx4 v126, s[4:7], s45 offen sc1 lds
    s_add_u32 m0, s40, 12288
    s_add_u32 s45, s39, 768
    buffer_load_dwordx4 v126, s[4:7], s45 offen sc1 lds
    s_add_u32 m0, s40, 14336
    s_add_u32 s45, s39, 896
    buffer_load_dwordx4 v126, s[4:7], s45 offen sc1 lds
    s_add_u32 s39, s39, 32768
    s_add_u32 s40, s40, 32768
    s_and_b32 s40, s40, 0x1ffff
    s_add_u32 s49, s49, 1
    s_mov_b32 s38, 0
    s_waitcnt vmcnt(16)
    s_branch L_a2e_64
    .p2align 6
L_a2_63:
    s_waitcnt vmcnt(18)
L_a2e_64:
    s_barrier
    buffer_load_dwordx2 v[120:121], v125, s[8:11], s51 offen
    ds_read_b128 v[20:23], v3 offset:0
    ds_read_b128 v[24:27], v4 offset:0
    ds_read_b128 v[28:31], v3 offset:2048
    ds_read_b128 v[32:35], v4 offset:2048
    ds_read_b128 v[36:39], v3 offset:4096
    ds_read_b128 v[40:43], v4 offset:4096
    ds_read_b128 v[44:47], v3 offset:6144
    s_lshr_b32 s32, s49, 3
    s_min_u32 s32, s32, 15
    s_cmp_gt_u32 s48, s32
    s_cbranch_scc1 L_aok_65
    s_mov_b32 s44, 262144
L_ap_66:
    buffer_load_dword v104, v1, s[4:7], 0 offen sc1
    s_sub_u32 s44, s44, 1
    s_cbranch_scc1 L_fail
    s_waitcnt vmcnt(0)
    v_cmp_ge_u32 vcc, s32, v104
    s_cbranch_vccz L_gotL_aok_65
    s_sleep 2
    s_branch L_ap_66
L_gotL_aok_65:
    s_add_u32 s48, s32, 1
L_aok_65:
    s_add_u32 m0, s40, 0
    s_add_u32 s45, s39, 0
    buffer_load_dwordx4 v126, s[4:7], s45 offen sc1 lds
    s_add_u32 m0, s40, 2048
    s_add_u32 s45, s39, 128
    buffer_load_dwordx4 v126, s[4:7], s45 offen sc1 lds
    s_add_u32 m0, s40, 4096
    s_add_u32 s45, s39, 256
    buffer_load_dwordx4 v126, s[4:7], s45 offen sc1 lds
    s_add_u32 m0, s40, 6144
    s_add_u32 s45, s39, 384
    buffer_load_dwordx4 v126, s[4:7], s45 offen sc1 lds
    s_add_u32 m0, s40, 8192
    s_add_u32 s45, s39, 512
    buffer_load_dwordx4 v126, s[4:7], s45 offen sc1 lds
    s_add_u32 m0, s40, 10240
    s_add_u32 s45, s39, 640
    buffer_load_dwordx4 v126, s[4:7], s45 offen sc1 lds
    s_add_u32 m0, s40, 12288
    s_add_u32 s45, s39, 768
    buffer_load_dwordx4 v126, s[4:7], s45 offen sc1 lds
    s_add_u32 m0, s40, 14336
    s_add_u32 s45, s39, 896
    buffer_load_dwordx4 v126, s[4:7], s45 offen sc1 lds
    s_add_u32 s39, s39, 32768
    s_add_u32 s40, s40, 32768
    s_and_b32 s40, s40, 0x1ffff
    s_add_u32 s49, s49, 1
    s_waitcnt lgkmcnt(6)
    v_mfma_f32_16x16x32_bf16 v[52:55], a[128:131], v[20:23], 0
    ds_read_b128 v[48:51], v4 offset:6144
    s_waitcnt lgkmcnt(6)
    v_mfma_f32_16x16x32_bf16 v[56:59], a[132:135], v[24:27], 0
    ds_read_b128 v[20:23], v3 offset:8192
    s_waitcnt lgkmcnt(6)
    v_mfma_f32_16x16x32_bf16 v[52:55], a[136:139], v[28:31], v[52:55]
    ds_read_b128 v[24:27], v4 offset:8192
    s_waitcnt lgkmcnt(6)
    v_mfma_f32_16x16x32_bf16 v[56:59], a[140:143], v[32:35], v[56:59]
    ds_read_b128 v[28:31], v3 offset:10240
    s_waitcnt lgkmcnt(6)
    v_mfma_f32_16x16x32_bf16 v[52:55], a[144:147], v[36:39], v[52:55]
    ds_read_b128 v[32:35], v4 offset:10240
    s_waitcnt lgkmcnt(6)
    v_mfma_f32_16x16x32_bf16 v[56:59], a[148:151], v[40:43], v[56:59]
    ds_read_b128 v[36:39], v3 offset:12288
    s_waitcnt lgkmcnt(6)
    v_mfma_f32_16x16x32_bf16 v[52:55], a[152:155], v[44:47], v[52:55]
    ds_read_b128 v[40:43], v4 offset:12288
    s_waitcnt lgkmcnt(6)
    v_mfma_f32_16x16x32_bf16 v[56:59], a[156:159], v[48:51], v[56:59]
    ds_read_b128 v[44:47], v3 offset:14336
    s_waitcnt lgkmcnt(6)
    v_mfma_f32_16x16x32_bf16 v[52:55], a[160:163], v[20:23], v[52:55]
    ds_read_b128 v[48:51], v4 offset:14336
    s_waitcnt lgkmcnt(6)
    v_mfma_f32_16x16x32_bf16 v[56:59], a[164:167], v[24:27], v[56:59]
    ds_read_b128 v[20:23], v3 offset:16384
    s_waitcnt lgkmcnt(6)
    v_mfma_f32_16x16x32_bf16 v[52:55], a[168:171], v[28:31], v[52:55]
    ds_read_b128 v[24:27], v4 offset:16384
    s_waitcnt lgkmcnt(6)
    v_mfma_f32_16x16x32_bf16 v[56:59], a[172:175], v[32:35], v[56:59]
    ds_read_b128 v[28:31], v3 offset:18432
    s_waitcnt lgkmcnt(6)
    v_mfma_f32_16x16x32_bf16 v[52:55], a[176:179], v[36:39], v[52:55]
    ds_read_b128 v[32:35], v4 offset:18432
    s_waitcnt lgkmcnt(6)
    v_mfma_f32_16x16x32_bf16 v[56:59], a[180:183], v[40:43], v[56:59]
    ds_read_b128 v[36:39], v3 offset:20480
    s_waitcnt lgkmcnt(6)
    v_mfma_f32_16x16x32_bf16 v[52:55], a[184:187], v[44:47], v[52:55]
    ds_read_b128 v[40:43], v4 offset:20480
    s_waitcnt lgkmcnt(6)
    v_mfma_f32_16x16x32_bf16 v[56:59], a[188:191], v[48:51], v[56:59]
    ds_read_b128 v[44:47], v3 offset:22528
    s_waitcnt lgkmcnt(6)
    v_mfma_f32_16x16x32_bf16 v[52:55], a[192:195], v[20:23], v[52:55]
    ds_read_b128 v[48:51], v4 offset:22528
    s_waitcnt lgkmcnt(6)
    v_mfma_f32_16x16x32_bf16 v[56:59], a[196:199], v[24:27], v[56:59]
    ds_read_b128 v[20:23], v3 offset:24576
    s_waitcnt lgkmcnt(6)
    v_mfma_f32_16x16x32_bf16 v[52:55], a[200:203], v[28:31], v[52:55]
    ds_read_b128 v[24:27], v4 offset:24576
    s_waitcnt lgkmcnt(6)
    v_mfma_f32_16x16x32_bf16 v[56:59], a[204:207], v[32:35], v[56:59]
    ds_read_b128 v[28:31], v3 offset:26624
    s_waitcnt lgkmcnt(6)
    v_mfma_f32_16x16x32_bf16 v[52:55], a[208:211], v[36:39], v[52:55]
    ds_read_b128 v[32:35], v4 offset:26624
    s_waitcnt lgkmcnt(6)
    v_mfma_f32_16x16x32_bf16 v[56:59], a[212:215], v[40:43], v[56:59]
    ds_read_b128 v[36:39], v3 offset:28672
    s_waitcnt lgkmcnt(6)
    v_mfma_f32_16x16x32_bf16 v[52:55], a[216:219], v[44:47], v[52:55]
    ds_read_b128 v[40:43], v4 offset:28672
    s_waitcnt lgkmcnt(6)
    v_mfma_f32_16x16x32_bf16 v[56:59], a[220:223], v[48:51], v[56:59]
    ds_read_b128 v[44:47], v3 offset:30720
    s_waitcnt lgkmcnt(6)
    v_mfma_f32_16x16x32_bf16 v[52:55], a[224:227], v[20:23], v[52:55]
    ds_read_b128 v[48:51], v4 offset:30720
    s_waitcnt lgkmcnt(6)
    v_mfma_f32_16x16x32_bf16 v[56:59], a[228:231], v[24:27], v[56:59]
    s_waitcnt lgkmcnt(5)
    v_mfma_f32_16x16x32_bf16 v[52:55], a[232:235], v[28:31], v[52:55]
    s_waitcnt lgkmcnt(4)
    v_mfma_f32_16x16x32_bf16 v[56:59], a[236:239], v[32:35], v[56:59]
    s_waitcnt lgkmcnt(3)
    v_mfma_f32_16x16x32_bf16 v[52:55], a[240:243], v[36:39], v[52:55]
    s_waitcnt lgkmcnt(2)
    v_mfma_f32_16x16x32_bf16 v[56:59], a[244:247], v[40:43], v[56:59]
    s_waitcnt lgkmcnt(1)
    v_mfma_f32_16x16x32_bf16 v[52:55], a[248:251], v[44:47], v[52:55]
    s_waitcnt lgkmcnt(0)
    v_mfma_f32_16x16x32_bf16 v[56:59], a[252:255], v[48:51], v[56:59]
    v_add_u32 v3, 0x8000, v3
    v_and_b32 v3, 0x1ffff, v3
    v_add_u32 v4, 0x8000, v4
    v_and_b32 v4, 0x1ffff, v4
    s_waitcnt vmcnt(8)
    v_lshlrev_b32 v104, 16, v120
    v_and_b32 v105, 0xffff0000, v120
    v_lshlrev_b32 v106, 16, v121
    v_and_b32 v107, 0xffff0000, v121
    v_mul_f32 v104, v104, v116
    v_mul_f32 v105, v105, v117
    v_mul_f32 v106, v106, v118
    v_mul_f32 v107, v107, v119
    v_cvt_pk_bf16_f32 v104, v104, v105
    v_cvt_pk_bf16_f32 v106, v106, v107
    v_and_b32 v105, 0xffff0000, v104
    v_lshlrev_b32 v104, 16, v104
    v_and_b32 v107, 0xffff0000, v106
    v_lshlrev_b32 v106, 16, v106
    v_add_f32 v52, v52, v56
    v_add_f32 v53, v53, v57
    v_add_f32 v54, v54, v58
    v_add_f32 v55, v55, v59
    v_fma_f32 v108, 2.0, v52, v104
    v_fma_f32 v109, 2.0, v53, v105
    v_fma_f32 v110, 2.0, v54, v106
    v_fma_f32 v111, 2.0, v55, v107
    buffer_store_dwordx4 v[108:111], v124, s[20:23], s50 offen
    s_add_u32 s50, s50, 65536
    s_add_u32 s51, s51, 16384
    s_add_u32 s38, s38, 1
    s_cmp_lt_u32 s38, 32
    s_cbranch_scc1 L_a2_63
    s_endpgm
.section .rodata,"a"
.p2align 6
.amdhsa_kernel concat_heads__ssm_conv_s5__memory_aug_recurrent_mem_tr__prompt_kernel
  .amdhsa_next_free_vgpr 512
  .amdhsa_next_free_sgpr 102
  .amdhsa_accum_offset 256
  .amdhsa_group_segment_fixed_size 0
  .amdhsa_kernarg_size 152
  .amdhsa_user_sgpr_count 2
  .amdhsa_user_sgpr_kernarg_segment_ptr 1
  .amdhsa_system_sgpr_workgroup_id_x 1
.end_amdhsa_kernel
```
